```python
import torch

def _softmax(x, axis=-1):
    return torch.softmax(x, dim=axis)
def _gelu(x):
    return torch.nn.functional.gelu(x, approximate="tanh")
def _silu(x):
    return torch.nn.functional.silu(x)
def _sigmoid(x):
    return torch.sigmoid(x)
def _layernorm(x, axis=-1, eps=1e-5):
    m = x.mean(dim=axis, keepdim=True)
    v = x.var(dim=axis, keepdim=True, unbiased=False)
    return (x - m) / torch.sqrt(v + eps)
def _scatter_add(tgt, idx, src, axis=0):
    return tgt.clone().index_add_(axis, idx, src)
def _segment_sum(src, seg, n):
    out = torch.zeros((n,) + src.shape[1:], dtype=src.dtype)
    return out.index_add_(0, seg, src)
def _pad(x, pw):
    flat = tuple(v for pair in reversed(pw) for v in pair)
    return torch.nn.functional.pad(x, flat)

kernel_name = 'gated_mix__sliding_block__dense_activation_silu__prompt'

def setup_inputs():

    _w = (lambda a: (lambda t: t.to(torch.bfloat16) if t.is_floating_point() else t)(torch.as_tensor(a)))
    def _A_setup():
        B, S, D = 1, 2048, 576
        return {
            "x": _w((lambda *s: torch.randn(*s, dtype=torch.bfloat16) * 0.2)(B, S, D)),
            "wqkv": _w((lambda *s: torch.randn(*s, dtype=torch.bfloat16) * 0.2)(D, 3 * D)),
            "wo": _w((lambda *s: torch.randn(*s, dtype=torch.bfloat16) * 0.2)(D, D)),
        }
    _A_in = _A_setup()

    def _B_setup():
        B, S, D, F = 1, 2048, 576, 4608
        return {
            "x": _w((lambda *s: torch.randn(*s, dtype=torch.bfloat16) * 0.2)(B, S, D)),
            "w1": _w((lambda *s: torch.randn(*s, dtype=torch.bfloat16) * 3.2)(D, F) * (D ** -0.5)),
            "w2": _w((lambda *s: torch.randn(*s, dtype=torch.bfloat16) * 3.2)(F, D) * (F ** -0.5)),
        }
    _B_in = _B_setup()

    return {
        "A_x": _A_in["x"],
        "A_wqkv": _A_in["wqkv"],
        "A_wo": _A_in["wo"],
        "B_x": _B_in["x"],
        "B_w1": _B_in["w1"],
        "B_w2": _B_in["w2"],
        "gate_w": _w((lambda *s: torch.randn(*s, dtype=torch.bfloat16) * 0.2)(576) * 16.0),
    }

def reference(A_x, A_wqkv, A_wo, B_x, B_w1, B_w2, gate_w):
    def _A_ref(x, wqkv, wo):
        B, S, D = x.shape
        H = 32; Dh = D // H; W = 256
        qkv = (lambda x, *d: x.permute(*d))((x @ wqkv).reshape(B, S, 3, H, Dh), 2, 0, 3, 1, 4)
        q, k, v = qkv[0], qkv[1], qkv[2]
        scores = torch.einsum("bhqd,bhkd->bhqk", q, k) * (Dh ** -0.5)
        idx = torch.arange(S)
        mask = (idx[:, None] - idx[None, :] >= 0) & (idx[:, None] - idx[None, :] < W)
        scores = torch.where(mask[None, None], scores, -1e9)
        p = _softmax(scores, axis=-1)
        o = torch.einsum("bhqk,bhkd->bhqd", p, v)
        return (lambda x, *d: x.permute(*d))(o, 0, 2, 1, 3).reshape(B, S, D) @ wo

    def _B_ref(x, w1, w2):
        h = torch.einsum("bsd,df->bsf", x, w1)
        h = _silu(h)
        out = torch.einsum("bsf,fd->bsd", h, w2)
        return out

    x = A_x
    g = _sigmoid((x * gate_w).sum(-1, keepdims=True))
    a = _A_ref(x, A_wqkv, A_wo)
    b = _B_ref(x, B_w1, B_w2)
    return g * a + (1 - g) * b
```

```asm
; @launch grid=(256,1,1) block=(512,1,1) lds=163840
.amdgcn_target "amdgcn-amd-amdhsa--gfx950"
.text
.globl gated_mix__sliding_block__dense_activation_silu__prompt_kernel
.p2align 8
.type gated_mix__sliding_block__dense_activation_silu__prompt_kernel,@function
gated_mix__sliding_block__dense_activation_silu__prompt_kernel:
    s_cmp_ge_u32 s2, 256
    s_cbranch_scc1 L_end_gated_mix__sliding_block__dense_activation_silu__prompt_kernel
    s_load_dwordx2 s[8:9], s[0:1], 0
    s_load_dwordx2 s[12:13], s[0:1], 8
    s_load_dwordx2 s[16:17], s[0:1], 32
    s_load_dwordx2 s[20:21], s[0:1], 72
    s_load_dwordx2 s[28:29], s[0:1], 16
    s_load_dwordx2 s[24:25], s[0:1], 40
    s_load_dwordx2 s[36:37], s[0:1], 48
    s_load_dwordx2 s[32:33], s[0:1], 56
    s_load_dwordx2 s[40:41], s[0:1], 64
    s_mov_b32 s10, 2359296
    s_mov_b32 s11, 0x00020000
    s_mov_b32 s14, 1990656
    s_mov_b32 s15, 0x00020000
    s_mov_b32 s30, 663552
    s_mov_b32 s31, 0x00020000
    s_mov_b32 s18, 5308416
    s_mov_b32 s19, 0x00020000
    s_mov_b32 s26, 5308416
    s_mov_b32 s27, 0x00020000
    s_mov_b32 s38, 1152
    s_mov_b32 s39, 0x00020000
    s_mov_b32 s34, 2359296
    s_mov_b32 s35, 0x00020000
    s_mov_b32 s42, 256
    s_mov_b32 s43, 0x00020000
    s_mov_b32 s22, 42991616
    s_mov_b32 s23, 0x00020000
    v_lshrrev_b32 v1, 6, v0
    v_and_b32 v0, 63, v0
    s_and_b32 s47, s2, 7
    v_readfirstlane_b32 s46, v1
    s_lshr_b32 s3, s2, 3
    s_and_b32 s48, s3, 3
    s_lshr_b32 s44, s3, 2
    s_lshl_b32 s45, s47, 2
    s_add_u32 s45, s45, s48
    s_mov_b32 s51, 0xbfb8aa3b
    s_lshl_b32 s49, s46, 10
    v_lshrrev_b32 v1, 3, v0
    s_lshl_b32 s52, s44, 8
    s_lshl_b32 s53, s46, 5
    s_add_u32 s52, s52, s53
    v_add_u32 v3, s52, v1
    v_mul_u32_u24 v3, 1152, v3
    v_lshrrev_b32 v15, 4, v0
    v_xor_b32 v15, v15, v0
    v_and_b32 v15, 7, v15
    v_lshl_add_u32 v2, v15, 4, v3
    v_xor_b32 v3, 64, v2
    v_add_u32 v3, 9216, v3
    s_mov_b32 s64, 18432
    s_lshl_b32 s53, s46, 3
    v_add_u32 v1, s53, v1
    v_lshrrev_b32 v15, 2, v0
    v_and_b32 v15, 4, v15
    v_xor_b32 v15, v15, v0
    v_and_b32 v15, 7, v15
    v_lshlrev_b32 v15, 4, v15
    v_mul_u32_u24 v4, 9216, v1
    v_mul_u32_u24 v5, 3456, v1
    v_add_u32 v4, v4, v15
    v_add_u32 v5, v5, v15
    v_lshrrev_b32 v1, 2, v0
    v_mul_u32_u24 v1, 9216, v1
    v_and_b32 v15, 3, v0
    v_lshl_add_u32 v15, v15, 4, v1
    s_lshr_b32 s53, s45, 3
    s_mul_i32 s53, s53, 9
    s_add_u32 s53, s53, s45
    s_mul_i32 s54, s45, 17
    s_sub_u32 s54, s54, 451
    s_min_u32 s54, s54, 68
    s_cmp_lt_u32 s45, 27
    s_cselect_b32 s54, s45, s54
    s_lshl_b32 s60, s54, 7
    s_lshl_b32 s65, s54, 12
    s_lshl_b32 s61, s53, 7
    s_and_b32 s54, s45, 7
    s_cmp_lt_u32 s54, 5
    s_cselect_b32 s67, 12, 4
    s_lshl_b32 s62, s67, 7
    s_add_u32 s62, s62, s61
    s_mul_i32 s63, s46, 147456
    s_lshl_b32 s73, s47, 1
    s_add_u32 s73, s73, s48
    s_bitcmp1_b32 s47, 0
    s_cselect_b32 s73, 16, s73
    s_waitcnt lgkmcnt(0)
    s_cmp_ge_u32 s45, 27
    s_cbranch_scc1 L_typeF_1
    s_add_u32 m0, s49, 0
    s_nop 0
    buffer_load_dwordx4 v5, s[12:15], s60 offen lds
    s_add_u32 s60, s60, 221184
    s_add_u32 m0, s49, 8192
    s_nop 0
    buffer_load_dwordx4 v4, s[16:19], s61 offen lds
    s_add_u32 s61, s61, 589824
    s_add_u32 m0, s49, 65536
    s_nop 0
    buffer_load_dwordx4 v2, s[8:11], 0 offen offset:0 lds
    s_add_u32 m0, s49, 90112
    s_nop 0
    buffer_load_dwordx4 v3, s[8:11], 0 offen offset:0 lds
    s_add_u32 m0, s49, 114688
    s_nop 0
    buffer_load_dwordx4 v2, s[8:11], s64 offen offset:0 lds
    s_add_u32 m0, s49, 139264
    s_nop 0
    buffer_load_dwordx4 v3, s[8:11], s64 offen offset:0 lds
    v_and_b32 v1, 31, v0
    v_lshrrev_b32 v244, 3, v1
    v_mul_u32_u24 v244, 24576, v244
    v_and_b32 v14, 7, v0
    v_lshl_add_u32 v244, v14, 7, v244
    s_add_u32 s54, s49, 65536
    v_add_u32 v244, s54, v244
    v_bfe_u32 v14, v0, 1, 3
    v_lshrrev_b32 v1, 5, v0
    v_xor_b32 v1, v1, v14
    v_xor_b32 v8, 0, v1
    v_lshl_add_u32 v8, v8, 4, v244
    v_xor_b32 v9, 2, v1
    v_lshl_add_u32 v9, v9, 4, v244
    v_xor_b32 v10, 4, v1
    v_lshl_add_u32 v10, v10, 4, v244
    v_xor_b32 v11, 6, v1
    v_lshl_add_u32 v11, v11, 4, v244
    s_add_u32 m0, s49, 73600
    s_nop 0
    buffer_load_dwordx4 v2, s[8:11], 0 offen offset:128 lds
    s_add_u32 m0, s49, 98176
    s_nop 0
    buffer_load_dwordx4 v3, s[8:11], 0 offen offset:128 lds
    s_add_u32 m0, s49, 122752
    s_nop 0
    buffer_load_dwordx4 v2, s[8:11], s64 offen offset:128 lds
    s_add_u32 m0, s49, 147328
    s_nop 0
    buffer_load_dwordx4 v3, s[8:11], s64 offen offset:128 lds
    s_add_u32 m0, s49, 16384
    s_nop 0
    buffer_load_dwordx4 v5, s[12:15], s60 offen lds
    s_add_u32 s60, s60, 221184
    s_add_u32 m0, s49, 24576
    s_nop 0
    buffer_load_dwordx4 v4, s[16:19], s61 offen lds
    s_add_u32 s61, s61, 589824
    v_bfe_u32 v1, v0, 2, 2
    v_lshrrev_b32 v244, 5, v0
    v_lshl_add_u32 v1, v244, 3, v1
    v_and_b32 v244, 3, v0
    v_lshlrev_b32 v244, 3, v244
    v_bfe_u32 v14, v0, 4, 1
    v_lshl_add_u32 v244, v14, 5, v244
    v_lshl_add_u32 v14, v1, 6, v244
    v_add_u32 v14, 53248, v14
    v_lshl_add_u32 v6, v1, 7, v244
    v_bfe_u32 v1, v0, 3, 1
    v_lshl_add_u32 v6, v1, 6, v6
    v_xor_b32 v7, 64, v6
    s_add_u32 m0, s49, 81664
    s_nop 0
    buffer_load_dwordx4 v2, s[8:11], 0 offen offset:256 lds
    s_add_u32 m0, s49, 106240
    s_nop 0
    buffer_load_dwordx4 v3, s[8:11], 0 offen offset:256 lds
    s_add_u32 m0, s49, 130816
    s_nop 0
    buffer_load_dwordx4 v2, s[8:11], s64 offen offset:256 lds
    s_add_u32 m0, s49, 155392
    s_nop 0
    buffer_load_dwordx4 v3, s[8:11], s64 offen offset:256 lds
    s_add_u32 m0, s49, 32768
    s_nop 0
    buffer_load_dwordx4 v5, s[12:15], s60 offen lds
    s_add_u32 s60, s60, 221184
    s_add_u32 m0, s49, 40960
    s_nop 0
    buffer_load_dwordx4 v4, s[16:19], s61 offen lds
    s_add_u32 s61, s61, 589824
    s_add_u32 s54, s52, s45
    s_mul_i32 s72, s54, 1152
    s_lshl_b32 s71, s54, 3
    s_add_u32 s71, s71, 29360128
    v_lshlrev_b32 v252, 5, v0
    v_mov_b32 v253, 0x7ffffff0
    v_cmp_gt_u32 vcc, 36, v0
    s_nop 1
    v_cndmask_b32 v252, v253, v252, vcc
    s_add_u32 m0, s49, 49152
    s_nop 0
    buffer_load_dwordx4 v5, s[12:15], s60 offen lds
    s_add_u32 s60, s60, 221184
    s_add_u32 m0, s49, 57344
    s_nop 0
    buffer_load_dwordx4 v4, s[16:19], s61 offen lds
    s_add_u32 s61, s61, 589824
    buffer_load_dwordx4 v[144:147], v252, s[8:11], s72 offen
    buffer_load_dwordx4 v[148:151], v252, s[8:11], s72 offen offset:16
    buffer_load_dwordx4 v[152:155], v252, s[36:39], 0 offen
    buffer_load_dwordx4 v[156:159], v252, s[36:39], 0 offen offset:16
    v_cmp_eq_u32 vcc, 63, v0
    s_nop 1
    v_cndmask_b32 v253, v253, 0, vcc
    v_lshlrev_b32 v12, 4, v0
    v_and_b32 v1, 31, v0
    v_lshrrev_b32 v13, 5, v0
    v_lshlrev_b32 v13, 4, v13
    v_lshl_add_u32 v13, v1, 5, v13
    s_lshr_b32 s54, s52, 5
    s_mul_i32 s69, s54, 110592
    s_lshl_b32 s55, s45, 11
    s_add_u32 s69, s69, s55
    s_add_u32 s70, s69, 55296
    s_mul_i32 s54, s54, 331776
    s_add_u32 s54, s54, 7340032
    s_add_u32 s65, s65, s54
    s_lshl_b32 s55, s53, 12
    s_add_u32 s66, s54, s55
    s_lshl_b32 s67, s67, 12
    s_add_u32 s67, s67, s66
    s_lshr_b32 s55, s73, 1
    s_lshl_b32 s53, s55, 6
    s_add_u32 s63, s63, s53
    s_add_u32 s63, s63, 8832
    s_lshl_b32 s55, s55, 11
    s_add_u32 s68, s54, s55
    s_add_u32 s68, s68, 282624
    s_or_b32 s52, s2, s46
    s_cmp_lg_u32 s52, 0
    s_cbranch_scc1 L_np_3
    s_memrealtime s[52:53]
    s_waitcnt lgkmcnt(0)
    s_or_b32 s52, s52, 1
    v_mov_b32 v1, s52
    s_mov_b64 exec, 1
    buffer_store_dword v1, off, s[40:43], 0 sc1
    s_mov_b64 exec, -1
L_np_3:
    s_lshl_b32 s52, s44, 3
    s_add_u32 s52, s52, s46
    s_lshl_b32 s3, s52, 7
    s_lshl_b32 s52, s45, 2
    s_add_u32 s3, s3, s52
    s_add_u32 s3, s3, 29425664
    s_mov_b32 s4, 29425664
    s_lshr_b32 s53, s47, 1
    s_mul_i32 s6, s53, 1253376
    s_lshr_b32 s52, s2, 3
    s_lshl_b32 s52, s52, 3
    s_add_u32 s52, s52, s46
    s_mul_i32 s7, s53, 248832
    s_sub_u32 s7, s7, 248832
    s_cmp_eq_u32 s53, 0
    s_cselect_b32 s7, 5087232, s7
    s_lshl_b32 s53, s52, 10
    s_add_u32 s7, s7, s53
    s_mul_i32 s52, s52, 1280
    s_add_u32 s6, s6, s52
    s_and_b32 s52, s47, 1
    s_mul_i32 s52, s52, 655360
    s_add_u32 s6, s6, s52
    s_lshl_b32 s52, s52, 1
    s_sub_u32 s5, 327680, s52
    s_waitcnt vmcnt(18)
    ds_read_b128 v[16:19], v8 offset:0
    ds_read_b128 v[20:23], v9 offset:0
    ds_read_b128 v[24:27], v10 offset:0
    ds_read_b128 v[28:31], v11 offset:0
    s_barrier
    ds_read_b64_tr_b16 v[224:225], v6 offset:0
    ds_read_b64_tr_b16 v[226:227], v6 offset:512
    ds_read_b64_tr_b16 v[228:229], v7 offset:0
    ds_read_b64_tr_b16 v[230:231], v7 offset:512
    ds_read_b64_tr_b16 v[232:233], v6 offset:8192
    ds_read_b64_tr_b16 v[234:235], v6 offset:8704
    s_lshl_b32 s52, s2, 3
    s_add_u32 s52, s52, s46
    s_lshl_b32 s52, s52, 7
    s_add_u32 s52, s52, 0
    v_mul_u32_u24 v129, 1061888, v0
    s_mov_b64 exec, 31
    buffer_load_dword v128, v129, s[24:27], s52 offen
    s_mov_b64 exec, -1
    ds_read_b64_tr_b16 v[236:237], v7 offset:8192
    ds_read_b64_tr_b16 v[238:239], v7 offset:8704
    s_waitcnt lgkmcnt(6)
    v_mfma_f32_32x32x16_bf16 v[160:175], v[16:19], v[224:227], 0
    ds_read_b64_tr_b16 v[240:241], v6 offset:2048
    ds_read_b64_tr_b16 v[242:243], v6 offset:2560
    s_add_u32 m0, s49, 65152
    s_nop 0
    buffer_load_dwordx4 v2, s[8:11], 0 offen offset:384 lds
    s_waitcnt lgkmcnt(6)
    v_mfma_f32_32x32x16_bf16 v[176:191], v[16:19], v[228:231], 0
    ds_read_b64_tr_b16 v[224:225], v7 offset:2048
    ds_read_b64_tr_b16 v[226:227], v7 offset:2560
    s_add_u32 m0, s49, 89728
    s_nop 0
    buffer_load_dwordx4 v3, s[8:11], 0 offen offset:384 lds
    s_waitcnt lgkmcnt(6)
    v_mfma_f32_32x32x16_bf16 v[192:207], v[232:235], v[16:19], 0
    ds_read_b64_tr_b16 v[228:229], v6 offset:10240
    ds_read_b64_tr_b16 v[230:231], v6 offset:10752
    s_add_u32 m0, s49, 114304
    s_nop 0
    buffer_load_dwordx4 v2, s[8:11], s64 offen offset:384 lds
    s_waitcnt lgkmcnt(6)
    v_mfma_f32_32x32x16_bf16 v[208:223], v[236:239], v[16:19], 0
    ds_read_b64_tr_b16 v[232:233], v7 offset:10240
    ds_read_b64_tr_b16 v[234:235], v7 offset:10752
    s_add_u32 m0, s49, 138880
    s_nop 0
    buffer_load_dwordx4 v3, s[8:11], s64 offen offset:384 lds
    s_waitcnt lgkmcnt(6)
    v_mfma_f32_32x32x16_bf16 v[160:175], v[20:23], v[240:243], v[160:175]
    ds_read_b64_tr_b16 v[236:237], v6 offset:4096
    ds_read_b64_tr_b16 v[238:239], v6 offset:4608
    s_waitcnt vmcnt(19)
    ds_read_b128 v[32:35], v8 offset:8192
    s_waitcnt lgkmcnt(7)
    v_mfma_f32_32x32x16_bf16 v[176:191], v[20:23], v[224:227], v[176:191]
    ds_read_b64_tr_b16 v[240:241], v7 offset:4096
    ds_read_b64_tr_b16 v[242:243], v7 offset:4608
    ds_read_b128 v[36:39], v9 offset:8192
    s_waitcnt lgkmcnt(8)
    v_mfma_f32_32x32x16_bf16 v[192:207], v[228:231], v[20:23], v[192:207]
    ds_read_b64_tr_b16 v[224:225], v6 offset:12288
    ds_read_b64_tr_b16 v[226:227], v6 offset:12800
    ds_read_b128 v[40:43], v10 offset:8192
    s_lshl_b32 s52, s2, 3
    s_add_u32 s52, s52, s46
    s_lshl_b32 s52, s52, 7
    s_add_u32 s52, s52, 262144
    v_mul_u32_u24 v129, 1061888, v0
    s_mov_b64 exec, 31
    buffer_load_dword v128, v129, s[24:27], s52 offen
    s_mov_b64 exec, -1
    s_waitcnt lgkmcnt(9)
    v_mfma_f32_32x32x16_bf16 v[208:223], v[232:235], v[20:23], v[208:223]
    ds_read_b64_tr_b16 v[228:229], v7 offset:12288
    ds_read_b64_tr_b16 v[230:231], v7 offset:12800
    ds_read_b128 v[44:47], v11 offset:8192
    s_waitcnt lgkmcnt(10)
    v_mfma_f32_32x32x16_bf16 v[160:175], v[24:27], v[236:239], v[160:175]
    ds_read_b64_tr_b16 v[232:233], v6 offset:6144
    ds_read_b64_tr_b16 v[234:235], v6 offset:6656
    s_waitcnt lgkmcnt(2)
    s_add_u32 m0, s49, 73216
    s_nop 0
    buffer_load_dwordx4 v2, s[8:11], 0 offen offset:512 lds
    v_mfma_f32_32x32x16_bf16 v[176:191], v[24:27], v[240:243], v[176:191]
    ds_read_b64_tr_b16 v[236:237], v7 offset:6144
    ds_read_b64_tr_b16 v[238:239], v7 offset:6656
    s_add_u32 m0, s49, 97792
    s_nop 0
    buffer_load_dwordx4 v3, s[8:11], 0 offen offset:512 lds
    v_mfma_f32_32x32x16_bf16 v[192:207], v[224:227], v[24:27], v[192:207]
    ds_read_b64_tr_b16 v[240:241], v6 offset:14336
    ds_read_b64_tr_b16 v[242:243], v6 offset:14848
    s_add_u32 m0, s49, 122368
    s_nop 0
    buffer_load_dwordx4 v2, s[8:11], s64 offen offset:512 lds
    v_mfma_f32_32x32x16_bf16 v[208:223], v[228:231], v[24:27], v[208:223]
    ds_read_b64_tr_b16 v[224:225], v7 offset:14336
    ds_read_b64_tr_b16 v[226:227], v7 offset:14848
    s_add_u32 m0, s49, 146944
    s_nop 0
    buffer_load_dwordx4 v3, s[8:11], s64 offen offset:512 lds
    s_waitcnt lgkmcnt(6)
    v_mfma_f32_32x32x16_bf16 v[160:175], v[28:31], v[232:235], v[160:175]
    s_waitcnt vmcnt(22)
    s_barrier
    ds_read_b64_tr_b16 v[228:229], v6 offset:16384
    ds_read_b64_tr_b16 v[230:231], v6 offset:16896
    buffer_load_dword v254, off, s[40:43], 0 sc1
    s_waitcnt lgkmcnt(6)
    v_mfma_f32_32x32x16_bf16 v[176:191], v[28:31], v[236:239], v[176:191]
    ds_read_b64_tr_b16 v[232:233], v7 offset:16384
    ds_read_b64_tr_b16 v[234:235], v7 offset:16896
    s_add_u32 m0, s49, 0
    s_nop 0
    buffer_load_dwordx4 v5, s[12:15], s60 offen lds
    s_add_u32 s60, s60, 221184
    s_waitcnt lgkmcnt(6)
    v_mfma_f32_32x32x16_bf16 v[192:207], v[240:243], v[28:31], v[192:207]
    ds_read_b64_tr_b16 v[236:237], v6 offset:24576
    ds_read_b64_tr_b16 v[238:239], v6 offset:25088
    s_lshl_b32 s52, s2, 3
    s_add_u32 s52, s52, s46
    s_lshl_b32 s52, s52, 7
    s_add_u32 s52, s52, 524288
    v_mul_u32_u24 v129, 1061888, v0
    s_mov_b64 exec, 31
    buffer_load_dword v128, v129, s[24:27], s52 offen
    s_mov_b64 exec, -1
    s_waitcnt lgkmcnt(6)
    v_mfma_f32_32x32x16_bf16 v[208:223], v[224:227], v[28:31], v[208:223]
    ds_read_b64_tr_b16 v[240:241], v7 offset:24576
    ds_read_b64_tr_b16 v[242:243], v7 offset:25088
    s_add_u32 m0, s49, 8192
    s_nop 0
    buffer_load_dwordx4 v4, s[16:19], s61 offen lds
    s_add_u32 s61, s61, 589824
    s_waitcnt lgkmcnt(6)
    v_mfma_f32_32x32x16_bf16 v[160:175], v[32:35], v[228:231], v[160:175]
    s_waitcnt vmcnt(14)
    v_mov_b32 v244, 0
    v_mov_b32 v245, 0
    v_lshlrev_b32 v246, 16, v144
    ds_read_b64_tr_b16 v[224:225], v6 offset:18432
    ds_read_b64_tr_b16 v[226:227], v6 offset:18944
    ds_read_b128 v[48:51], v8 offset:16384
    s_waitcnt lgkmcnt(7)
    v_mfma_f32_32x32x16_bf16 v[176:191], v[32:35], v[232:235], v[176:191]
    v_and_b32 v247, 0xffff0000, v144
    v_lshlrev_b32 v248, 16, v152
    v_and_b32 v249, 0xffff0000, v152
    v_mul_f32 v246, v246, v248
    ds_read_b64_tr_b16 v[228:229], v7 offset:18432
    ds_read_b64_tr_b16 v[230:231], v7 offset:18944
    ds_read_b128 v[52:55], v9 offset:16384
    s_waitcnt lgkmcnt(8)
    v_mfma_f32_32x32x16_bf16 v[192:207], v[236:239], v[32:35], v[192:207]
    v_mul_f32 v247, v247, v249
    v_cvt_pk_bf16_f32 v246, v246, v247
    v_lshlrev_b32 v247, 16, v246
    ds_read_b64_tr_b16 v[232:233], v6 offset:26624
    ds_read_b64_tr_b16 v[234:235], v6 offset:27136
    ds_read_b128 v[56:59], v10 offset:16384
    s_waitcnt lgkmcnt(9)
    v_mfma_f32_32x32x16_bf16 v[208:223], v[240:243], v[32:35], v[208:223]
    v_and_b32 v246, 0xffff0000, v246
    v_add_f32 v244, v244, v247
    v_add_f32 v245, v245, v246
    v_lshlrev_b32 v246, 16, v145
    ds_read_b64_tr_b16 v[236:237], v7 offset:26624
    ds_read_b64_tr_b16 v[238:239], v7 offset:27136
    ds_read_b128 v[60:63], v11 offset:16384
    s_waitcnt lgkmcnt(10)
    v_mfma_f32_32x32x16_bf16 v[160:175], v[36:39], v[224:227], v[160:175]
    v_and_b32 v247, 0xffff0000, v145
    v_lshlrev_b32 v248, 16, v153
    v_and_b32 v249, 0xffff0000, v153
    ds_read_b64_tr_b16 v[240:241], v6 offset:20480
    ds_read_b64_tr_b16 v[242:243], v6 offset:20992
    s_waitcnt lgkmcnt(9)
    v_mfma_f32_32x32x16_bf16 v[176:191], v[36:39], v[228:231], v[176:191]
    v_mul_f32 v246, v246, v248
    v_mul_f32 v247, v247, v249
    v_cvt_pk_bf16_f32 v246, v246, v247
    v_lshlrev_b32 v247, 16, v246
    ds_read_b64_tr_b16 v[224:225], v7 offset:20480
    ds_read_b64_tr_b16 v[226:227], v7 offset:20992
    s_lshl_b32 s54, s44, 3
    s_add_u32 s54, s54, s46
    v_and_b32 v1, 15, v0
    v_lshl_add_u32 v1, v1, 6, s54
    v_mul_u32_u24 v250, 9216, v1
    s_bfe_u32 s55, s73, 0x20002
    s_lshl_b32 s55, s55, 7
    s_add_u32 s55, s55, 8832
    v_mov_b32 v1, s62
    v_mov_b32 v251, s55
    v_cmp_gt_u32 vcc, 16, v0
    s_nop 1
    v_cndmask_b32 v1, v251, v1, vcc
    v_add_u32 v250, v250, v1
    s_and_b32 s55, s73, 0x1f3
    s_cmp_eq_u32 s55, 0
    s_mov_b64 exec, 0x1ff
    s_cselect_b32 exec_lo, 0x1ff01ff, exec_lo
    buffer_load_dword v251, v250, s[16:19], 0 offen
    s_mov_b64 exec, -1
    s_waitcnt lgkmcnt(8)
    v_mfma_f32_32x32x16_bf16 v[192:207], v[232:235], v[36:39], v[192:207]
    v_and_b32 v246, 0xffff0000, v246
    v_add_f32 v244, v244, v247
    v_add_f32 v245, v245, v246
    ds_read_b64_tr_b16 v[228:229], v6 offset:28672
    ds_read_b64_tr_b16 v[230:231], v6 offset:29184
    s_lshl_b32 s52, s2, 3
    s_add_u32 s52, s52, s46
    s_lshl_b32 s52, s52, 7
    s_add_u32 s52, s52, 786432
    v_mul_u32_u24 v129, 1061888, v0
    s_mov_b64 exec, 31
    buffer_load_dword v128, v129, s[24:27], s52 offen
    s_mov_b64 exec, -1
    s_waitcnt lgkmcnt(7)
    v_mfma_f32_32x32x16_bf16 v[208:223], v[236:239], v[36:39], v[208:223]
    v_lshlrev_b32 v246, 16, v146
    v_and_b32 v247, 0xffff0000, v146
    v_lshlrev_b32 v248, 16, v154
    v_and_b32 v249, 0xffff0000, v154
    ds_read_b64_tr_b16 v[232:233], v7 offset:28672
    ds_read_b64_tr_b16 v[234:235], v7 offset:29184
    s_waitcnt lgkmcnt(6)
    v_mfma_f32_32x32x16_bf16 v[160:175], v[40:43], v[240:243], v[160:175]
    v_mul_f32 v246, v246, v248
    v_mul_f32 v247, v247, v249
    v_cvt_pk_bf16_f32 v246, v246, v247
    ds_read_b64_tr_b16 v[236:237], v6 offset:22528
    ds_read_b64_tr_b16 v[238:239], v6 offset:23040
    s_add_u32 m0, s49, 81280
    s_nop 0
    buffer_load_dwordx4 v2, s[8:11], 0 offen offset:640 lds
    s_waitcnt lgkmcnt(6)
    v_mfma_f32_32x32x16_bf16 v[176:191], v[40:43], v[224:227], v[176:191]
    v_lshlrev_b32 v247, 16, v246
    v_and_b32 v246, 0xffff0000, v246
    v_add_f32 v244, v244, v247
    v_add_f32 v245, v245, v246
    ds_read_b64_tr_b16 v[240:241], v7 offset:22528
    ds_read_b64_tr_b16 v[242:243], v7 offset:23040
    s_add_u32 m0, s49, 105856
    s_nop 0
    buffer_load_dwordx4 v3, s[8:11], 0 offen offset:640 lds
    s_waitcnt lgkmcnt(6)
    v_mfma_f32_32x32x16_bf16 v[192:207], v[228:231], v[40:43], v[192:207]
    v_lshlrev_b32 v246, 16, v147
    v_and_b32 v247, 0xffff0000, v147
    v_lshlrev_b32 v248, 16, v155
    ds_read_b64_tr_b16 v[224:225], v6 offset:30720
    ds_read_b64_tr_b16 v[226:227], v6 offset:31232
    s_add_u32 m0, s49, 130432
    s_nop 0
    buffer_load_dwordx4 v2, s[8:11], s64 offen offset:640 lds
    s_waitcnt lgkmcnt(6)
    v_mfma_f32_32x32x16_bf16 v[208:223], v[232:235], v[40:43], v[208:223]
    v_and_b32 v249, 0xffff0000, v155
    v_mul_f32 v246, v246, v248
    v_mul_f32 v247, v247, v249
    v_cvt_pk_bf16_f32 v246, v246, v247
    ds_read_b64_tr_b16 v[228:229], v7 offset:30720
    ds_read_b64_tr_b16 v[230:231], v7 offset:31232
    s_add_u32 m0, s49, 155008
    s_nop 0
    buffer_load_dwordx4 v3, s[8:11], s64 offen offset:640 lds
    s_waitcnt lgkmcnt(6)
    v_mfma_f32_32x32x16_bf16 v[160:175], v[44:47], v[236:239], v[160:175]
    v_lshlrev_b32 v247, 16, v246
    v_and_b32 v246, 0xffff0000, v246
    v_add_f32 v244, v244, v247
    s_barrier
    ds_read_b64_tr_b16 v[232:233], v6 offset:32768
    ds_read_b64_tr_b16 v[234:235], v6 offset:33280
    s_waitcnt lgkmcnt(6)
    v_mfma_f32_32x32x16_bf16 v[176:191], v[44:47], v[240:243], v[176:191]
    v_add_f32 v245, v245, v246
    v_lshlrev_b32 v246, 16, v148
    v_and_b32 v247, 0xffff0000, v148
    v_lshlrev_b32 v248, 16, v156
    ds_read_b64_tr_b16 v[236:237], v7 offset:32768
    ds_read_b64_tr_b16 v[238:239], v7 offset:33280
    s_add_u32 m0, s49, 16384
    s_nop 0
    buffer_load_dwordx4 v5, s[12:15], s60 offen lds
    s_add_u32 s60, s60, 221184
    s_waitcnt lgkmcnt(6)
    v_mfma_f32_32x32x16_bf16 v[192:207], v[224:227], v[44:47], v[192:207]
    v_and_b32 v249, 0xffff0000, v156
    v_mul_f32 v246, v246, v248
    v_mul_f32 v247, v247, v249
    ds_read_b64_tr_b16 v[240:241], v6 offset:40960
    ds_read_b64_tr_b16 v[242:243], v6 offset:41472
    s_lshl_b32 s52, s2, 3
    s_add_u32 s52, s52, s46
    s_lshl_b32 s52, s52, 7
    v_mul_u32_u24 v129, 200704, v0
    s_mov_b64 exec, 7
    buffer_load_dword v128, v129, s[28:31], s52 offen
    s_mov_b64 exec, -1
    s_waitcnt lgkmcnt(6)
    v_mfma_f32_32x32x16_bf16 v[208:223], v[228:231], v[44:47], v[208:223]
    v_cvt_pk_bf16_f32 v246, v246, v247
    v_lshlrev_b32 v247, 16, v246
    v_and_b32 v246, 0xffff0000, v246
    v_add_f32 v244, v244, v247
    ds_read_b64_tr_b16 v[224:225], v7 offset:40960
    ds_read_b64_tr_b16 v[226:227], v7 offset:41472
    s_add_u32 m0, s49, 24576
    s_nop 0
    buffer_load_dwordx4 v4, s[16:19], s61 offen lds
    s_add_u32 s61, s61, 589824
    s_waitcnt lgkmcnt(6)
    v_mfma_f32_32x32x16_bf16 v[160:175], v[48:51], v[232:235], v[160:175]
    v_add_f32 v245, v245, v246
    v_lshlrev_b32 v246, 16, v149
    v_and_b32 v247, 0xffff0000, v149
    ds_read_b64_tr_b16 v[228:229], v6 offset:34816
    ds_read_b64_tr_b16 v[230:231], v6 offset:35328
    s_waitcnt vmcnt(18)
    ds_read_b128 v[64:67], v8 offset:0
    s_waitcnt lgkmcnt(7)
    v_mfma_f32_32x32x16_bf16 v[176:191], v[48:51], v[236:239], v[176:191]
    v_lshlrev_b32 v248, 16, v157
    v_and_b32 v249, 0xffff0000, v157
    v_mul_f32 v246, v246, v248
    v_mul_f32 v247, v247, v249
    ds_read_b64_tr_b16 v[232:233], v7 offset:34816
    ds_read_b64_tr_b16 v[234:235], v7 offset:35328
    ds_read_b128 v[68:71], v9 offset:0
    s_waitcnt lgkmcnt(8)
    v_mfma_f32_32x32x16_bf16 v[192:207], v[240:243], v[48:51], v[192:207]
    v_cvt_pk_bf16_f32 v246, v246, v247
    v_lshlrev_b32 v247, 16, v246
    v_and_b32 v246, 0xffff0000, v246
    ds_read_b64_tr_b16 v[236:237], v6 offset:43008
    ds_read_b64_tr_b16 v[238:239], v6 offset:43520
    ds_read_b128 v[72:75], v10 offset:0
    s_waitcnt lgkmcnt(9)
    v_mfma_f32_32x32x16_bf16 v[208:223], v[224:227], v[48:51], v[208:223]
    v_add_f32 v244, v244, v247
    v_add_f32 v245, v245, v246
    v_lshlrev_b32 v246, 16, v150
    v_and_b32 v247, 0xffff0000, v150
    ds_read_b64_tr_b16 v[240:241], v7 offset:43008
    ds_read_b64_tr_b16 v[242:243], v7 offset:43520
    ds_read_b128 v[76:79], v11 offset:0
    s_waitcnt lgkmcnt(10)
    v_mfma_f32_32x32x16_bf16 v[160:175], v[52:55], v[228:231], v[160:175]
    v_lshlrev_b32 v248, 16, v158
    v_and_b32 v249, 0xffff0000, v158
    v_mul_f32 v246, v246, v248
    ds_read_b64_tr_b16 v[224:225], v6 offset:36864
    ds_read_b64_tr_b16 v[226:227], v6 offset:37376
    s_waitcnt lgkmcnt(9)
    v_mfma_f32_32x32x16_bf16 v[176:191], v[52:55], v[232:235], v[176:191]
    v_mul_f32 v247, v247, v249
    v_cvt_pk_bf16_f32 v246, v246, v247
    v_lshlrev_b32 v247, 16, v246
    v_and_b32 v246, 0xffff0000, v246
    ds_read_b64_tr_b16 v[228:229], v7 offset:36864
    ds_read_b64_tr_b16 v[230:231], v7 offset:37376
    s_waitcnt lgkmcnt(8)
    v_mfma_f32_32x32x16_bf16 v[192:207], v[236:239], v[52:55], v[192:207]
    v_add_f32 v244, v244, v247
    v_add_f32 v245, v245, v246
    v_lshlrev_b32 v246, 16, v151
    ds_read_b64_tr_b16 v[232:233], v6 offset:45056
    ds_read_b64_tr_b16 v[234:235], v6 offset:45568
    s_waitcnt lgkmcnt(7)
    v_mfma_f32_32x32x16_bf16 v[208:223], v[240:243], v[52:55], v[208:223]
    v_and_b32 v247, 0xffff0000, v151
    v_lshlrev_b32 v248, 16, v159
    v_and_b32 v249, 0xffff0000, v159
    v_mul_f32 v246, v246, v248
    ds_read_b64_tr_b16 v[236:237], v7 offset:45056
    ds_read_b64_tr_b16 v[238:239], v7 offset:45568
    s_waitcnt lgkmcnt(6)
    v_mfma_f32_32x32x16_bf16 v[160:175], v[56:59], v[224:227], v[160:175]
    v_mul_f32 v247, v247, v249
    v_cvt_pk_bf16_f32 v246, v246, v247
    v_lshlrev_b32 v247, 16, v246
    ds_read_b64_tr_b16 v[240:241], v6 offset:38912
    ds_read_b64_tr_b16 v[242:243], v6 offset:39424
    s_add_u32 m0, s49, 64768
    s_nop 0
    buffer_load_dwordx4 v2, s[8:11], 0 offen offset:768 lds
    s_waitcnt lgkmcnt(6)
    v_mfma_f32_32x32x16_bf16 v[176:191], v[56:59], v[228:231], v[176:191]
    v_and_b32 v246, 0xffff0000, v246
    v_add_f32 v244, v244, v247
    v_add_f32 v245, v245, v246
    ds_read_b64_tr_b16 v[224:225], v7 offset:38912
    ds_read_b64_tr_b16 v[226:227], v7 offset:39424
    s_add_u32 m0, s49, 89344
    s_nop 0
    buffer_load_dwordx4 v3, s[8:11], 0 offen offset:768 lds
    s_waitcnt lgkmcnt(6)
    v_mfma_f32_32x32x16_bf16 v[192:207], v[232:235], v[56:59], v[192:207]
    v_add_f32 v244, v244, v245
    ds_read_b64_tr_b16 v[228:229], v6 offset:47104
    ds_read_b64_tr_b16 v[230:231], v6 offset:47616
    s_add_u32 m0, s49, 113920
    s_nop 0
    buffer_load_dwordx4 v2, s[8:11], s64 offen offset:768 lds
    s_waitcnt lgkmcnt(6)
    v_mfma_f32_32x32x16_bf16 v[208:223], v[236:239], v[56:59], v[208:223]
    v_add_f32_dpp v244, v244, v244 row_shr:1 row_mask:0xf bank_mask:0xf bound_ctrl:0
    ds_read_b64_tr_b16 v[232:233], v7 offset:47104
    ds_read_b64_tr_b16 v[234:235], v7 offset:47616
    s_add_u32 m0, s49, 138496
    s_nop 0
    buffer_load_dwordx4 v3, s[8:11], s64 offen offset:768 lds
    s_waitcnt lgkmcnt(6)
    v_mfma_f32_32x32x16_bf16 v[160:175], v[60:63], v[240:243], v[160:175]
    v_add_f32_dpp v244, v244, v244 row_shr:2 row_mask:0xf bank_mask:0xf bound_ctrl:0
    s_barrier
    ds_read_b64_tr_b16 v[236:237], v6 offset:49152
    ds_read_b64_tr_b16 v[238:239], v6 offset:49664
    s_waitcnt lgkmcnt(6)
    v_mfma_f32_32x32x16_bf16 v[176:191], v[60:63], v[224:227], v[176:191]
    v_add_f32_dpp v244, v244, v244 row_shr:4 row_mask:0xf bank_mask:0xf bound_ctrl:0
    s_nop 1
    v_add_f32_dpp v244, v244, v244 row_shr:8 row_mask:0xf bank_mask:0xf bound_ctrl:0
    ds_read_b64_tr_b16 v[240:241], v7 offset:49152
    ds_read_b64_tr_b16 v[242:243], v7 offset:49664
    s_add_u32 m0, s49, 32768
    s_nop 0
    buffer_load_dwordx4 v5, s[12:15], s60 offen lds
    s_add_u32 s60, s60, 221184
    s_waitcnt lgkmcnt(6)
    v_mfma_f32_32x32x16_bf16 v[192:207], v[228:231], v[60:63], v[192:207]
    v_add_f32_dpp v244, v244, v244 row_bcast:15 row_mask:0xa bank_mask:0xf
    ds_read_b64_tr_b16 v[224:225], v6 offset:57344
    ds_read_b64_tr_b16 v[226:227], v6 offset:57856
    s_waitcnt lgkmcnt(6)
    v_mfma_f32_32x32x16_bf16 v[208:223], v[232:235], v[60:63], v[208:223]
    v_add_f32_dpp v244, v244, v244 row_bcast:31 row_mask:0xc bank_mask:0xf
    v_cvt_pk_bf16_f32 v244, v244, v244
    v_and_b32 v244, 0xffff0000, v244
    v_mul_f32 v244, s51, v244
    ds_read_b64_tr_b16 v[228:229], v7 offset:57344
    ds_read_b64_tr_b16 v[230:231], v7 offset:57856
    s_add_u32 m0, s49, 40960
    s_nop 0
    buffer_load_dwordx4 v4, s[16:19], s61 offen lds
    s_add_u32 s61, s61, 589824
    s_waitcnt lgkmcnt(6)
    v_mfma_f32_32x32x16_bf16 v[160:175], v[64:67], v[236:239], v[160:175]
    v_exp_f32 v244, v244
    ds_read_b64_tr_b16 v[232:233], v6 offset:51200
    ds_read_b64_tr_b16 v[234:235], v6 offset:51712
    s_waitcnt vmcnt(19)
    ds_read_b128 v[80:83], v8 offset:8192
    s_waitcnt lgkmcnt(7)
    v_mfma_f32_32x32x16_bf16 v[176:191], v[64:67], v[240:243], v[176:191]
    v_add_f32 v244, 1.0, v244
    v_rcp_f32 v244, v244
    ds_read_b64_tr_b16 v[236:237], v7 offset:51200
    ds_read_b64_tr_b16 v[238:239], v7 offset:51712
    ds_read_b128 v[84:87], v9 offset:8192
    s_waitcnt lgkmcnt(8)
    v_mfma_f32_32x32x16_bf16 v[192:207], v[224:227], v[64:67], v[192:207]
    v_cvt_pk_bf16_f32 v244, v244, v244
    v_and_b32 v244, 0xffff0000, v244
    v_sub_f32 v245, 1.0, v244
    ds_read_b64_tr_b16 v[240:241], v6 offset:59392
    ds_read_b64_tr_b16 v[242:243], v6 offset:59904
    ds_read_b128 v[88:91], v10 offset:8192
    s_waitcnt lgkmcnt(9)
    v_mfma_f32_32x32x16_bf16 v[208:223], v[228:231], v[64:67], v[208:223]
    v_cvt_pk_bf16_f32 v244, v244, v245
    s_waitcnt vmcnt(18)
    s_mov_b32 s59, 30000
L_ngl_6:
    v_readfirstlane_b32 s50, v254
    s_nop 0
    s_cmp_lg_u32 s50, 0
    s_cbranch_scc1 L_ng_5
    buffer_load_dword v254, off, s[40:43], 0 sc1
    s_waitcnt vmcnt(0)
    s_sub_u32 s59, s59, 1
    s_cmp_lg_u32 s59, 0
    s_cbranch_scc1 L_ngl_6
L_ng_5:
    v_mov_b32 v245, s50
    buffer_store_dwordx2 v[244:245], v253, s[20:23], s71 offen sc1
    ds_read_b64_tr_b16 v[224:225], v7 offset:59392
    ds_read_b64_tr_b16 v[226:227], v7 offset:59904
    ds_read_b128 v[92:95], v11 offset:8192
    s_waitcnt lgkmcnt(10)
    v_mfma_f32_32x32x16_bf16 v[160:175], v[68:71], v[232:235], v[160:175]
    ds_read_b64_tr_b16 v[228:229], v6 offset:53248
    ds_read_b64_tr_b16 v[230:231], v6 offset:53760
    s_waitcnt lgkmcnt(9)
    v_mfma_f32_32x32x16_bf16 v[176:191], v[68:71], v[236:239], v[176:191]
    ds_read_b64_tr_b16 v[232:233], v7 offset:53248
    ds_read_b64_tr_b16 v[234:235], v7 offset:53760
    s_waitcnt lgkmcnt(8)
    v_mfma_f32_32x32x16_bf16 v[192:207], v[240:243], v[68:71], v[192:207]
    ds_read_b64_tr_b16 v[236:237], v6 offset:61440
    ds_read_b64_tr_b16 v[238:239], v6 offset:61952
    s_waitcnt lgkmcnt(7)
    v_mfma_f32_32x32x16_bf16 v[208:223], v[224:227], v[68:71], v[208:223]
    ds_read_b64_tr_b16 v[240:241], v7 offset:61440
    ds_read_b64_tr_b16 v[242:243], v7 offset:61952
    s_waitcnt lgkmcnt(6)
    v_mfma_f32_32x32x16_bf16 v[160:175], v[72:75], v[228:231], v[160:175]
    ds_read_b64_tr_b16 v[224:225], v6 offset:55296
    ds_read_b64_tr_b16 v[226:227], v6 offset:55808
    s_add_u32 m0, s49, 72832
    s_nop 0
    buffer_load_dwordx4 v2, s[8:11], 0 offen offset:896 lds
    s_waitcnt lgkmcnt(6)
    v_mfma_f32_32x32x16_bf16 v[176:191], v[72:75], v[232:235], v[176:191]
    ds_read_b64_tr_b16 v[228:229], v7 offset:55296
    ds_read_b64_tr_b16 v[230:231], v7 offset:55808
    s_add_u32 m0, s49, 97408
    s_nop 0
    buffer_load_dwordx4 v3, s[8:11], 0 offen offset:896 lds
    s_waitcnt lgkmcnt(6)
    v_mfma_f32_32x32x16_bf16 v[192:207], v[236:239], v[72:75], v[192:207]
    ds_read_b64_tr_b16 v[232:233], v6 offset:63488
    ds_read_b64_tr_b16 v[234:235], v6 offset:64000
    s_add_u32 m0, s49, 121984
    s_nop 0
    buffer_load_dwordx4 v2, s[8:11], s64 offen offset:896 lds
    s_waitcnt lgkmcnt(6)
    v_mfma_f32_32x32x16_bf16 v[208:223], v[240:243], v[72:75], v[208:223]
    ds_read_b64_tr_b16 v[236:237], v7 offset:63488
    ds_read_b64_tr_b16 v[238:239], v7 offset:64000
    s_add_u32 m0, s49, 146560
    s_nop 0
    buffer_load_dwordx4 v3, s[8:11], s64 offen offset:896 lds
    s_waitcnt lgkmcnt(6)
    v_mfma_f32_32x32x16_bf16 v[160:175], v[76:79], v[224:227], v[160:175]
    s_waitcnt vmcnt(20)
    s_barrier
    ds_read_b64_tr_b16 v[240:241], v6 offset:0
    ds_read_b64_tr_b16 v[242:243], v6 offset:512
    s_waitcnt lgkmcnt(6)
    v_mfma_f32_32x32x16_bf16 v[176:191], v[76:79], v[228:231], v[176:191]
    ds_read_b64_tr_b16 v[224:225], v7 offset:0
    ds_read_b64_tr_b16 v[226:227], v7 offset:512
    s_add_u32 m0, s49, 49152
    s_nop 0
    buffer_load_dwordx4 v5, s[12:15], s60 offen lds
    s_add_u32 s60, s60, 221184
    s_waitcnt lgkmcnt(6)
    v_mfma_f32_32x32x16_bf16 v[192:207], v[232:235], v[76:79], v[192:207]
    ds_read_b64_tr_b16 v[228:229], v6 offset:8192
    ds_read_b64_tr_b16 v[230:231], v6 offset:8704
    s_waitcnt lgkmcnt(6)
    v_mfma_f32_32x32x16_bf16 v[208:223], v[236:239], v[76:79], v[208:223]
    ds_read_b64_tr_b16 v[232:233], v7 offset:8192
    ds_read_b64_tr_b16 v[234:235], v7 offset:8704
    s_add_u32 m0, s49, 57344
    s_nop 0
    buffer_load_dwordx4 v4, s[16:19], s61 offen lds
    s_add_u32 s61, s61, 589824
    s_waitcnt lgkmcnt(6)
    v_mfma_f32_32x32x16_bf16 v[160:175], v[80:83], v[240:243], v[160:175]
    ds_read_b64_tr_b16 v[236:237], v6 offset:2048
    ds_read_b64_tr_b16 v[238:239], v6 offset:2560
    s_waitcnt vmcnt(16)
    ds_read_b128 v[96:99], v8 offset:16384
    s_waitcnt lgkmcnt(7)
    v_mfma_f32_32x32x16_bf16 v[176:191], v[80:83], v[224:227], v[176:191]
    ds_read_b64_tr_b16 v[240:241], v7 offset:2048
    ds_read_b64_tr_b16 v[242:243], v7 offset:2560
    ds_read_b128 v[100:103], v9 offset:16384
    s_waitcnt lgkmcnt(8)
    v_mfma_f32_32x32x16_bf16 v[192:207], v[228:231], v[80:83], v[192:207]
    ds_read_b64_tr_b16 v[224:225], v6 offset:10240
    ds_read_b64_tr_b16 v[226:227], v6 offset:10752
    ds_read_b128 v[104:107], v10 offset:16384
    s_waitcnt lgkmcnt(9)
    v_mfma_f32_32x32x16_bf16 v[208:223], v[232:235], v[80:83], v[208:223]
    ds_read_b64_tr_b16 v[228:229], v7 offset:10240
    ds_read_b64_tr_b16 v[230:231], v7 offset:10752
    ds_read_b128 v[108:111], v11 offset:16384
    s_waitcnt lgkmcnt(10)
    v_mfma_f32_32x32x16_bf16 v[160:175], v[84:87], v[236:239], v[160:175]
    ds_read_b64_tr_b16 v[232:233], v6 offset:4096
    ds_read_b64_tr_b16 v[234:235], v6 offset:4608
    s_waitcnt lgkmcnt(9)
    v_mfma_f32_32x32x16_bf16 v[176:191], v[84:87], v[240:243], v[176:191]
    ds_read_b64_tr_b16 v[236:237], v7 offset:4096
    ds_read_b64_tr_b16 v[238:239], v7 offset:4608
    s_waitcnt lgkmcnt(8)
    v_mfma_f32_32x32x16_bf16 v[192:207], v[224:227], v[84:87], v[192:207]
    ds_read_b64_tr_b16 v[240:241], v6 offset:12288
    ds_read_b64_tr_b16 v[242:243], v6 offset:12800
    s_waitcnt lgkmcnt(7)
    v_mfma_f32_32x32x16_bf16 v[208:223], v[228:231], v[84:87], v[208:223]
    ds_read_b64_tr_b16 v[224:225], v7 offset:12288
    ds_read_b64_tr_b16 v[226:227], v7 offset:12800
    s_waitcnt lgkmcnt(6)
    v_mfma_f32_32x32x16_bf16 v[160:175], v[88:91], v[232:235], v[160:175]
    ds_read_b64_tr_b16 v[228:229], v6 offset:6144
    ds_read_b64_tr_b16 v[230:231], v6 offset:6656
    s_add_u32 m0, s49, 80896
    s_nop 0
    buffer_load_dwordx4 v2, s[8:11], 0 offen offset:1024 lds
    s_waitcnt lgkmcnt(6)
    v_mfma_f32_32x32x16_bf16 v[176:191], v[88:91], v[236:239], v[176:191]
    ds_read_b64_tr_b16 v[232:233], v7 offset:6144
    ds_read_b64_tr_b16 v[234:235], v7 offset:6656
    s_add_u32 m0, s49, 105472
    s_nop 0
    buffer_load_dwordx4 v3, s[8:11], 0 offen offset:1024 lds
    s_waitcnt lgkmcnt(6)
    v_mfma_f32_32x32x16_bf16 v[192:207], v[240:243], v[88:91], v[192:207]
    ds_read_b64_tr_b16 v[236:237], v6 offset:14336
    ds_read_b64_tr_b16 v[238:239], v6 offset:14848
    s_add_u32 m0, s49, 130048
    s_nop 0
    buffer_load_dwordx4 v2, s[8:11], s64 offen offset:1024 lds
    s_waitcnt lgkmcnt(6)
    v_mfma_f32_32x32x16_bf16 v[208:223], v[224:227], v[88:91], v[208:223]
    ds_read_b64_tr_b16 v[240:241], v7 offset:14336
    ds_read_b64_tr_b16 v[242:243], v7 offset:14848
    s_add_u32 m0, s49, 154624
    s_nop 0
    buffer_load_dwordx4 v3, s[8:11], s64 offen offset:1024 lds
    s_waitcnt lgkmcnt(6)
    v_mfma_f32_32x32x16_bf16 v[160:175], v[92:95], v[228:231], v[160:175]
    s_waitcnt vmcnt(17)
    s_barrier
    ds_read_b64_tr_b16 v[224:225], v6 offset:16384
    ds_read_b64_tr_b16 v[226:227], v6 offset:16896
    s_add_u32 m0, s49, 0
    s_nop 0
    buffer_load_dwordx4 v5, s[12:15], s60 offen lds
    s_waitcnt lgkmcnt(6)
    v_mfma_f32_32x32x16_bf16 v[176:191], v[92:95], v[232:235], v[176:191]
    ds_read_b64_tr_b16 v[228:229], v7 offset:16384
    ds_read_b64_tr_b16 v[230:231], v7 offset:16896
    s_add_u32 m0, s49, 8192
    s_nop 0
    buffer_load_dwordx4 v4, s[16:19], s61 offen lds
    s_waitcnt vmcnt(15)
    ds_read_b128 v[112:115], v8 offset:0
    s_waitcnt lgkmcnt(7)
    v_mfma_f32_32x32x16_bf16 v[192:207], v[236:239], v[92:95], v[192:207]
    ds_read_b64_tr_b16 v[232:233], v6 offset:18432
    ds_read_b64_tr_b16 v[234:235], v6 offset:18944
    ds_read_b128 v[116:119], v9 offset:0
    s_waitcnt lgkmcnt(8)
    v_mfma_f32_32x32x16_bf16 v[208:223], v[240:243], v[92:95], v[208:223]
    ds_read_b64_tr_b16 v[236:237], v7 offset:18432
    ds_read_b64_tr_b16 v[238:239], v7 offset:18944
    ds_read_b128 v[120:123], v10 offset:0
    s_waitcnt lgkmcnt(9)
    v_mfma_f32_32x32x16_bf16 v[160:175], v[96:99], v[224:227], v[160:175]
    ds_read_b64_tr_b16 v[240:241], v6 offset:20480
    ds_read_b64_tr_b16 v[242:243], v6 offset:20992
    ds_read_b128 v[124:127], v11 offset:0
    s_waitcnt lgkmcnt(10)
    v_mfma_f32_32x32x16_bf16 v[176:191], v[96:99], v[228:231], v[176:191]
    ds_read_b64_tr_b16 v[224:225], v7 offset:20480
    ds_read_b64_tr_b16 v[226:227], v7 offset:20992
    s_waitcnt lgkmcnt(9)
    v_mfma_f32_32x32x16_bf16 v[160:175], v[100:103], v[232:235], v[160:175]
    ds_read_b64_tr_b16 v[228:229], v6 offset:22528
    ds_read_b64_tr_b16 v[230:231], v6 offset:23040
    s_waitcnt lgkmcnt(4)
    s_add_u32 m0, s49, 90112
    s_nop 0
    buffer_load_dwordx4 v4, s[16:19], s62 offen lds
    s_add_u32 s62, s62, 589824
    v_mfma_f32_32x32x16_bf16 v[176:191], v[100:103], v[236:239], v[176:191]
    ds_read_b64_tr_b16 v[232:233], v7 offset:22528
    ds_read_b64_tr_b16 v[234:235], v7 offset:23040
    s_add_u32 m0, s49, 114688
    s_nop 0
    buffer_load_dwordx4 v4, s[16:19], s62 offen lds
    s_add_u32 s62, s62, 589824
    s_add_u32 m0, s49, 139264
    s_nop 0
    buffer_load_dwordx4 v4, s[16:19], s62 offen lds
    s_add_u32 s62, s62, 589824
    v_mfma_f32_32x32x16_bf16 v[160:175], v[104:107], v[240:243], v[160:175]
    s_waitcnt vmcnt(9)
    s_barrier
    ds_read_b64_tr_b16 v[236:237], v6 offset:32768
    ds_read_b64_tr_b16 v[238:239], v6 offset:33280
    s_waitcnt lgkmcnt(6)
    v_mfma_f32_32x32x16_bf16 v[176:191], v[104:107], v[224:227], v[176:191]
    ds_read_b64_tr_b16 v[240:241], v7 offset:32768
    ds_read_b64_tr_b16 v[242:243], v7 offset:33280
    ds_read_b128 v[128:131], v8 offset:8192
    s_waitcnt lgkmcnt(7)
    v_mfma_f32_32x32x16_bf16 v[160:175], v[108:111], v[228:231], v[160:175]
    ds_read_b64_tr_b16 v[224:225], v6 offset:34816
    ds_read_b64_tr_b16 v[226:227], v6 offset:35328
    ds_read_b128 v[132:135], v9 offset:8192
    s_waitcnt lgkmcnt(8)
    v_mfma_f32_32x32x16_bf16 v[176:191], v[108:111], v[232:235], v[176:191]
    ds_read_b64_tr_b16 v[228:229], v7 offset:34816
    ds_read_b64_tr_b16 v[230:231], v7 offset:35328
    ds_read_b128 v[136:139], v10 offset:8192
    s_waitcnt lgkmcnt(9)
    v_mfma_f32_32x32x16_bf16 v[160:175], v[112:115], v[236:239], v[160:175]
    ds_read_b64_tr_b16 v[232:233], v6 offset:36864
    ds_read_b64_tr_b16 v[234:235], v6 offset:37376
    ds_read_b128 v[140:143], v11 offset:8192
    s_waitcnt lgkmcnt(10)
    v_mfma_f32_32x32x16_bf16 v[176:191], v[112:115], v[240:243], v[176:191]
    ds_read_b64_tr_b16 v[236:237], v7 offset:36864
    ds_read_b64_tr_b16 v[238:239], v7 offset:37376
    s_waitcnt lgkmcnt(9)
    v_mfma_f32_32x32x16_bf16 v[160:175], v[116:119], v[224:227], v[160:175]
    ds_read_b64_tr_b16 v[240:241], v6 offset:38912
    ds_read_b64_tr_b16 v[242:243], v6 offset:39424
    s_waitcnt lgkmcnt(4)
    s_add_u32 m0, s49, 98304
    s_nop 0
    buffer_load_dwordx4 v4, s[16:19], s62 offen lds
    s_add_u32 s62, s62, 589824
    v_mfma_f32_32x32x16_bf16 v[176:191], v[116:119], v[228:231], v[176:191]
    ds_read_b64_tr_b16 v[224:225], v7 offset:38912
    ds_read_b64_tr_b16 v[226:227], v7 offset:39424
    s_add_u32 m0, s49, 122880
    s_nop 0
    buffer_load_dwordx4 v4, s[16:19], s62 offen lds
    s_add_u32 s62, s62, 589824
    s_add_u32 m0, s49, 147456
    s_nop 0
    buffer_load_dwordx4 v4, s[16:19], s62 offen lds
    s_add_u32 s62, s62, 589824
    v_mfma_f32_32x32x16_bf16 v[160:175], v[120:123], v[232:235], v[160:175]
    ds_read_b64_tr_b16 v[228:229], v6 offset:49152
    ds_read_b64_tr_b16 v[230:231], v6 offset:49664
    s_waitcnt lgkmcnt(6)
    v_mfma_f32_32x32x16_bf16 v[176:191], v[120:123], v[236:239], v[176:191]
    ds_read_b64_tr_b16 v[232:233], v7 offset:49152
    ds_read_b64_tr_b16 v[234:235], v7 offset:49664
    s_waitcnt vmcnt(8)
    ds_read_b128 v[144:147], v8 offset:16384
    s_waitcnt lgkmcnt(7)
    v_mfma_f32_32x32x16_bf16 v[160:175], v[124:127], v[240:243], v[160:175]
    ds_read_b64_tr_b16 v[236:237], v6 offset:51200
    ds_read_b64_tr_b16 v[238:239], v6 offset:51712
    ds_read_b128 v[148:151], v9 offset:16384
    s_waitcnt lgkmcnt(8)
    v_mfma_f32_32x32x16_bf16 v[176:191], v[124:127], v[224:227], v[176:191]
    ds_read_b64_tr_b16 v[240:241], v7 offset:51200
    ds_read_b64_tr_b16 v[242:243], v7 offset:51712
    ds_read_b128 v[152:155], v10 offset:16384
    s_waitcnt lgkmcnt(9)
    v_mfma_f32_32x32x16_bf16 v[160:175], v[128:131], v[228:231], v[160:175]
    ds_read_b64_tr_b16 v[224:225], v6 offset:53248
    ds_read_b64_tr_b16 v[226:227], v6 offset:53760
    ds_read_b128 v[156:159], v11 offset:16384
    s_waitcnt lgkmcnt(10)
    v_mfma_f32_32x32x16_bf16 v[176:191], v[128:131], v[232:235], v[176:191]
    ds_read_b64_tr_b16 v[228:229], v7 offset:53248
    ds_read_b64_tr_b16 v[230:231], v7 offset:53760
    s_waitcnt lgkmcnt(9)
    v_mfma_f32_32x32x16_bf16 v[160:175], v[132:135], v[236:239], v[160:175]
    ds_read_b64_tr_b16 v[232:233], v6 offset:55296
    ds_read_b64_tr_b16 v[234:235], v6 offset:55808
    s_waitcnt lgkmcnt(4)
    s_add_u32 m0, s49, 106496
    s_nop 0
    buffer_load_dwordx4 v4, s[16:19], s62 offen lds
    s_add_u32 s62, s62, 589824
    v_mfma_f32_32x32x16_bf16 v[176:191], v[132:135], v[240:243], v[176:191]
    ds_read_b64_tr_b16 v[236:237], v7 offset:55296
    ds_read_b64_tr_b16 v[238:239], v7 offset:55808
    s_add_u32 m0, s49, 131072
    s_nop 0
    buffer_load_dwordx4 v4, s[16:19], s62 offen lds
    s_add_u32 s62, s62, 589824
    s_add_u32 m0, s49, 155648
    s_nop 0
    buffer_load_dwordx4 v4, s[16:19], s62 offen lds
    v_mfma_f32_32x32x16_bf16 v[160:175], v[136:139], v[224:227], v[160:175]
    s_waitcnt vmcnt(9)
    s_barrier
    ds_read_b64_tr_b16 v[240:241], v6 offset:0
    ds_read_b64_tr_b16 v[242:243], v6 offset:512
    s_waitcnt lgkmcnt(6)
    v_mfma_f32_32x32x16_bf16 v[176:191], v[136:139], v[228:231], v[176:191]
    ds_read_b64_tr_b16 v[224:225], v6 offset:2048
    ds_read_b64_tr_b16 v[226:227], v6 offset:2560
    s_waitcnt lgkmcnt(6)
    v_mfma_f32_32x32x16_bf16 v[160:175], v[140:143], v[232:235], v[160:175]
    ds_read_b64_tr_b16 v[228:229], v6 offset:4096
    ds_read_b64_tr_b16 v[230:231], v6 offset:4608
    s_waitcnt lgkmcnt(6)
    v_mfma_f32_32x32x16_bf16 v[176:191], v[140:143], v[236:239], v[176:191]
    ds_read_b64_tr_b16 v[232:233], v6 offset:6144
    ds_read_b64_tr_b16 v[234:235], v6 offset:6656
    s_waitcnt lgkmcnt(6)
    v_mfma_f32_32x32x16_bf16 v[160:175], v[144:147], v[240:243], v[160:175]
    ds_read_b64_tr_b16 v[236:237], v7 offset:0
    ds_read_b64_tr_b16 v[238:239], v7 offset:512
    s_waitcnt lgkmcnt(6)
    v_mfma_f32_32x32x16_bf16 v[160:175], v[148:151], v[224:227], v[160:175]
    ds_read_b64_tr_b16 v[240:241], v7 offset:2048
    ds_read_b64_tr_b16 v[242:243], v7 offset:2560
    s_waitcnt lgkmcnt(6)
    v_mfma_f32_32x32x16_bf16 v[160:175], v[152:155], v[228:231], v[160:175]
    ds_read_b64_tr_b16 v[224:225], v7 offset:4096
    ds_read_b64_tr_b16 v[226:227], v7 offset:4608
    s_waitcnt lgkmcnt(6)
    v_mfma_f32_32x32x16_bf16 v[160:175], v[156:159], v[232:235], v[160:175]
    ds_read_b64_tr_b16 v[228:229], v7 offset:6144
    ds_read_b64_tr_b16 v[230:231], v7 offset:6656
    s_waitcnt lgkmcnt(6)
    v_mfma_f32_32x32x16_bf16 v[176:191], v[144:147], v[236:239], v[176:191]
    ds_read_b64_tr_b16 v[232:233], v6 offset:24576
    ds_read_b64_tr_b16 v[234:235], v6 offset:25088
    s_waitcnt lgkmcnt(6)
    v_mfma_f32_32x32x16_bf16 v[176:191], v[148:151], v[240:243], v[176:191]
    ds_read_b64_tr_b16 v[236:237], v6 offset:26624
    ds_read_b64_tr_b16 v[238:239], v6 offset:27136
    s_waitcnt lgkmcnt(6)
    v_mfma_f32_32x32x16_bf16 v[176:191], v[152:155], v[224:227], v[176:191]
    v_cvt_pk_bf16_f32 v160, v160, v161
    v_cvt_pk_bf16_f32 v161, v162, v163
    v_cvt_pk_bf16_f32 v162, v164, v165
    v_cvt_pk_bf16_f32 v163, v166, v167
    v_cvt_pk_bf16_f32 v164, v168, v169
    v_cvt_pk_bf16_f32 v165, v170, v171
    ds_read_b64_tr_b16 v[240:241], v6 offset:28672
    ds_read_b64_tr_b16 v[242:243], v6 offset:29184
    v_lshlrev_b32 v2, 7, v0
    s_mov_b64 exec, 0x3ff
    buffer_load_dword v3, v2, s[24:27], s6 offen
    s_add_u32 s6, s6, 327680
    s_mov_b64 exec, -1
    s_waitcnt lgkmcnt(6)
    v_mfma_f32_32x32x16_bf16 v[176:191], v[156:159], v[228:231], v[176:191]
    v_cvt_pk_bf16_f32 v166, v172, v173
    v_cvt_pk_bf16_f32 v167, v174, v175
    buffer_store_dwordx4 v[160:163], v13, s[20:23], s69 offen offset:0 sc1
    buffer_store_dwordx4 v[164:167], v13, s[20:23], s70 offen offset:0 sc1
    ds_read_b64_tr_b16 v[224:225], v6 offset:30720
    ds_read_b64_tr_b16 v[226:227], v6 offset:31232
    s_waitcnt lgkmcnt(6)
    v_mfma_f32_32x32x16_bf16 v[192:207], v[232:235], v[96:99], v[192:207]
    ds_read_b64_tr_b16 v[228:229], v6 offset:40960
    ds_read_b64_tr_b16 v[230:231], v6 offset:41472
    s_waitcnt lgkmcnt(6)
    v_mfma_f32_32x32x16_bf16 v[192:207], v[236:239], v[100:103], v[192:207]
    ds_read_b64_tr_b16 v[232:233], v6 offset:43008
    ds_read_b64_tr_b16 v[234:235], v6 offset:43520
    s_waitcnt lgkmcnt(6)
    v_mfma_f32_32x32x16_bf16 v[192:207], v[240:243], v[104:107], v[192:207]
    v_cvt_pk_bf16_f32 v176, v176, v177
    v_cvt_pk_bf16_f32 v177, v178, v179
    v_cvt_pk_bf16_f32 v178, v180, v181
    v_cvt_pk_bf16_f32 v179, v182, v183
    v_cvt_pk_bf16_f32 v180, v184, v185
    v_cvt_pk_bf16_f32 v181, v186, v187
    ds_read_b64_tr_b16 v[236:237], v6 offset:45056
    ds_read_b64_tr_b16 v[238:239], v6 offset:45568
    s_waitcnt lgkmcnt(6)
    v_mfma_f32_32x32x16_bf16 v[192:207], v[224:227], v[108:111], v[192:207]
    v_cvt_pk_bf16_f32 v182, v188, v189
    v_cvt_pk_bf16_f32 v183, v190, v191
    buffer_store_dwordx4 v[176:179], v13, s[20:23], s69 offen offset:1024 sc1
    buffer_store_dwordx4 v[180:183], v13, s[20:23], s70 offen offset:1024 sc1
    s_lshl_b32 s52, s44, 3
    s_lshl_b32 s53, s46, 1
    s_add_u32 s53, s53, s52
    s_sub_u32 s76, s53, 8
    s_cmp_lt_u32 s53, 8
    s_cselect_b32 s76, s53, s76
    s_cselect_b32 s78, 0xf149f149, 0
    s_mul_i32 s79, s45, 18
    v_bfe_u32 v1, v0, 1, 1
    v_add_u32 v1, 1, v1
    v_mul_u32_u24 v1, 576, v1
    ds_read_b64_tr_b16 v[240:241], v6 offset:47104
    ds_read_b64_tr_b16 v[242:243], v6 offset:47616
    s_waitcnt lgkmcnt(6)
    v_mfma_f32_32x32x16_bf16 v[192:207], v[228:231], v[112:115], v[192:207]
    v_bfe_u32 v253, v0, 3, 1
    v_add_u32 v253, s76, v253
    s_add_u32 s80, s52, s46
    v_mov_b32 v252, s80
    v_and_b32 v13, 4, v0
    v_cmp_eq_u32 vcc, 0, v13
    s_nop 1
    v_cndmask_b32 v1, 0, v1, vcc
    v_cndmask_b32 v253, v252, v253, vcc
    ds_read_b64_tr_b16 v[224:225], v6 offset:57344
    ds_read_b64_tr_b16 v[226:227], v6 offset:57856
    s_waitcnt lgkmcnt(6)
    v_mfma_f32_32x32x16_bf16 v[192:207], v[232:235], v[116:119], v[192:207]
    v_and_b32 v252, 1, v0
    v_mul_u32_u24 v252, 17, v252
    v_add3_u32 v1, v1, v252, s79
    v_lshrrev_b32 v1, 6, v1
    v_lshl_add_u32 v1, v253, 5, v1
    v_lshlrev_b32 v252, 2, v1
    s_lshl_b32 s81, s80, 8
    s_add_u32 s81, s81, 29360128
    s_mul_i32 s76, s76, 110592
    s_mul_i32 s53, s45, 576
    s_add_u32 s76, s76, s53
    s_add_u32 s76, s76, 18432
    s_add_u32 s52, s52, s46
    s_mul_i32 s77, s52, 110592
    s_add_u32 s77, s77, s53
    s_mul_i32 s82, s46, 1280
    s_lshl_b32 s83, s82, 1
    v_lshlrev_b32 v12, 4, v0
    ds_read_b64_tr_b16 v[228:229], v6 offset:59392
    ds_read_b64_tr_b16 v[230:231], v6 offset:59904
    s_waitcnt lgkmcnt(6)
    v_mfma_f32_32x32x16_bf16 v[192:207], v[236:239], v[120:123], v[192:207]
    v_bfe_u32 v1, v0, 4, 1
    v_xor_b32 v1, v1, v0
    v_lshlrev_b32 v13, 4, v1
    v_bfe_u32 v1, v0, 2, 2
    v_mul_u32_u24 v5, 640, v1
    v_and_b32 v1, 3, v0
    ds_read_b64_tr_b16 v[232:233], v6 offset:61440
    ds_read_b64_tr_b16 v[234:235], v6 offset:61952
    s_waitcnt lgkmcnt(6)
    v_mfma_f32_32x32x16_bf16 v[192:207], v[240:243], v[124:127], v[192:207]
    v_lshl_add_u32 v5, v1, 4, v5
    v_lshrrev_b32 v1, 4, v0
    v_mul_u32_u24 v1, 20480, v1
    v_add3_u32 v5, v5, v1, s82
    v_mov_b32 v1, s82
    v_cmp_gt_u32 vcc, 32, v0
    s_nop 1
    v_cndmask_b32 v1, 0, v1, vcc
    ds_read_b64_tr_b16 v[236:237], v6 offset:63488
    ds_read_b64_tr_b16 v[238:239], v6 offset:64000
    s_waitcnt lgkmcnt(6)
    v_mfma_f32_32x32x16_bf16 v[192:207], v[224:227], v[128:131], v[192:207]
    v_add_u32 v5, v5, v1
    v_mov_b32 v8, 0x3f803f80
    v_mov_b32 v1, s78
    v_cmp_gt_u32 vcc, 16, v0
    s_nop 1
    v_cndmask_b32 v8, v8, v1, vcc
    v_and_b32 v1, 0x32, v0
    v_cmp_eq_u32 vcc, 0x02, v1
    ds_read_b64_tr_b16 v[240:241], v6 offset:8192
    ds_read_b64_tr_b16 v[242:243], v6 offset:8704
    v_lshlrev_b32 v2, 7, v0
    s_mov_b64 exec, 0x3ff
    buffer_load_dword v3, v2, s[24:27], s6 offen
    s_add_u32 s6, s6, s5
    s_mov_b64 exec, -1
    s_waitcnt lgkmcnt(6)
    v_mfma_f32_32x32x16_bf16 v[192:207], v[228:231], v[132:135], v[192:207]
    v_cndmask_b32 v8, v8, 0, vcc
    v_cmp_eq_u32 vcc, 0x22, v1
    s_nop 1
    v_cndmask_b32 v8, v8, 0, vcc
    v_mov_b32 v9, v8
    v_mov_b32 v10, v8
    v_mov_b32 v11, v8
    ds_read_b64_tr_b16 v[224:225], v6 offset:10240
    ds_read_b64_tr_b16 v[226:227], v6 offset:10752
    s_waitcnt lgkmcnt(6)
    v_mfma_f32_32x32x16_bf16 v[192:207], v[232:235], v[136:139], v[192:207]
    ds_read_b64_tr_b16 v[228:229], v6 offset:12288
    ds_read_b64_tr_b16 v[230:231], v6 offset:12800
    s_waitcnt lgkmcnt(6)
    v_mfma_f32_32x32x16_bf16 v[192:207], v[236:239], v[140:143], v[192:207]
    ds_read_b64_tr_b16 v[232:233], v6 offset:14336
    ds_read_b64_tr_b16 v[234:235], v6 offset:14848
    s_waitcnt lgkmcnt(6)
    v_mfma_f32_32x32x16_bf16 v[192:207], v[240:243], v[144:147], v[192:207]
    ds_read_b64_tr_b16 v[236:237], v7 offset:24576
    ds_read_b64_tr_b16 v[238:239], v7 offset:25088
    s_waitcnt lgkmcnt(6)
    v_mfma_f32_32x32x16_bf16 v[192:207], v[224:227], v[148:151], v[192:207]
    ds_read_b64_tr_b16 v[240:241], v7 offset:26624
    ds_read_b64_tr_b16 v[242:243], v7 offset:27136
    s_waitcnt lgkmcnt(6)
    v_mfma_f32_32x32x16_bf16 v[192:207], v[228:231], v[152:155], v[192:207]
    ds_read_b64_tr_b16 v[224:225], v7 offset:28672
    ds_read_b64_tr_b16 v[226:227], v7 offset:29184
    s_waitcnt lgkmcnt(6)
    v_mfma_f32_32x32x16_bf16 v[192:207], v[232:235], v[156:159], v[192:207]
    ds_read_b64_tr_b16 v[228:229], v7 offset:30720
    ds_read_b64_tr_b16 v[230:231], v7 offset:31232
    s_waitcnt lgkmcnt(6)
    v_mfma_f32_32x32x16_bf16 v[208:223], v[236:239], v[96:99], v[208:223]
    ds_read_b64_tr_b16 v[232:233], v7 offset:40960
    ds_read_b64_tr_b16 v[234:235], v7 offset:41472
    s_waitcnt lgkmcnt(6)
    v_mfma_f32_32x32x16_bf16 v[208:223], v[240:243], v[100:103], v[208:223]
    ds_read_b64_tr_b16 v[236:237], v7 offset:43008
    ds_read_b64_tr_b16 v[238:239], v7 offset:43520
    s_waitcnt lgkmcnt(6)
    v_mfma_f32_32x32x16_bf16 v[208:223], v[224:227], v[104:107], v[208:223]
    v_pk_mul_f32 v[244:245], v[192:193], s[50:51] op_sel:[0,1] op_sel_hi:[1,1]
    v_pk_mul_f32 v[246:247], v[194:195], s[50:51] op_sel:[0,1] op_sel_hi:[1,1]
    v_pk_mul_f32 v[248:249], v[196:197], s[50:51] op_sel:[0,1] op_sel_hi:[1,1]
    v_pk_mul_f32 v[250:251], v[198:199], s[50:51] op_sel:[0,1] op_sel_hi:[1,1]
    ds_read_b64_tr_b16 v[240:241], v7 offset:45056
    ds_read_b64_tr_b16 v[242:243], v7 offset:45568
    v_lshlrev_b32 v2, 7, v0
    s_mov_b64 exec, 0x3ff
    buffer_load_dword v3, v2, s[24:27], s6 offen
    s_add_u32 s6, s6, 327680
    s_mov_b64 exec, -1
    s_waitcnt lgkmcnt(6)
    v_mfma_f32_32x32x16_bf16 v[208:223], v[228:231], v[108:111], v[208:223]
    v_exp_f32 v244, v244
    v_exp_f32 v245, v245
    ds_read_b64_tr_b16 v[224:225], v7 offset:47104
    ds_read_b64_tr_b16 v[226:227], v7 offset:47616
    s_waitcnt lgkmcnt(6)
    v_mfma_f32_32x32x16_bf16 v[208:223], v[232:235], v[112:115], v[208:223]
    v_exp_f32 v246, v246
    v_exp_f32 v247, v247
    ds_read_b64_tr_b16 v[228:229], v7 offset:57344
    ds_read_b64_tr_b16 v[230:231], v7 offset:57856
    s_waitcnt vmcnt(2)
    v_mov_b32 v254, s50
    s_mov_b64 exec, 1
    buffer_store_dword v254, off, s[20:23], s3 offset:0 sc1
    s_mov_b64 exec, -1
    s_waitcnt lgkmcnt(6)
    v_mfma_f32_32x32x16_bf16 v[208:223], v[236:239], v[116:119], v[208:223]
    v_exp_f32 v248, v248
    ds_read_b64_tr_b16 v[232:233], v7 offset:59392
    ds_read_b64_tr_b16 v[234:235], v7 offset:59904
    s_waitcnt lgkmcnt(6)
    v_mfma_f32_32x32x16_bf16 v[208:223], v[240:243], v[120:123], v[208:223]
    v_exp_f32 v249, v249
    v_exp_f32 v250, v250
    ds_read_b64_tr_b16 v[236:237], v7 offset:61440
    ds_read_b64_tr_b16 v[238:239], v7 offset:61952
    s_waitcnt lgkmcnt(6)
    v_mfma_f32_32x32x16_bf16 v[208:223], v[224:227], v[124:127], v[208:223]
    v_exp_f32 v251, v251
    v_pk_add_f32 v[244:245], v[244:245], 1.0 op_sel_hi:[1,0]
    v_pk_add_f32 v[246:247], v[246:247], 1.0 op_sel_hi:[1,0]
    v_pk_add_f32 v[248:249], v[248:249], 1.0 op_sel_hi:[1,0]
    v_pk_add_f32 v[250:251], v[250:251], 1.0 op_sel_hi:[1,0]
    ds_read_b64_tr_b16 v[240:241], v7 offset:63488
    ds_read_b64_tr_b16 v[242:243], v7 offset:64000
    s_waitcnt lgkmcnt(6)
    v_mfma_f32_32x32x16_bf16 v[208:223], v[228:231], v[128:131], v[208:223]
    v_rcp_f32 v244, v244
    ds_read_b64_tr_b16 v[224:225], v7 offset:8192
    ds_read_b64_tr_b16 v[226:227], v7 offset:8704
    s_waitcnt lgkmcnt(6)
    v_mfma_f32_32x32x16_bf16 v[208:223], v[232:235], v[132:135], v[208:223]
    v_rcp_f32 v245, v245
    v_rcp_f32 v246, v246
    ds_read_b64_tr_b16 v[228:229], v7 offset:10240
    ds_read_b64_tr_b16 v[230:231], v7 offset:10752
    s_waitcnt lgkmcnt(6)
    v_mfma_f32_32x32x16_bf16 v[208:223], v[236:239], v[136:139], v[208:223]
    v_rcp_f32 v247, v247
    v_rcp_f32 v248, v248
    ds_read_b64_tr_b16 v[232:233], v7 offset:12288
    ds_read_b64_tr_b16 v[234:235], v7 offset:12800
    s_waitcnt lgkmcnt(6)
    v_mfma_f32_32x32x16_bf16 v[208:223], v[240:243], v[140:143], v[208:223]
    v_rcp_f32 v249, v249
    ds_read_b64_tr_b16 v[236:237], v7 offset:14336
    ds_read_b64_tr_b16 v[238:239], v7 offset:14848
    s_waitcnt lgkmcnt(6)
    v_mfma_f32_32x32x16_bf16 v[208:223], v[224:227], v[144:147], v[208:223]
    v_rcp_f32 v250, v250
    v_rcp_f32 v251, v251
    v_pk_mul_f32 v[192:193], v[192:193], v[244:245]
    v_pk_mul_f32 v[194:195], v[194:195], v[246:247]
    s_barrier
    v_add_u32 v6, 90112, v6
    ds_read_b64_tr_b16 v[240:241], v6 offset:0
    ds_read_b64_tr_b16 v[242:243], v6 offset:512
    v_lshlrev_b32 v2, 7, v0
    s_mov_b64 exec, 0x3ff
    buffer_load_dword v3, v2, s[24:27], s6 offen
    s_add_u32 s6, s6, 327680
    s_mov_b64 exec, -1
    s_waitcnt lgkmcnt(6)
    v_mfma_f32_32x32x16_bf16 v[208:223], v[228:231], v[148:151], v[208:223]
    v_pk_mul_f32 v[196:197], v[196:197], v[248:249]
    v_pk_mul_f32 v[198:199], v[198:199], v[250:251]
    v_cvt_pk_bf16_f32 v192, v192, v193
    v_cvt_pk_bf16_f32 v193, v194, v195
    v_cvt_pk_bf16_f32 v194, v196, v197
    v_cvt_pk_bf16_f32 v195, v198, v199
    buffer_store_dwordx4 v[192:195], v12, s[20:23], s66 offen offset:0 sc1
    ds_read_b64_tr_b16 v[224:225], v6 offset:2048
    ds_read_b64_tr_b16 v[226:227], v6 offset:2560
    s_cmp_ge_u32 s73, 12
    s_cbranch_scc1 L_noex_7
    s_add_u32 m0, s49, 53248
    s_nop 0
    buffer_load_dwordx4 v15, s[16:19], s63 offen lds
    s_add_u32 s63, s63, 1179648
L_noex_7:
    s_waitcnt lgkmcnt(6)
    v_mfma_f32_32x32x16_bf16 v[208:223], v[232:235], v[152:155], v[208:223]
    v_pk_mul_f32 v[244:245], v[200:201], s[50:51] op_sel:[0,1] op_sel_hi:[1,1]
    v_pk_mul_f32 v[246:247], v[202:203], s[50:51] op_sel:[0,1] op_sel_hi:[1,1]
    v_pk_mul_f32 v[248:249], v[204:205], s[50:51] op_sel:[0,1] op_sel_hi:[1,1]
    v_pk_mul_f32 v[250:251], v[206:207], s[50:51] op_sel:[0,1] op_sel_hi:[1,1]
    ds_read_b64_tr_b16 v[228:229], v6 offset:4096
    ds_read_b64_tr_b16 v[230:231], v6 offset:4608
    s_waitcnt lgkmcnt(6)
    v_mfma_f32_32x32x16_bf16 v[208:223], v[236:239], v[156:159], v[208:223]
    v_exp_f32 v244, v244
    v_exp_f32 v245, v245
    ds_read_b64_tr_b16 v[232:233], v6 offset:6144
    ds_read_b64_tr_b16 v[234:235], v6 offset:6656
    s_waitcnt lgkmcnt(6)
    v_mfma_f32_32x32x16_bf16 v[160:175], v[240:243], v[16:19], 0
    v_exp_f32 v246, v246
    v_exp_f32 v247, v247
    ds_read_b64_tr_b16 v[236:237], v6 offset:24576
    ds_read_b64_tr_b16 v[238:239], v6 offset:25088
    s_cmp_ge_u32 s73, 12
    s_cbranch_scc1 L_noex_8
    s_add_u32 m0, s49, 61440
    s_nop 0
    buffer_load_dwordx4 v15, s[16:19], s63 offen lds
    s_add_u32 s63, s63, 1179648
L_noex_8:
    s_waitcnt lgkmcnt(6)
    v_mfma_f32_32x32x16_bf16 v[160:175], v[224:227], v[20:23], v[160:175]
    v_exp_f32 v248, v248
    ds_read_b64_tr_b16 v[240:241], v6 offset:26624
    ds_read_b64_tr_b16 v[242:243], v6 offset:27136
    s_mov_b32 exec_hi, 0xff
    ds_write_b128 v5, v[8:11] offset:576
    s_mov_b32 exec_hi, -1
    s_waitcnt lgkmcnt(7)
    v_mfma_f32_32x32x16_bf16 v[160:175], v[228:231], v[24:27], v[160:175]
    v_exp_f32 v249, v249
    v_exp_f32 v250, v250
    ds_read_b64_tr_b16 v[224:225], v6 offset:28672
    ds_read_b64_tr_b16 v[226:227], v6 offset:29184
    s_waitcnt lgkmcnt(7)
    v_mfma_f32_32x32x16_bf16 v[160:175], v[232:235], v[28:31], v[160:175]
    v_exp_f32 v251, v251
    v_pk_add_f32 v[244:245], v[244:245], 1.0 op_sel_hi:[1,0]
    v_pk_add_f32 v[246:247], v[246:247], 1.0 op_sel_hi:[1,0]
    v_pk_add_f32 v[248:249], v[248:249], 1.0 op_sel_hi:[1,0]
    v_pk_add_f32 v[250:251], v[250:251], 1.0 op_sel_hi:[1,0]
    ds_read_b64_tr_b16 v[228:229], v6 offset:30720
    ds_read_b64_tr_b16 v[230:231], v6 offset:31232
    s_cmp_ge_u32 s73, 12
    s_cbranch_scc1 L_noex_9
    s_add_u32 m0, s49, 69632
    s_nop 0
    buffer_load_dwordx4 v15, s[16:19], s63 offen lds
    s_add_u32 s63, s63, 1179648
L_noex_9:
    s_waitcnt lgkmcnt(7)
    v_mfma_f32_32x32x16_bf16 v[160:175], v[236:239], v[32:35], v[160:175]
    v_rcp_f32 v244, v244
    ds_read_b64_tr_b16 v[232:233], v6 offset:49152
    ds_read_b64_tr_b16 v[234:235], v6 offset:49664
    s_waitcnt lgkmcnt(7)
    v_mfma_f32_32x32x16_bf16 v[160:175], v[240:243], v[36:39], v[160:175]
    v_rcp_f32 v245, v245
    v_rcp_f32 v246, v246
    ds_read_b64_tr_b16 v[236:237], v6 offset:51200
    ds_read_b64_tr_b16 v[238:239], v6 offset:51712
    s_waitcnt lgkmcnt(6)
    v_mfma_f32_32x32x16_bf16 v[160:175], v[224:227], v[40:43], v[160:175]
    v_rcp_f32 v247, v247
    v_rcp_f32 v248, v248
    ds_read_b64_tr_b16 v[240:241], v6 offset:53248
    ds_read_b64_tr_b16 v[242:243], v6 offset:53760
    s_cmp_ge_u32 s73, 12
    s_cbranch_scc1 L_noex_10
    s_add_u32 m0, s49, 77824
    s_nop 0
    buffer_load_dwordx4 v15, s[16:19], s63 offen lds
    s_add_u32 s63, s63, 1179648
L_noex_10:
    v_lshlrev_b32 v2, 7, v0
    s_mov_b64 exec, 0xff
    v_add_u32 v2, s7, v2
    s_cmp_lt_u32 s47, 2
    s_cbranch_scc1 L_t_11
    buffer_load_dword v3, v2, s[28:31], 0 offen
    s_branch L_t_12
L_t_11:
    buffer_load_dword v3, v2, s[24:27], 0 offen
L_t_12:
    s_mov_b64 exec, -1
    s_waitcnt lgkmcnt(6)
    v_mfma_f32_32x32x16_bf16 v[160:175], v[228:231], v[44:47], v[160:175]
    v_rcp_f32 v249, v249
    ds_read_b64_tr_b16 v[224:225], v6 offset:55296
    ds_read_b64_tr_b16 v[226:227], v6 offset:55808
    s_waitcnt lgkmcnt(6)
    v_mfma_f32_32x32x16_bf16 v[160:175], v[232:235], v[48:51], v[160:175]
    v_rcp_f32 v250, v250
    v_rcp_f32 v251, v251
    v_pk_mul_f32 v[200:201], v[200:201], v[244:245]
    v_pk_mul_f32 v[202:203], v[202:203], v[246:247]
    ds_read_b64_tr_b16 v[228:229], v6 offset:8192
    ds_read_b64_tr_b16 v[230:231], v6 offset:8704
    s_waitcnt lgkmcnt(6)
    v_mfma_f32_32x32x16_bf16 v[160:175], v[236:239], v[52:55], v[160:175]
    v_pk_mul_f32 v[204:205], v[204:205], v[248:249]
    v_pk_mul_f32 v[206:207], v[206:207], v[250:251]
    v_cvt_pk_bf16_f32 v200, v200, v201
    v_cvt_pk_bf16_f32 v201, v202, v203
    v_cvt_pk_bf16_f32 v202, v204, v205
    v_cvt_pk_bf16_f32 v203, v206, v207
    buffer_store_dwordx4 v[200:203], v12, s[20:23], s66 offen offset:1024 sc1
    ds_read_b64_tr_b16 v[232:233], v6 offset:10240
    ds_read_b64_tr_b16 v[234:235], v6 offset:10752
    s_cmp_ge_u32 s73, 12
    s_cbranch_scc1 L_noex_13
    s_cmp_ge_u32 s46, 4
    s_cbranch_scc1 L_noex_13
    s_add_u32 m0, s49, 86016
    s_nop 0
    buffer_load_dwordx4 v15, s[16:19], s63 offen lds
L_noex_13:
    s_waitcnt lgkmcnt(6)
    v_mfma_f32_32x32x16_bf16 v[160:175], v[240:243], v[56:59], v[160:175]
    v_pk_mul_f32 v[244:245], v[208:209], s[50:51] op_sel:[0,1] op_sel_hi:[1,1]
    v_pk_mul_f32 v[246:247], v[210:211], s[50:51] op_sel:[0,1] op_sel_hi:[1,1]
    v_pk_mul_f32 v[248:249], v[212:213], s[50:51] op_sel:[0,1] op_sel_hi:[1,1]
    v_pk_mul_f32 v[250:251], v[214:215], s[50:51] op_sel:[0,1] op_sel_hi:[1,1]
    ds_read_b64_tr_b16 v[236:237], v6 offset:12288
    ds_read_b64_tr_b16 v[238:239], v6 offset:12800
    s_waitcnt lgkmcnt(6)
    v_mfma_f32_32x32x16_bf16 v[160:175], v[224:227], v[60:63], v[160:175]
    v_exp_f32 v244, v244
    v_exp_f32 v245, v245
    ds_read_b64_tr_b16 v[240:241], v6 offset:14336
    ds_read_b64_tr_b16 v[242:243], v6 offset:14848
    s_waitcnt lgkmcnt(6)
    v_mfma_f32_32x32x16_bf16 v[160:175], v[228:231], v[64:67], v[160:175]
    v_exp_f32 v246, v246
    v_exp_f32 v247, v247
    ds_read_b64_tr_b16 v[224:225], v6 offset:32768
    ds_read_b64_tr_b16 v[226:227], v6 offset:33280
    s_waitcnt lgkmcnt(6)
    v_mfma_f32_32x32x16_bf16 v[160:175], v[232:235], v[68:71], v[160:175]
    v_exp_f32 v248, v248
    ds_read_b64_tr_b16 v[228:229], v6 offset:34816
    ds_read_b64_tr_b16 v[230:231], v6 offset:35328
    s_waitcnt lgkmcnt(6)
    v_mfma_f32_32x32x16_bf16 v[160:175], v[236:239], v[72:75], v[160:175]
    v_exp_f32 v249, v249
    v_exp_f32 v250, v250
    ds_read_b64_tr_b16 v[232:233], v6 offset:36864
    ds_read_b64_tr_b16 v[234:235], v6 offset:37376
    s_waitcnt lgkmcnt(6)
    v_mfma_f32_32x32x16_bf16 v[160:175], v[240:243], v[76:79], v[160:175]
    v_exp_f32 v251, v251
    v_pk_add_f32 v[244:245], v[244:245], 1.0 op_sel_hi:[1,0]
    v_pk_add_f32 v[246:247], v[246:247], 1.0 op_sel_hi:[1,0]
    v_pk_add_f32 v[248:249], v[248:249], 1.0 op_sel_hi:[1,0]
    v_pk_add_f32 v[250:251], v[250:251], 1.0 op_sel_hi:[1,0]
    ds_read_b64_tr_b16 v[236:237], v6 offset:38912
    ds_read_b64_tr_b16 v[238:239], v6 offset:39424
    s_waitcnt lgkmcnt(6)
    v_mfma_f32_32x32x16_bf16 v[160:175], v[224:227], v[80:83], v[160:175]
    v_rcp_f32 v244, v244
    ds_read_b64_tr_b16 v[240:241], v6 offset:57344
    ds_read_b64_tr_b16 v[242:243], v6 offset:57856
    buffer_load_dword v253, v252, s[20:23], s4 offen sc1
    s_waitcnt lgkmcnt(6)
    v_mfma_f32_32x32x16_bf16 v[160:175], v[228:231], v[84:87], v[160:175]
    v_rcp_f32 v245, v245
    v_rcp_f32 v246, v246
    ds_read_b64_tr_b16 v[224:225], v6 offset:59392
    ds_read_b64_tr_b16 v[226:227], v6 offset:59904
    s_waitcnt lgkmcnt(6)
    v_mfma_f32_32x32x16_bf16 v[160:175], v[232:235], v[88:91], v[160:175]
    v_rcp_f32 v247, v247
    v_rcp_f32 v248, v248
    ds_read_b64_tr_b16 v[228:229], v6 offset:61440
    ds_read_b64_tr_b16 v[230:231], v6 offset:61952
    s_waitcnt lgkmcnt(6)
    v_mfma_f32_32x32x16_bf16 v[160:175], v[236:239], v[92:95], v[160:175]
    v_rcp_f32 v249, v249
    ds_read_b64_tr_b16 v[232:233], v6 offset:63488
    ds_read_b64_tr_b16 v[234:235], v6 offset:64000
    s_waitcnt lgkmcnt(6)
    v_mfma_f32_32x32x16_bf16 v[160:175], v[240:243], v[96:99], v[160:175]
    v_rcp_f32 v250, v250
    v_rcp_f32 v251, v251
    v_pk_mul_f32 v[208:209], v[208:209], v[244:245]
    v_pk_mul_f32 v[210:211], v[210:211], v[246:247]
    ds_read_b64_tr_b16 v[236:237], v6 offset:16384
    ds_read_b64_tr_b16 v[238:239], v6 offset:16896
    s_waitcnt lgkmcnt(6)
    v_mfma_f32_32x32x16_bf16 v[160:175], v[224:227], v[100:103], v[160:175]
    v_pk_mul_f32 v[212:213], v[212:213], v[248:249]
    v_pk_mul_f32 v[214:215], v[214:215], v[250:251]
    v_cvt_pk_bf16_f32 v208, v208, v209
    v_cvt_pk_bf16_f32 v209, v210, v211
    v_cvt_pk_bf16_f32 v210, v212, v213
    v_cvt_pk_bf16_f32 v211, v214, v215
    buffer_store_dwordx4 v[208:211], v12, s[20:23], s66 offen offset:2048 sc1
    ds_read_b64_tr_b16 v[240:241], v6 offset:18432
    ds_read_b64_tr_b16 v[242:243], v6 offset:18944
    s_waitcnt lgkmcnt(6)
    v_mfma_f32_32x32x16_bf16 v[160:175], v[228:231], v[104:107], v[160:175]
    v_pk_mul_f32 v[244:245], v[216:217], s[50:51] op_sel:[0,1] op_sel_hi:[1,1]
    v_pk_mul_f32 v[246:247], v[218:219], s[50:51] op_sel:[0,1] op_sel_hi:[1,1]
    v_pk_mul_f32 v[248:249], v[220:221], s[50:51] op_sel:[0,1] op_sel_hi:[1,1]
    v_pk_mul_f32 v[250:251], v[222:223], s[50:51] op_sel:[0,1] op_sel_hi:[1,1]
    ds_read_b64_tr_b16 v[224:225], v6 offset:20480
    ds_read_b64_tr_b16 v[226:227], v6 offset:20992
    s_waitcnt lgkmcnt(6)
    v_mfma_f32_32x32x16_bf16 v[160:175], v[232:235], v[108:111], v[160:175]
    v_exp_f32 v244, v244
    v_exp_f32 v245, v245
    ds_read_b64_tr_b16 v[228:229], v6 offset:22528
    ds_read_b64_tr_b16 v[230:231], v6 offset:23040
    s_waitcnt lgkmcnt(6)
    v_mfma_f32_32x32x16_bf16 v[160:175], v[236:239], v[112:115], v[160:175]
    v_exp_f32 v246, v246
    v_exp_f32 v247, v247
    ds_read_b64_tr_b16 v[232:233], v6 offset:40960
    ds_read_b64_tr_b16 v[234:235], v6 offset:41472
    s_waitcnt vmcnt(1)
    s_mov_b32 s59, 30000
L_pl_15:
    v_cmp_ne_u32 vcc, s50, v253
    s_nop 4
    s_cbranch_vccz L_pd_14
    buffer_load_dword v253, v252, s[20:23], s4 offen sc1
    s_waitcnt vmcnt(0)
    s_sub_u32 s59, s59, 1
    s_cmp_lg_u32 s59, 0
    s_cbranch_scc1 L_pl_15
L_pd_14:
    v_and_b32 v1, 31, v0
    v_lshlrev_b32 v1, 3, v1
    buffer_load_dwordx2 v[2:3], v1, s[20:23], s81 offen sc1
    s_mov_b32 exec_hi, 0xf
    s_add_u32 m0, s82, 40960
    s_add_u32 s52, s77, 0
    buffer_load_dwordx4 v12, s[20:23], s52 offen sc1 lds
    s_mov_b32 exec_hi, -1
    s_waitcnt lgkmcnt(6)
    v_mfma_f32_32x32x16_bf16 v[160:175], v[240:243], v[116:119], v[160:175]
    v_exp_f32 v248, v248
    ds_read_b64_tr_b16 v[236:237], v6 offset:43008
    ds_read_b64_tr_b16 v[238:239], v6 offset:43520
    s_waitcnt lgkmcnt(6)
    v_mfma_f32_32x32x16_bf16 v[160:175], v[224:227], v[120:123], v[160:175]
    v_exp_f32 v249, v249
    v_exp_f32 v250, v250
    ds_read_b64_tr_b16 v[240:241], v6 offset:45056
    ds_read_b64_tr_b16 v[242:243], v6 offset:45568
    s_mov_b32 exec_hi, 0xf
    s_add_u32 m0, s82, 41600
    s_add_u32 s52, s77, 55296
    buffer_load_dwordx4 v12, s[20:23], s52 offen sc1 lds
    s_mov_b32 exec_hi, -1
    s_waitcnt lgkmcnt(6)
    v_mfma_f32_32x32x16_bf16 v[160:175], v[228:231], v[124:127], v[160:175]
    v_exp_f32 v251, v251
    v_pk_add_f32 v[244:245], v[244:245], 1.0 op_sel_hi:[1,0]
    v_pk_add_f32 v[246:247], v[246:247], 1.0 op_sel_hi:[1,0]
    v_pk_add_f32 v[248:249], v[248:249], 1.0 op_sel_hi:[1,0]
    v_pk_add_f32 v[250:251], v[250:251], 1.0 op_sel_hi:[1,0]
    ds_read_b64_tr_b16 v[224:225], v6 offset:47104
    ds_read_b64_tr_b16 v[226:227], v6 offset:47616
    s_waitcnt lgkmcnt(6)
    v_mfma_f32_32x32x16_bf16 v[160:175], v[232:235], v[128:131], v[160:175]
    v_rcp_f32 v244, v244
    v_add_u32 v6, 65536, v6
    ds_read_b64_tr_b16 v[228:229], v6 offset:0
    ds_read_b64_tr_b16 v[230:231], v6 offset:512
    s_mov_b32 exec_hi, 0xf
    s_add_u32 m0, s83, 0
    s_add_u32 s52, s76, 0
    buffer_load_dwordx4 v12, s[20:23], s52 offen sc1 lds
    s_mov_b32 exec_hi, -1
    s_waitcnt lgkmcnt(6)
    v_mfma_f32_32x32x16_bf16 v[160:175], v[236:239], v[132:135], v[160:175]
    v_rcp_f32 v245, v245
    v_rcp_f32 v246, v246
    ds_read_b64_tr_b16 v[232:233], v6 offset:2048
    ds_read_b64_tr_b16 v[234:235], v6 offset:2560
    s_waitcnt lgkmcnt(6)
    v_mfma_f32_32x32x16_bf16 v[160:175], v[240:243], v[136:139], v[160:175]
    v_rcp_f32 v247, v247
    v_rcp_f32 v248, v248
    ds_read_b64_tr_b16 v[236:237], v6 offset:4096
    ds_read_b64_tr_b16 v[238:239], v6 offset:4608
    s_mov_b32 exec_hi, 0xf
    s_add_u32 m0, s83, 640
    s_add_u32 s52, s76, 55296
    buffer_load_dwordx4 v12, s[20:23], s52 offen sc1 lds
    s_mov_b32 exec_hi, -1
    s_waitcnt lgkmcnt(6)
    v_mfma_f32_32x32x16_bf16 v[160:175], v[224:227], v[140:143], v[160:175]
    v_rcp_f32 v249, v249
    ds_read_b64_tr_b16 v[240:241], v6 offset:6144
    ds_read_b64_tr_b16 v[242:243], v6 offset:6656
    s_waitcnt lgkmcnt(6)
    v_mfma_f32_32x32x16_bf16 v[160:175], v[228:231], v[144:147], v[160:175]
    v_rcp_f32 v250, v250
    v_rcp_f32 v251, v251
    v_pk_mul_f32 v[216:217], v[216:217], v[244:245]
    v_pk_mul_f32 v[218:219], v[218:219], v[246:247]
    v_add_u32 v7, 90112, v7
    ds_read_b64_tr_b16 v[224:225], v7 offset:0
    ds_read_b64_tr_b16 v[226:227], v7 offset:512
    s_mov_b32 exec_hi, 0xf
    s_add_u32 m0, s83, 1280
    s_add_u32 s52, s76, 110592
    buffer_load_dwordx4 v12, s[20:23], s52 offen sc1 lds
    s_mov_b32 exec_hi, -1
    s_waitcnt lgkmcnt(6)
    v_mfma_f32_32x32x16_bf16 v[160:175], v[232:235], v[148:151], v[160:175]
    v_pk_mul_f32 v[220:221], v[220:221], v[248:249]
    v_pk_mul_f32 v[222:223], v[222:223], v[250:251]
    v_cvt_pk_bf16_f32 v216, v216, v217
    v_cvt_pk_bf16_f32 v217, v218, v219
    v_cvt_pk_bf16_f32 v218, v220, v221
    v_cvt_pk_bf16_f32 v219, v222, v223
    buffer_store_dwordx4 v[216:219], v12, s[20:23], s66 offen offset:3072 sc1
    ds_read_b64_tr_b16 v[228:229], v7 offset:2048
    ds_read_b64_tr_b16 v[230:231], v7 offset:2560
    s_waitcnt lgkmcnt(6)
    v_mfma_f32_32x32x16_bf16 v[160:175], v[236:239], v[152:155], v[160:175]
    ds_read_b64_tr_b16 v[232:233], v7 offset:4096
    ds_read_b64_tr_b16 v[234:235], v7 offset:4608
    s_mov_b32 exec_hi, 0xf
    s_add_u32 m0, s83, 1920
    s_add_u32 s52, s76, 165888
    buffer_load_dwordx4 v12, s[20:23], s52 offen sc1 lds
    s_mov_b32 exec_hi, -1
    s_waitcnt lgkmcnt(6)
    v_mfma_f32_32x32x16_bf16 v[160:175], v[240:243], v[156:159], v[160:175]
    ds_read_b64_tr_b16 v[236:237], v7 offset:6144
    ds_read_b64_tr_b16 v[238:239], v7 offset:6656
    s_waitcnt lgkmcnt(6)
    v_mfma_f32_32x32x16_bf16 v[176:191], v[224:227], v[16:19], 0
    ds_read_b64_tr_b16 v[240:241], v7 offset:24576
    ds_read_b64_tr_b16 v[242:243], v7 offset:25088
    s_mov_b32 exec_hi, 0xf
    s_add_u32 m0, s83, 20480
    s_add_u32 s52, s76, 18432
    buffer_load_dwordx4 v13, s[20:23], s52 offen sc1 lds
    s_mov_b32 exec_hi, -1
    s_waitcnt lgkmcnt(6)
    v_mfma_f32_32x32x16_bf16 v[176:191], v[228:231], v[20:23], v[176:191]
    ds_read_b64_tr_b16 v[224:225], v7 offset:26624
    ds_read_b64_tr_b16 v[226:227], v7 offset:27136
    s_waitcnt lgkmcnt(6)
    v_mfma_f32_32x32x16_bf16 v[176:191], v[232:235], v[24:27], v[176:191]
    v_pk_mul_f32 v[244:245], v[160:161], s[50:51] op_sel:[0,1] op_sel_hi:[1,1]
    v_pk_mul_f32 v[246:247], v[162:163], s[50:51] op_sel:[0,1] op_sel_hi:[1,1]
    v_pk_mul_f32 v[248:249], v[164:165], s[50:51] op_sel:[0,1] op_sel_hi:[1,1]
    v_pk_mul_f32 v[250:251], v[166:167], s[50:51] op_sel:[0,1] op_sel_hi:[1,1]
    ds_read_b64_tr_b16 v[228:229], v7 offset:28672
    ds_read_b64_tr_b16 v[230:231], v7 offset:29184
    s_mov_b32 exec_hi, 0xf
    s_add_u32 m0, s83, 21120
    s_add_u32 s52, s76, 73728
    buffer_load_dwordx4 v13, s[20:23], s52 offen sc1 lds
    s_mov_b32 exec_hi, -1
    s_waitcnt lgkmcnt(6)
    v_mfma_f32_32x32x16_bf16 v[176:191], v[236:239], v[28:31], v[176:191]
    v_exp_f32 v244, v244
    v_exp_f32 v245, v245
    ds_read_b64_tr_b16 v[232:233], v7 offset:30720
    ds_read_b64_tr_b16 v[234:235], v7 offset:31232
    s_waitcnt lgkmcnt(6)
    v_mfma_f32_32x32x16_bf16 v[176:191], v[240:243], v[32:35], v[176:191]
    v_exp_f32 v246, v246
    v_exp_f32 v247, v247
    ds_read_b64_tr_b16 v[236:237], v7 offset:49152
    ds_read_b64_tr_b16 v[238:239], v7 offset:49664
    s_mov_b32 exec_hi, 0xf
    s_add_u32 m0, s83, 21760
    s_add_u32 s52, s76, 129024
    buffer_load_dwordx4 v13, s[20:23], s52 offen sc1 lds
    s_mov_b32 exec_hi, -1
    s_waitcnt lgkmcnt(6)
    v_mfma_f32_32x32x16_bf16 v[176:191], v[224:227], v[36:39], v[176:191]
    v_exp_f32 v248, v248
    ds_read_b64_tr_b16 v[240:241], v7 offset:51200
    ds_read_b64_tr_b16 v[242:243], v7 offset:51712
    s_waitcnt lgkmcnt(6)
    v_mfma_f32_32x32x16_bf16 v[176:191], v[228:231], v[40:43], v[176:191]
    v_exp_f32 v249, v249
    v_exp_f32 v250, v250
    ds_read_b64_tr_b16 v[224:225], v7 offset:53248
    ds_read_b64_tr_b16 v[226:227], v7 offset:53760
    s_mov_b32 exec_hi, 0xf
    s_add_u32 m0, s83, 22400
    s_add_u32 s52, s76, 184320
    buffer_load_dwordx4 v13, s[20:23], s52 offen sc1 lds
    s_mov_b32 exec_hi, -1
    s_waitcnt lgkmcnt(6)
    v_mfma_f32_32x32x16_bf16 v[176:191], v[232:235], v[44:47], v[176:191]
    v_exp_f32 v251, v251
    v_pk_add_f32 v[244:245], v[244:245], 1.0 op_sel_hi:[1,0]
    v_pk_add_f32 v[246:247], v[246:247], 1.0 op_sel_hi:[1,0]
    v_pk_add_f32 v[248:249], v[248:249], 1.0 op_sel_hi:[1,0]
    v_pk_add_f32 v[250:251], v[250:251], 1.0 op_sel_hi:[1,0]
    ds_read_b64_tr_b16 v[228:229], v7 offset:55296
    ds_read_b64_tr_b16 v[230:231], v7 offset:55808
    s_waitcnt lgkmcnt(6)
    v_mfma_f32_32x32x16_bf16 v[176:191], v[236:239], v[48:51], v[176:191]
    v_rcp_f32 v244, v244
    ds_read_b64_tr_b16 v[232:233], v7 offset:8192
    ds_read_b64_tr_b16 v[234:235], v7 offset:8704
    s_waitcnt lgkmcnt(6)
    v_mfma_f32_32x32x16_bf16 v[176:191], v[240:243], v[52:55], v[176:191]
    v_rcp_f32 v245, v245
    v_rcp_f32 v246, v246
    ds_read_b64_tr_b16 v[236:237], v7 offset:10240
    ds_read_b64_tr_b16 v[238:239], v7 offset:10752
    s_waitcnt lgkmcnt(6)
    v_mfma_f32_32x32x16_bf16 v[176:191], v[224:227], v[56:59], v[176:191]
    v_rcp_f32 v247, v247
    v_rcp_f32 v248, v248
    ds_read_b64_tr_b16 v[240:241], v7 offset:12288
    ds_read_b64_tr_b16 v[242:243], v7 offset:12800
    s_waitcnt lgkmcnt(6)
    v_mfma_f32_32x32x16_bf16 v[176:191], v[228:231], v[60:63], v[176:191]
    v_rcp_f32 v249, v249
    ds_read_b64_tr_b16 v[224:225], v7 offset:14336
    ds_read_b64_tr_b16 v[226:227], v7 offset:14848
    s_waitcnt lgkmcnt(6)
    v_mfma_f32_32x32x16_bf16 v[176:191], v[232:235], v[64:67], v[176:191]
    v_rcp_f32 v250, v250
    v_rcp_f32 v251, v251
    v_pk_mul_f32 v[160:161], v[160:161], v[244:245]
    v_pk_mul_f32 v[162:163], v[162:163], v[246:247]
    ds_read_b64_tr_b16 v[228:229], v7 offset:32768
    ds_read_b64_tr_b16 v[230:231], v7 offset:33280
    s_waitcnt lgkmcnt(6)
    v_mfma_f32_32x32x16_bf16 v[176:191], v[236:239], v[68:71], v[176:191]
    v_pk_mul_f32 v[164:165], v[164:165], v[248:249]
    v_pk_mul_f32 v[166:167], v[166:167], v[250:251]
    v_cvt_pk_bf16_f32 v160, v160, v161
    v_cvt_pk_bf16_f32 v161, v162, v163
    v_cvt_pk_bf16_f32 v162, v164, v165
    v_cvt_pk_bf16_f32 v163, v166, v167
    buffer_store_dwordx4 v[160:163], v12, s[20:23], s67 offen offset:0 sc1
    ds_read_b64_tr_b16 v[232:233], v7 offset:34816
    ds_read_b64_tr_b16 v[234:235], v7 offset:35328
    s_waitcnt lgkmcnt(6)
    v_mfma_f32_32x32x16_bf16 v[176:191], v[240:243], v[72:75], v[176:191]
    v_pk_mul_f32 v[244:245], v[168:169], s[50:51] op_sel:[0,1] op_sel_hi:[1,1]
    v_pk_mul_f32 v[246:247], v[170:171], s[50:51] op_sel:[0,1] op_sel_hi:[1,1]
    v_pk_mul_f32 v[248:249], v[172:173], s[50:51] op_sel:[0,1] op_sel_hi:[1,1]
    v_pk_mul_f32 v[250:251], v[174:175], s[50:51] op_sel:[0,1] op_sel_hi:[1,1]
    ds_read_b64_tr_b16 v[236:237], v7 offset:36864
    ds_read_b64_tr_b16 v[238:239], v7 offset:37376
    s_waitcnt lgkmcnt(6)
    v_mfma_f32_32x32x16_bf16 v[176:191], v[224:227], v[76:79], v[176:191]
    v_exp_f32 v244, v244
    v_exp_f32 v245, v245
    ds_read_b64_tr_b16 v[240:241], v7 offset:38912
    ds_read_b64_tr_b16 v[242:243], v7 offset:39424
    s_waitcnt lgkmcnt(6)
    v_mfma_f32_32x32x16_bf16 v[176:191], v[228:231], v[80:83], v[176:191]
    v_exp_f32 v246, v246
    v_exp_f32 v247, v247
    s_cmp_ge_u32 s73, 12
    s_cbranch_scc1 L_noeb_16
    s_barrier
L_noeb_16:
    ds_read_b64_tr_b16 v[224:225], v7 offset:57344
    ds_read_b64_tr_b16 v[226:227], v7 offset:57856
    s_waitcnt lgkmcnt(6)
    v_mfma_f32_32x32x16_bf16 v[176:191], v[232:235], v[84:87], v[176:191]
    v_exp_f32 v248, v248
    ds_read_b64_tr_b16 v[228:229], v7 offset:59392
    ds_read_b64_tr_b16 v[230:231], v7 offset:59904
    s_waitcnt lgkmcnt(6)
    v_mfma_f32_32x32x16_bf16 v[176:191], v[236:239], v[88:91], v[176:191]
    v_exp_f32 v249, v249
    v_exp_f32 v250, v250
    ds_read_b64_tr_b16 v[232:233], v7 offset:61440
    ds_read_b64_tr_b16 v[234:235], v7 offset:61952
    s_waitcnt lgkmcnt(6)
    v_mfma_f32_32x32x16_bf16 v[176:191], v[240:243], v[92:95], v[176:191]
    v_exp_f32 v251, v251
    v_pk_add_f32 v[244:245], v[244:245], 1.0 op_sel_hi:[1,0]
    v_pk_add_f32 v[246:247], v[246:247], 1.0 op_sel_hi:[1,0]
    v_pk_add_f32 v[248:249], v[248:249], 1.0 op_sel_hi:[1,0]
    v_pk_add_f32 v[250:251], v[250:251], 1.0 op_sel_hi:[1,0]
    ds_read_b64_tr_b16 v[236:237], v7 offset:63488
    ds_read_b64_tr_b16 v[238:239], v7 offset:64000
    s_waitcnt lgkmcnt(6)
    v_mfma_f32_32x32x16_bf16 v[176:191], v[224:227], v[96:99], v[176:191]
    v_rcp_f32 v244, v244
    ds_read_b64_tr_b16 v[240:241], v7 offset:16384
    ds_read_b64_tr_b16 v[242:243], v7 offset:16896
    s_waitcnt lgkmcnt(6)
    v_mfma_f32_32x32x16_bf16 v[176:191], v[228:231], v[100:103], v[176:191]
    v_rcp_f32 v245, v245
    v_rcp_f32 v246, v246
    ds_read_b64_tr_b16 v[224:225], v7 offset:18432
    ds_read_b64_tr_b16 v[226:227], v7 offset:18944
    s_waitcnt lgkmcnt(6)
    v_mfma_f32_32x32x16_bf16 v[176:191], v[232:235], v[104:107], v[176:191]
    v_rcp_f32 v247, v247
    v_rcp_f32 v248, v248
    ds_read_b64_tr_b16 v[228:229], v7 offset:20480
    ds_read_b64_tr_b16 v[230:231], v7 offset:20992
    s_waitcnt lgkmcnt(6)
    v_mfma_f32_32x32x16_bf16 v[176:191], v[236:239], v[108:111], v[176:191]
    v_rcp_f32 v249, v249
    ds_read_b64_tr_b16 v[232:233], v7 offset:22528
    ds_read_b64_tr_b16 v[234:235], v7 offset:23040
    s_waitcnt lgkmcnt(6)
    v_mfma_f32_32x32x16_bf16 v[176:191], v[240:243], v[112:115], v[176:191]
    v_rcp_f32 v250, v250
    v_rcp_f32 v251, v251
    v_pk_mul_f32 v[168:169], v[168:169], v[244:245]
    v_pk_mul_f32 v[170:171], v[170:171], v[246:247]
    ds_read_b64_tr_b16 v[236:237], v7 offset:40960
    ds_read_b64_tr_b16 v[238:239], v7 offset:41472
    s_waitcnt lgkmcnt(6)
    v_mfma_f32_32x32x16_bf16 v[176:191], v[224:227], v[116:119], v[176:191]
    v_pk_mul_f32 v[172:173], v[172:173], v[248:249]
    v_pk_mul_f32 v[174:175], v[174:175], v[250:251]
    v_cvt_pk_bf16_f32 v168, v168, v169
    v_cvt_pk_bf16_f32 v169, v170, v171
    v_cvt_pk_bf16_f32 v170, v172, v173
    v_cvt_pk_bf16_f32 v171, v174, v175
    buffer_store_dwordx4 v[168:171], v12, s[20:23], s67 offen offset:1024 sc1
    ds_read_b64_tr_b16 v[240:241], v7 offset:43008
    ds_read_b64_tr_b16 v[242:243], v7 offset:43520
    s_waitcnt lgkmcnt(6)
    v_mfma_f32_32x32x16_bf16 v[176:191], v[228:231], v[120:123], v[176:191]
    ds_read_b64_tr_b16 v[224:225], v7 offset:45056
    ds_read_b64_tr_b16 v[226:227], v7 offset:45568
    s_waitcnt lgkmcnt(6)
    v_mfma_f32_32x32x16_bf16 v[176:191], v[232:235], v[124:127], v[176:191]
    ds_read_b64_tr_b16 v[228:229], v7 offset:47104
    ds_read_b64_tr_b16 v[230:231], v7 offset:47616
    s_waitcnt lgkmcnt(6)
    v_mfma_f32_32x32x16_bf16 v[176:191], v[236:239], v[128:131], v[176:191]
    v_add_u32 v7, 65536, v7
    ds_read_b64_tr_b16 v[232:233], v7 offset:0
    ds_read_b64_tr_b16 v[234:235], v7 offset:512
    s_waitcnt lgkmcnt(6)
    v_mfma_f32_32x32x16_bf16 v[176:191], v[240:243], v[132:135], v[176:191]
    ds_read_b64_tr_b16 v[236:237], v7 offset:2048
    ds_read_b64_tr_b16 v[238:239], v7 offset:2560
    s_waitcnt lgkmcnt(6)
    v_mfma_f32_32x32x16_bf16 v[176:191], v[224:227], v[136:139], v[176:191]
    ds_read_b64_tr_b16 v[240:241], v7 offset:4096
    ds_read_b64_tr_b16 v[242:243], v7 offset:4608
    s_waitcnt lgkmcnt(6)
    v_mfma_f32_32x32x16_bf16 v[176:191], v[228:231], v[140:143], v[176:191]
    ds_read_b64_tr_b16 v[224:225], v7 offset:6144
    ds_read_b64_tr_b16 v[226:227], v7 offset:6656
    s_waitcnt lgkmcnt(6)
    v_mfma_f32_32x32x16_bf16 v[176:191], v[232:235], v[144:147], v[176:191]
    s_waitcnt lgkmcnt(4)
    v_mfma_f32_32x32x16_bf16 v[176:191], v[236:239], v[148:151], v[176:191]
    s_waitcnt lgkmcnt(2)
    v_mfma_f32_32x32x16_bf16 v[176:191], v[240:243], v[152:155], v[176:191]
    s_waitcnt lgkmcnt(0)
    v_mfma_f32_32x32x16_bf16 v[176:191], v[224:227], v[156:159], v[176:191]
    s_waitcnt vmcnt(7)
    s_add_u32 s52, s3, 8192
    v_mov_b32 v254, s50
    s_mov_b64 exec, 1
    buffer_store_dword v254, off, s[20:23], s52 offset:0 sc1
    s_mov_b64 exec, -1
    s_branch L_passB_2
L_typeF_1:
    s_add_u32 m0, s49, 0
    s_nop 0
    buffer_load_dwordx4 v4, s[16:19], s60 offen lds
    s_add_u32 s60, s60, 589824
    s_add_u32 m0, s49, 8192
    s_nop 0
    buffer_load_dwordx4 v4, s[16:19], s61 offen lds
    s_add_u32 s61, s61, 589824
    s_add_u32 m0, s49, 65536
    s_nop 0
    buffer_load_dwordx4 v2, s[8:11], 0 offen offset:0 lds
    s_add_u32 m0, s49, 90112
    s_nop 0
    buffer_load_dwordx4 v3, s[8:11], 0 offen offset:0 lds
    s_add_u32 m0, s49, 114688
    s_nop 0
    buffer_load_dwordx4 v2, s[8:11], s64 offen offset:0 lds
    s_add_u32 m0, s49, 139264
    s_nop 0
    buffer_load_dwordx4 v3, s[8:11], s64 offen offset:0 lds
    v_and_b32 v1, 31, v0
    v_lshrrev_b32 v244, 3, v1
    v_mul_u32_u24 v244, 24576, v244
    v_and_b32 v14, 7, v0
    v_lshl_add_u32 v244, v14, 7, v244
    s_add_u32 s54, s49, 65536
    v_add_u32 v244, s54, v244
    v_bfe_u32 v14, v0, 1, 3
    v_lshrrev_b32 v1, 5, v0
    v_xor_b32 v1, v1, v14
    v_xor_b32 v8, 0, v1
    v_lshl_add_u32 v8, v8, 4, v244
    v_xor_b32 v9, 2, v1
    v_lshl_add_u32 v9, v9, 4, v244
    v_xor_b32 v10, 4, v1
    v_lshl_add_u32 v10, v10, 4, v244
    v_xor_b32 v11, 6, v1
    v_lshl_add_u32 v11, v11, 4, v244
    s_add_u32 m0, s49, 73600
    s_nop 0
    buffer_load_dwordx4 v2, s[8:11], 0 offen offset:128 lds
    s_add_u32 m0, s49, 98176
    s_nop 0
    buffer_load_dwordx4 v3, s[8:11], 0 offen offset:128 lds
    s_add_u32 m0, s49, 122752
    s_nop 0
    buffer_load_dwordx4 v2, s[8:11], s64 offen offset:128 lds
    s_add_u32 m0, s49, 147328
    s_nop 0
    buffer_load_dwordx4 v3, s[8:11], s64 offen offset:128 lds
    s_add_u32 m0, s49, 16384
    s_nop 0
    buffer_load_dwordx4 v4, s[16:19], s60 offen lds
    s_add_u32 s60, s60, 589824
    s_add_u32 m0, s49, 24576
    s_nop 0
    buffer_load_dwordx4 v4, s[16:19], s61 offen lds
    s_add_u32 s61, s61, 589824
    v_bfe_u32 v1, v0, 2, 2
    v_lshrrev_b32 v244, 5, v0
    v_lshl_add_u32 v1, v244, 3, v1
    v_and_b32 v244, 3, v0
    v_lshlrev_b32 v244, 3, v244
    v_bfe_u32 v14, v0, 4, 1
    v_lshl_add_u32 v244, v14, 5, v244
    v_lshl_add_u32 v14, v1, 6, v244
    v_add_u32 v14, 53248, v14
    v_lshl_add_u32 v6, v1, 7, v244
    v_bfe_u32 v1, v0, 3, 1
    v_lshl_add_u32 v6, v1, 6, v6
    v_xor_b32 v7, 64, v6
    s_add_u32 m0, s49, 81664
    s_nop 0
    buffer_load_dwordx4 v2, s[8:11], 0 offen offset:256 lds
    s_add_u32 m0, s49, 106240
    s_nop 0
    buffer_load_dwordx4 v3, s[8:11], 0 offen offset:256 lds
    s_add_u32 m0, s49, 130816
    s_nop 0
    buffer_load_dwordx4 v2, s[8:11], s64 offen offset:256 lds
    s_add_u32 m0, s49, 155392
    s_nop 0
    buffer_load_dwordx4 v3, s[8:11], s64 offen offset:256 lds
    s_add_u32 m0, s49, 32768
    s_nop 0
    buffer_load_dwordx4 v4, s[16:19], s60 offen lds
    s_add_u32 s60, s60, 589824
    s_add_u32 m0, s49, 40960
    s_nop 0
    buffer_load_dwordx4 v4, s[16:19], s61 offen lds
    s_add_u32 s61, s61, 589824
    s_add_u32 s54, s52, s45
    s_mul_i32 s72, s54, 1152
    s_lshl_b32 s71, s54, 3
    s_add_u32 s71, s71, 29360128
    v_lshlrev_b32 v252, 5, v0
    v_mov_b32 v253, 0x7ffffff0
    v_cmp_gt_u32 vcc, 36, v0
    s_nop 1
    v_cndmask_b32 v252, v253, v252, vcc
    s_add_u32 m0, s49, 49152
    s_nop 0
    buffer_load_dwordx4 v4, s[16:19], s60 offen lds
    s_add_u32 s60, s60, 589824
    s_add_u32 m0, s49, 57344
    s_nop 0
    buffer_load_dwordx4 v4, s[16:19], s61 offen lds
    s_add_u32 s61, s61, 589824
    buffer_load_dwordx4 v[144:147], v252, s[8:11], s72 offen
    buffer_load_dwordx4 v[148:151], v252, s[8:11], s72 offen offset:16
    buffer_load_dwordx4 v[152:155], v252, s[36:39], 0 offen
    buffer_load_dwordx4 v[156:159], v252, s[36:39], 0 offen offset:16
    v_cmp_eq_u32 vcc, 63, v0
    s_nop 1
    v_cndmask_b32 v253, v253, 0, vcc
    v_lshlrev_b32 v12, 4, v0
    v_and_b32 v1, 31, v0
    v_lshrrev_b32 v13, 5, v0
    v_lshlrev_b32 v13, 4, v13
    v_lshl_add_u32 v13, v1, 5, v13
    s_lshr_b32 s54, s52, 5
    s_mul_i32 s69, s54, 110592
    s_lshl_b32 s55, s45, 11
    s_add_u32 s69, s69, s55
    s_add_u32 s70, s69, 55296
    s_mul_i32 s54, s54, 331776
    s_add_u32 s54, s54, 7340032
    s_add_u32 s65, s65, s54
    s_lshl_b32 s55, s53, 12
    s_add_u32 s66, s54, s55
    s_lshl_b32 s67, s67, 12
    s_add_u32 s67, s67, s66
    s_lshr_b32 s55, s73, 1
    s_lshl_b32 s53, s55, 6
    s_add_u32 s63, s63, s53
    s_add_u32 s63, s63, 8832
    s_lshl_b32 s55, s55, 11
    s_add_u32 s68, s54, s55
    s_add_u32 s68, s68, 282624
    s_or_b32 s52, s2, s46
    s_cmp_lg_u32 s52, 0
    s_cbranch_scc1 L_np_17
    s_memrealtime s[52:53]
    s_waitcnt lgkmcnt(0)
    s_or_b32 s52, s52, 1
    v_mov_b32 v1, s52
    s_mov_b64 exec, 1
    buffer_store_dword v1, off, s[40:43], 0 sc1
    s_mov_b64 exec, -1
L_np_17:
    s_lshl_b32 s52, s44, 3
    s_add_u32 s52, s52, s46
    s_lshl_b32 s3, s52, 7
    s_lshl_b32 s52, s45, 2
    s_add_u32 s3, s3, s52
    s_add_u32 s3, s3, 29425664
    s_mov_b32 s4, 29425664
    s_lshr_b32 s53, s47, 1
    s_mul_i32 s6, s53, 1253376
    s_lshr_b32 s52, s2, 3
    s_lshl_b32 s52, s52, 3
    s_add_u32 s52, s52, s46
    s_mul_i32 s7, s53, 248832
    s_sub_u32 s7, s7, 248832
    s_cmp_eq_u32 s53, 0
    s_cselect_b32 s7, 5087232, s7
    s_lshl_b32 s53, s52, 10
    s_add_u32 s7, s7, s53
    s_mul_i32 s52, s52, 1280
    s_add_u32 s6, s6, s52
    s_and_b32 s52, s47, 1
    s_mul_i32 s52, s52, 655360
    s_add_u32 s6, s6, s52
    s_lshl_b32 s52, s52, 1
    s_sub_u32 s5, 327680, s52
    s_waitcnt vmcnt(18)
    ds_read_b128 v[16:19], v8 offset:0
    ds_read_b128 v[20:23], v9 offset:0
    ds_read_b128 v[24:27], v10 offset:0
    ds_read_b128 v[28:31], v11 offset:0
    s_barrier
    ds_read_b64_tr_b16 v[224:225], v6 offset:0
    ds_read_b64_tr_b16 v[226:227], v6 offset:512
    ds_read_b64_tr_b16 v[228:229], v7 offset:0
    ds_read_b64_tr_b16 v[230:231], v7 offset:512
    ds_read_b64_tr_b16 v[232:233], v6 offset:8192
    ds_read_b64_tr_b16 v[234:235], v6 offset:8704
    s_lshl_b32 s52, s2, 3
    s_add_u32 s52, s52, s46
    s_lshl_b32 s52, s52, 7
    s_add_u32 s52, s52, 0
    v_mul_u32_u24 v129, 1061888, v0
    s_mov_b64 exec, 31
    buffer_load_dword v128, v129, s[24:27], s52 offen
    s_mov_b64 exec, -1
    ds_read_b64_tr_b16 v[236:237], v7 offset:8192
    ds_read_b64_tr_b16 v[238:239], v7 offset:8704
    s_waitcnt lgkmcnt(6)
    v_mfma_f32_32x32x16_bf16 v[160:175], v[224:227], v[16:19], 0
    ds_read_b64_tr_b16 v[240:241], v6 offset:2048
    ds_read_b64_tr_b16 v[242:243], v6 offset:2560
    s_add_u32 m0, s49, 65152
    s_nop 0
    buffer_load_dwordx4 v2, s[8:11], 0 offen offset:384 lds
    s_waitcnt lgkmcnt(6)
    v_mfma_f32_32x32x16_bf16 v[176:191], v[228:231], v[16:19], 0
    ds_read_b64_tr_b16 v[224:225], v7 offset:2048
    ds_read_b64_tr_b16 v[226:227], v7 offset:2560
    s_add_u32 m0, s49, 89728
    s_nop 0
    buffer_load_dwordx4 v3, s[8:11], 0 offen offset:384 lds
    s_waitcnt lgkmcnt(6)
    v_mfma_f32_32x32x16_bf16 v[192:207], v[232:235], v[16:19], 0
    ds_read_b64_tr_b16 v[228:229], v6 offset:10240
    ds_read_b64_tr_b16 v[230:231], v6 offset:10752
    s_add_u32 m0, s49, 114304
    s_nop 0
    buffer_load_dwordx4 v2, s[8:11], s64 offen offset:384 lds
    s_waitcnt lgkmcnt(6)
    v_mfma_f32_32x32x16_bf16 v[208:223], v[236:239], v[16:19], 0
    ds_read_b64_tr_b16 v[232:233], v7 offset:10240
    ds_read_b64_tr_b16 v[234:235], v7 offset:10752
    s_add_u32 m0, s49, 138880
    s_nop 0
    buffer_load_dwordx4 v3, s[8:11], s64 offen offset:384 lds
    s_waitcnt lgkmcnt(6)
    v_mfma_f32_32x32x16_bf16 v[160:175], v[240:243], v[20:23], v[160:175]
    ds_read_b64_tr_b16 v[236:237], v6 offset:4096
    ds_read_b64_tr_b16 v[238:239], v6 offset:4608
    s_waitcnt vmcnt(19)
    ds_read_b128 v[32:35], v8 offset:8192
    s_waitcnt lgkmcnt(7)
    v_mfma_f32_32x32x16_bf16 v[176:191], v[224:227], v[20:23], v[176:191]
    ds_read_b64_tr_b16 v[240:241], v7 offset:4096
    ds_read_b64_tr_b16 v[242:243], v7 offset:4608
    ds_read_b128 v[36:39], v9 offset:8192
    s_waitcnt lgkmcnt(8)
    v_mfma_f32_32x32x16_bf16 v[192:207], v[228:231], v[20:23], v[192:207]
    ds_read_b64_tr_b16 v[224:225], v6 offset:12288
    ds_read_b64_tr_b16 v[226:227], v6 offset:12800
    ds_read_b128 v[40:43], v10 offset:8192
    s_lshl_b32 s52, s2, 3
    s_add_u32 s52, s52, s46
    s_lshl_b32 s52, s52, 7
    s_add_u32 s52, s52, 262144
    v_mul_u32_u24 v129, 1061888, v0
    s_mov_b64 exec, 31
    buffer_load_dword v128, v129, s[24:27], s52 offen
    s_mov_b64 exec, -1
    s_waitcnt lgkmcnt(9)
    v_mfma_f32_32x32x16_bf16 v[208:223], v[232:235], v[20:23], v[208:223]
    ds_read_b64_tr_b16 v[228:229], v7 offset:12288
    ds_read_b64_tr_b16 v[230:231], v7 offset:12800
    ds_read_b128 v[44:47], v11 offset:8192
    s_waitcnt lgkmcnt(10)
    v_mfma_f32_32x32x16_bf16 v[160:175], v[236:239], v[24:27], v[160:175]
    ds_read_b64_tr_b16 v[232:233], v6 offset:6144
    ds_read_b64_tr_b16 v[234:235], v6 offset:6656
    s_waitcnt lgkmcnt(2)
    s_add_u32 m0, s49, 73216
    s_nop 0
    buffer_load_dwordx4 v2, s[8:11], 0 offen offset:512 lds
    v_mfma_f32_32x32x16_bf16 v[176:191], v[240:243], v[24:27], v[176:191]
    ds_read_b64_tr_b16 v[236:237], v7 offset:6144
    ds_read_b64_tr_b16 v[238:239], v7 offset:6656
    s_add_u32 m0, s49, 97792
    s_nop 0
    buffer_load_dwordx4 v3, s[8:11], 0 offen offset:512 lds
    v_mfma_f32_32x32x16_bf16 v[192:207], v[224:227], v[24:27], v[192:207]
    ds_read_b64_tr_b16 v[240:241], v6 offset:14336
    ds_read_b64_tr_b16 v[242:243], v6 offset:14848
    s_add_u32 m0, s49, 122368
    s_nop 0
    buffer_load_dwordx4 v2, s[8:11], s64 offen offset:512 lds
    v_mfma_f32_32x32x16_bf16 v[208:223], v[228:231], v[24:27], v[208:223]
    ds_read_b64_tr_b16 v[224:225], v7 offset:14336
    ds_read_b64_tr_b16 v[226:227], v7 offset:14848
    s_add_u32 m0, s49, 146944
    s_nop 0
    buffer_load_dwordx4 v3, s[8:11], s64 offen offset:512 lds
    s_waitcnt lgkmcnt(6)
    v_mfma_f32_32x32x16_bf16 v[160:175], v[232:235], v[28:31], v[160:175]
    s_waitcnt vmcnt(22)
    s_barrier
    ds_read_b64_tr_b16 v[228:229], v6 offset:16384
    ds_read_b64_tr_b16 v[230:231], v6 offset:16896
    buffer_load_dword v254, off, s[40:43], 0 sc1
    s_waitcnt lgkmcnt(6)
    v_mfma_f32_32x32x16_bf16 v[176:191], v[236:239], v[28:31], v[176:191]
    ds_read_b64_tr_b16 v[232:233], v7 offset:16384
    ds_read_b64_tr_b16 v[234:235], v7 offset:16896
    s_add_u32 m0, s49, 0
    s_nop 0
    buffer_load_dwordx4 v4, s[16:19], s60 offen lds
    s_add_u32 s60, s60, 589824
    s_waitcnt lgkmcnt(6)
    v_mfma_f32_32x32x16_bf16 v[192:207], v[240:243], v[28:31], v[192:207]
    ds_read_b64_tr_b16 v[236:237], v6 offset:24576
    ds_read_b64_tr_b16 v[238:239], v6 offset:25088
    s_lshl_b32 s52, s2, 3
    s_add_u32 s52, s52, s46
    s_lshl_b32 s52, s52, 7
    s_add_u32 s52, s52, 524288
    v_mul_u32_u24 v129, 1061888, v0
    s_mov_b64 exec, 31
    buffer_load_dword v128, v129, s[24:27], s52 offen
    s_mov_b64 exec, -1
    s_waitcnt lgkmcnt(6)
    v_mfma_f32_32x32x16_bf16 v[208:223], v[224:227], v[28:31], v[208:223]
    ds_read_b64_tr_b16 v[240:241], v7 offset:24576
    ds_read_b64_tr_b16 v[242:243], v7 offset:25088
    s_add_u32 m0, s49, 8192
    s_nop 0
    buffer_load_dwordx4 v4, s[16:19], s61 offen lds
    s_add_u32 s61, s61, 589824
    s_waitcnt lgkmcnt(6)
    v_mfma_f32_32x32x16_bf16 v[160:175], v[228:231], v[32:35], v[160:175]
    s_waitcnt vmcnt(14)
    v_mov_b32 v244, 0
    v_mov_b32 v245, 0
    v_lshlrev_b32 v246, 16, v144
    ds_read_b64_tr_b16 v[224:225], v6 offset:18432
    ds_read_b64_tr_b16 v[226:227], v6 offset:18944
    ds_read_b128 v[48:51], v8 offset:16384
    s_waitcnt lgkmcnt(7)
    v_mfma_f32_32x32x16_bf16 v[176:191], v[232:235], v[32:35], v[176:191]
    v_and_b32 v247, 0xffff0000, v144
    v_lshlrev_b32 v248, 16, v152
    v_and_b32 v249, 0xffff0000, v152
    v_mul_f32 v246, v246, v248
    ds_read_b64_tr_b16 v[228:229], v7 offset:18432
    ds_read_b64_tr_b16 v[230:231], v7 offset:18944
    ds_read_b128 v[52:55], v9 offset:16384
    s_waitcnt lgkmcnt(8)
    v_mfma_f32_32x32x16_bf16 v[192:207], v[236:239], v[32:35], v[192:207]
    v_mul_f32 v247, v247, v249
    v_cvt_pk_bf16_f32 v246, v246, v247
    v_lshlrev_b32 v247, 16, v246
    ds_read_b64_tr_b16 v[232:233], v6 offset:26624
    ds_read_b64_tr_b16 v[234:235], v6 offset:27136
    ds_read_b128 v[56:59], v10 offset:16384
    s_waitcnt lgkmcnt(9)
    v_mfma_f32_32x32x16_bf16 v[208:223], v[240:243], v[32:35], v[208:223]
    v_and_b32 v246, 0xffff0000, v246
    v_add_f32 v244, v244, v247
    v_add_f32 v245, v245, v246
    v_lshlrev_b32 v246, 16, v145
    ds_read_b64_tr_b16 v[236:237], v7 offset:26624
    ds_read_b64_tr_b16 v[238:239], v7 offset:27136
    ds_read_b128 v[60:63], v11 offset:16384
    s_waitcnt lgkmcnt(10)
    v_mfma_f32_32x32x16_bf16 v[160:175], v[224:227], v[36:39], v[160:175]
    v_and_b32 v247, 0xffff0000, v145
    v_lshlrev_b32 v248, 16, v153
    v_and_b32 v249, 0xffff0000, v153
    ds_read_b64_tr_b16 v[240:241], v6 offset:20480
    ds_read_b64_tr_b16 v[242:243], v6 offset:20992
    s_waitcnt lgkmcnt(9)
    v_mfma_f32_32x32x16_bf16 v[176:191], v[228:231], v[36:39], v[176:191]
    v_mul_f32 v246, v246, v248
    v_mul_f32 v247, v247, v249
    v_cvt_pk_bf16_f32 v246, v246, v247
    v_lshlrev_b32 v247, 16, v246
    ds_read_b64_tr_b16 v[224:225], v7 offset:20480
    ds_read_b64_tr_b16 v[226:227], v7 offset:20992
    s_lshl_b32 s54, s44, 3
    s_add_u32 s54, s54, s46
    v_and_b32 v1, 15, v0
    v_lshl_add_u32 v1, v1, 6, s54
    v_mul_u32_u24 v250, 9216, v1
    s_bfe_u32 s55, s73, 0x20002
    s_lshl_b32 s55, s55, 7
    s_add_u32 s55, s55, 8832
    v_mov_b32 v1, s62
    v_mov_b32 v251, s55
    v_cmp_gt_u32 vcc, 16, v0
    s_nop 1
    v_cndmask_b32 v1, v251, v1, vcc
    v_add_u32 v250, v250, v1
    s_and_b32 s55, s73, 0x1f3
    s_cmp_eq_u32 s55, 0
    s_mov_b64 exec, 0x1ff
    s_cselect_b32 exec_lo, 0x1ff01ff, exec_lo
    buffer_load_dword v251, v250, s[16:19], 0 offen
    s_mov_b64 exec, -1
    s_waitcnt lgkmcnt(8)
    v_mfma_f32_32x32x16_bf16 v[192:207], v[232:235], v[36:39], v[192:207]
    v_and_b32 v246, 0xffff0000, v246
    v_add_f32 v244, v244, v247
    v_add_f32 v245, v245, v246
    ds_read_b64_tr_b16 v[228:229], v6 offset:28672
    ds_read_b64_tr_b16 v[230:231], v6 offset:29184
    s_lshl_b32 s52, s2, 3
    s_add_u32 s52, s52, s46
    s_lshl_b32 s52, s52, 7
    s_add_u32 s52, s52, 786432
    v_mul_u32_u24 v129, 1061888, v0
    s_mov_b64 exec, 31
    buffer_load_dword v128, v129, s[24:27], s52 offen
    s_mov_b64 exec, -1
    s_waitcnt lgkmcnt(7)
    v_mfma_f32_32x32x16_bf16 v[208:223], v[236:239], v[36:39], v[208:223]
    v_lshlrev_b32 v246, 16, v146
    v_and_b32 v247, 0xffff0000, v146
    v_lshlrev_b32 v248, 16, v154
    v_and_b32 v249, 0xffff0000, v154
    ds_read_b64_tr_b16 v[232:233], v7 offset:28672
    ds_read_b64_tr_b16 v[234:235], v7 offset:29184
    s_waitcnt lgkmcnt(6)
    v_mfma_f32_32x32x16_bf16 v[160:175], v[240:243], v[40:43], v[160:175]
    v_mul_f32 v246, v246, v248
    v_mul_f32 v247, v247, v249
    v_cvt_pk_bf16_f32 v246, v246, v247
    ds_read_b64_tr_b16 v[236:237], v6 offset:22528
    ds_read_b64_tr_b16 v[238:239], v6 offset:23040
    s_add_u32 m0, s49, 81280
    s_nop 0
    buffer_load_dwordx4 v2, s[8:11], 0 offen offset:640 lds
    s_waitcnt lgkmcnt(6)
    v_mfma_f32_32x32x16_bf16 v[176:191], v[224:227], v[40:43], v[176:191]
    v_lshlrev_b32 v247, 16, v246
    v_and_b32 v246, 0xffff0000, v246
    v_add_f32 v244, v244, v247
    v_add_f32 v245, v245, v246
    ds_read_b64_tr_b16 v[240:241], v7 offset:22528
    ds_read_b64_tr_b16 v[242:243], v7 offset:23040
    s_add_u32 m0, s49, 105856
    s_nop 0
    buffer_load_dwordx4 v3, s[8:11], 0 offen offset:640 lds
    s_waitcnt lgkmcnt(6)
    v_mfma_f32_32x32x16_bf16 v[192:207], v[228:231], v[40:43], v[192:207]
    v_lshlrev_b32 v246, 16, v147
    v_and_b32 v247, 0xffff0000, v147
    v_lshlrev_b32 v248, 16, v155
    ds_read_b64_tr_b16 v[224:225], v6 offset:30720
    ds_read_b64_tr_b16 v[226:227], v6 offset:31232
    s_add_u32 m0, s49, 130432
    s_nop 0
    buffer_load_dwordx4 v2, s[8:11], s64 offen offset:640 lds
    s_waitcnt lgkmcnt(6)
    v_mfma_f32_32x32x16_bf16 v[208:223], v[232:235], v[40:43], v[208:223]
    v_and_b32 v249, 0xffff0000, v155
    v_mul_f32 v246, v246, v248
    v_mul_f32 v247, v247, v249
    v_cvt_pk_bf16_f32 v246, v246, v247
    ds_read_b64_tr_b16 v[228:229], v7 offset:30720
    ds_read_b64_tr_b16 v[230:231], v7 offset:31232
    s_add_u32 m0, s49, 155008
    s_nop 0
    buffer_load_dwordx4 v3, s[8:11], s64 offen offset:640 lds
    s_waitcnt lgkmcnt(6)
    v_mfma_f32_32x32x16_bf16 v[160:175], v[236:239], v[44:47], v[160:175]
    v_lshlrev_b32 v247, 16, v246
    v_and_b32 v246, 0xffff0000, v246
    v_add_f32 v244, v244, v247
    s_barrier
    ds_read_b64_tr_b16 v[232:233], v6 offset:32768
    ds_read_b64_tr_b16 v[234:235], v6 offset:33280
    s_waitcnt lgkmcnt(6)
    v_mfma_f32_32x32x16_bf16 v[176:191], v[240:243], v[44:47], v[176:191]
    v_add_f32 v245, v245, v246
    v_lshlrev_b32 v246, 16, v148
    v_and_b32 v247, 0xffff0000, v148
    v_lshlrev_b32 v248, 16, v156
    ds_read_b64_tr_b16 v[236:237], v7 offset:32768
    ds_read_b64_tr_b16 v[238:239], v7 offset:33280
    s_add_u32 m0, s49, 16384
    s_nop 0
    buffer_load_dwordx4 v4, s[16:19], s60 offen lds
    s_add_u32 s60, s60, 589824
    s_waitcnt lgkmcnt(6)
    v_mfma_f32_32x32x16_bf16 v[192:207], v[224:227], v[44:47], v[192:207]
    v_and_b32 v249, 0xffff0000, v156
    v_mul_f32 v246, v246, v248
    v_mul_f32 v247, v247, v249
    ds_read_b64_tr_b16 v[240:241], v6 offset:40960
    ds_read_b64_tr_b16 v[242:243], v6 offset:41472
    s_lshl_b32 s52, s2, 3
    s_add_u32 s52, s52, s46
    s_lshl_b32 s52, s52, 7
    v_mul_u32_u24 v129, 200704, v0
    s_mov_b64 exec, 7
    buffer_load_dword v128, v129, s[28:31], s52 offen
    s_mov_b64 exec, -1
    s_waitcnt lgkmcnt(6)
    v_mfma_f32_32x32x16_bf16 v[208:223], v[228:231], v[44:47], v[208:223]
    v_cvt_pk_bf16_f32 v246, v246, v247
    v_lshlrev_b32 v247, 16, v246
    v_and_b32 v246, 0xffff0000, v246
    v_add_f32 v244, v244, v247
    ds_read_b64_tr_b16 v[224:225], v7 offset:40960
    ds_read_b64_tr_b16 v[226:227], v7 offset:41472
    s_add_u32 m0, s49, 24576
    s_nop 0
    buffer_load_dwordx4 v4, s[16:19], s61 offen lds
    s_add_u32 s61, s61, 589824
    s_waitcnt lgkmcnt(6)
    v_mfma_f32_32x32x16_bf16 v[160:175], v[232:235], v[48:51], v[160:175]
    v_add_f32 v245, v245, v246
    v_lshlrev_b32 v246, 16, v149
    v_and_b32 v247, 0xffff0000, v149
    ds_read_b64_tr_b16 v[228:229], v6 offset:34816
    ds_read_b64_tr_b16 v[230:231], v6 offset:35328
    s_waitcnt vmcnt(18)
    ds_read_b128 v[64:67], v8 offset:0
    s_waitcnt lgkmcnt(7)
    v_mfma_f32_32x32x16_bf16 v[176:191], v[236:239], v[48:51], v[176:191]
    v_lshlrev_b32 v248, 16, v157
    v_and_b32 v249, 0xffff0000, v157
    v_mul_f32 v246, v246, v248
    v_mul_f32 v247, v247, v249
    ds_read_b64_tr_b16 v[232:233], v7 offset:34816
    ds_read_b64_tr_b16 v[234:235], v7 offset:35328
    ds_read_b128 v[68:71], v9 offset:0
    s_waitcnt lgkmcnt(8)
    v_mfma_f32_32x32x16_bf16 v[192:207], v[240:243], v[48:51], v[192:207]
    v_cvt_pk_bf16_f32 v246, v246, v247
    v_lshlrev_b32 v247, 16, v246
    v_and_b32 v246, 0xffff0000, v246
    ds_read_b64_tr_b16 v[236:237], v6 offset:43008
    ds_read_b64_tr_b16 v[238:239], v6 offset:43520
    ds_read_b128 v[72:75], v10 offset:0
    s_waitcnt lgkmcnt(9)
    v_mfma_f32_32x32x16_bf16 v[208:223], v[224:227], v[48:51], v[208:223]
    v_add_f32 v244, v244, v247
    v_add_f32 v245, v245, v246
    v_lshlrev_b32 v246, 16, v150
    v_and_b32 v247, 0xffff0000, v150
    ds_read_b64_tr_b16 v[240:241], v7 offset:43008
    ds_read_b64_tr_b16 v[242:243], v7 offset:43520
    ds_read_b128 v[76:79], v11 offset:0
    s_waitcnt lgkmcnt(10)
    v_mfma_f32_32x32x16_bf16 v[160:175], v[228:231], v[52:55], v[160:175]
    v_lshlrev_b32 v248, 16, v158
    v_and_b32 v249, 0xffff0000, v158
    v_mul_f32 v246, v246, v248
    ds_read_b64_tr_b16 v[224:225], v6 offset:36864
    ds_read_b64_tr_b16 v[226:227], v6 offset:37376
    s_waitcnt lgkmcnt(9)
    v_mfma_f32_32x32x16_bf16 v[176:191], v[232:235], v[52:55], v[176:191]
    v_mul_f32 v247, v247, v249
    v_cvt_pk_bf16_f32 v246, v246, v247
    v_lshlrev_b32 v247, 16, v246
    v_and_b32 v246, 0xffff0000, v246
    ds_read_b64_tr_b16 v[228:229], v7 offset:36864
    ds_read_b64_tr_b16 v[230:231], v7 offset:37376
    s_waitcnt lgkmcnt(8)
    v_mfma_f32_32x32x16_bf16 v[192:207], v[236:239], v[52:55], v[192:207]
    v_add_f32 v244, v244, v247
    v_add_f32 v245, v245, v246
    v_lshlrev_b32 v246, 16, v151
    ds_read_b64_tr_b16 v[232:233], v6 offset:45056
    ds_read_b64_tr_b16 v[234:235], v6 offset:45568
    s_waitcnt lgkmcnt(7)
    v_mfma_f32_32x32x16_bf16 v[208:223], v[240:243], v[52:55], v[208:223]
    v_and_b32 v247, 0xffff0000, v151
    v_lshlrev_b32 v248, 16, v159
    v_and_b32 v249, 0xffff0000, v159
    v_mul_f32 v246, v246, v248
    ds_read_b64_tr_b16 v[236:237], v7 offset:45056
    ds_read_b64_tr_b16 v[238:239], v7 offset:45568
    s_waitcnt lgkmcnt(6)
    v_mfma_f32_32x32x16_bf16 v[160:175], v[224:227], v[56:59], v[160:175]
    v_mul_f32 v247, v247, v249
    v_cvt_pk_bf16_f32 v246, v246, v247
    v_lshlrev_b32 v247, 16, v246
    ds_read_b64_tr_b16 v[240:241], v6 offset:38912
    ds_read_b64_tr_b16 v[242:243], v6 offset:39424
    s_add_u32 m0, s49, 64768
    s_nop 0
    buffer_load_dwordx4 v2, s[8:11], 0 offen offset:768 lds
    s_waitcnt lgkmcnt(6)
    v_mfma_f32_32x32x16_bf16 v[176:191], v[228:231], v[56:59], v[176:191]
    v_and_b32 v246, 0xffff0000, v246
    v_add_f32 v244, v244, v247
    v_add_f32 v245, v245, v246
    ds_read_b64_tr_b16 v[224:225], v7 offset:38912
    ds_read_b64_tr_b16 v[226:227], v7 offset:39424
    s_add_u32 m0, s49, 89344
    s_nop 0
    buffer_load_dwordx4 v3, s[8:11], 0 offen offset:768 lds
    s_waitcnt lgkmcnt(6)
    v_mfma_f32_32x32x16_bf16 v[192:207], v[232:235], v[56:59], v[192:207]
    v_add_f32 v244, v244, v245
    ds_read_b64_tr_b16 v[228:229], v6 offset:47104
    ds_read_b64_tr_b16 v[230:231], v6 offset:47616
    s_add_u32 m0, s49, 113920
    s_nop 0
    buffer_load_dwordx4 v2, s[8:11], s64 offen offset:768 lds
    s_waitcnt lgkmcnt(6)
    v_mfma_f32_32x32x16_bf16 v[208:223], v[236:239], v[56:59], v[208:223]
    v_add_f32_dpp v244, v244, v244 row_shr:1 row_mask:0xf bank_mask:0xf bound_ctrl:0
    ds_read_b64_tr_b16 v[232:233], v7 offset:47104
    ds_read_b64_tr_b16 v[234:235], v7 offset:47616
    s_add_u32 m0, s49, 138496
    s_nop 0
    buffer_load_dwordx4 v3, s[8:11], s64 offen offset:768 lds
    s_waitcnt lgkmcnt(6)
    v_mfma_f32_32x32x16_bf16 v[160:175], v[240:243], v[60:63], v[160:175]
    v_add_f32_dpp v244, v244, v244 row_shr:2 row_mask:0xf bank_mask:0xf bound_ctrl:0
    s_barrier
    ds_read_b64_tr_b16 v[236:237], v6 offset:49152
    ds_read_b64_tr_b16 v[238:239], v6 offset:49664
    s_waitcnt lgkmcnt(6)
    v_mfma_f32_32x32x16_bf16 v[176:191], v[224:227], v[60:63], v[176:191]
    v_add_f32_dpp v244, v244, v244 row_shr:4 row_mask:0xf bank_mask:0xf bound_ctrl:0
    s_nop 1
    v_add_f32_dpp v244, v244, v244 row_shr:8 row_mask:0xf bank_mask:0xf bound_ctrl:0
    ds_read_b64_tr_b16 v[240:241], v7 offset:49152
    ds_read_b64_tr_b16 v[242:243], v7 offset:49664
    s_add_u32 m0, s49, 32768
    s_nop 0
    buffer_load_dwordx4 v4, s[16:19], s60 offen lds
    s_add_u32 s60, s60, 589824
    s_waitcnt lgkmcnt(6)
    v_mfma_f32_32x32x16_bf16 v[192:207], v[228:231], v[60:63], v[192:207]
    v_add_f32_dpp v244, v244, v244 row_bcast:15 row_mask:0xa bank_mask:0xf
    ds_read_b64_tr_b16 v[224:225], v6 offset:57344
    ds_read_b64_tr_b16 v[226:227], v6 offset:57856
    s_waitcnt lgkmcnt(6)
    v_mfma_f32_32x32x16_bf16 v[208:223], v[232:235], v[60:63], v[208:223]
    v_add_f32_dpp v244, v244, v244 row_bcast:31 row_mask:0xc bank_mask:0xf
    v_cvt_pk_bf16_f32 v244, v244, v244
    v_and_b32 v244, 0xffff0000, v244
    v_mul_f32 v244, s51, v244
    ds_read_b64_tr_b16 v[228:229], v7 offset:57344
    ds_read_b64_tr_b16 v[230:231], v7 offset:57856
    s_add_u32 m0, s49, 40960
    s_nop 0
    buffer_load_dwordx4 v4, s[16:19], s61 offen lds
    s_add_u32 s61, s61, 589824
    s_waitcnt lgkmcnt(6)
    v_mfma_f32_32x32x16_bf16 v[160:175], v[236:239], v[64:67], v[160:175]
    v_exp_f32 v244, v244
    ds_read_b64_tr_b16 v[232:233], v6 offset:51200
    ds_read_b64_tr_b16 v[234:235], v6 offset:51712
    s_waitcnt vmcnt(19)
    ds_read_b128 v[80:83], v8 offset:8192
    s_waitcnt lgkmcnt(7)
    v_mfma_f32_32x32x16_bf16 v[176:191], v[240:243], v[64:67], v[176:191]
    v_add_f32 v244, 1.0, v244
    v_rcp_f32 v244, v244
    ds_read_b64_tr_b16 v[236:237], v7 offset:51200
    ds_read_b64_tr_b16 v[238:239], v7 offset:51712
    ds_read_b128 v[84:87], v9 offset:8192
    s_waitcnt lgkmcnt(8)
    v_mfma_f32_32x32x16_bf16 v[192:207], v[224:227], v[64:67], v[192:207]
    v_cvt_pk_bf16_f32 v244, v244, v244
    v_and_b32 v244, 0xffff0000, v244
    v_sub_f32 v245, 1.0, v244
    ds_read_b64_tr_b16 v[240:241], v6 offset:59392
    ds_read_b64_tr_b16 v[242:243], v6 offset:59904
    ds_read_b128 v[88:91], v10 offset:8192
    s_waitcnt lgkmcnt(9)
    v_mfma_f32_32x32x16_bf16 v[208:223], v[228:231], v[64:67], v[208:223]
    v_cvt_pk_bf16_f32 v244, v244, v245
    s_waitcnt vmcnt(18)
    s_mov_b32 s59, 30000
L_ngl_20:
    v_readfirstlane_b32 s50, v254
    s_nop 0
    s_cmp_lg_u32 s50, 0
    s_cbranch_scc1 L_ng_19
    buffer_load_dword v254, off, s[40:43], 0 sc1
    s_waitcnt vmcnt(0)
    s_sub_u32 s59, s59, 1
    s_cmp_lg_u32 s59, 0
    s_cbranch_scc1 L_ngl_20
L_ng_19:
    v_mov_b32 v245, s50
    buffer_store_dwordx2 v[244:245], v253, s[20:23], s71 offen sc1
    ds_read_b64_tr_b16 v[224:225], v7 offset:59392
    ds_read_b64_tr_b16 v[226:227], v7 offset:59904
    ds_read_b128 v[92:95], v11 offset:8192
    s_waitcnt lgkmcnt(10)
    v_mfma_f32_32x32x16_bf16 v[160:175], v[232:235], v[68:71], v[160:175]
    ds_read_b64_tr_b16 v[228:229], v6 offset:53248
    ds_read_b64_tr_b16 v[230:231], v6 offset:53760
    s_waitcnt lgkmcnt(9)
    v_mfma_f32_32x32x16_bf16 v[176:191], v[236:239], v[68:71], v[176:191]
    ds_read_b64_tr_b16 v[232:233], v7 offset:53248
    ds_read_b64_tr_b16 v[234:235], v7 offset:53760
    s_waitcnt lgkmcnt(8)
    v_mfma_f32_32x32x16_bf16 v[192:207], v[240:243], v[68:71], v[192:207]
    ds_read_b64_tr_b16 v[236:237], v6 offset:61440
    ds_read_b64_tr_b16 v[238:239], v6 offset:61952
    s_waitcnt lgkmcnt(7)
    v_mfma_f32_32x32x16_bf16 v[208:223], v[224:227], v[68:71], v[208:223]
    ds_read_b64_tr_b16 v[240:241], v7 offset:61440
    ds_read_b64_tr_b16 v[242:243], v7 offset:61952
    s_waitcnt lgkmcnt(6)
    v_mfma_f32_32x32x16_bf16 v[160:175], v[228:231], v[72:75], v[160:175]
    ds_read_b64_tr_b16 v[224:225], v6 offset:55296
    ds_read_b64_tr_b16 v[226:227], v6 offset:55808
    s_add_u32 m0, s49, 72832
    s_nop 0
    buffer_load_dwordx4 v2, s[8:11], 0 offen offset:896 lds
    s_waitcnt lgkmcnt(6)
    v_mfma_f32_32x32x16_bf16 v[176:191], v[232:235], v[72:75], v[176:191]
    ds_read_b64_tr_b16 v[228:229], v7 offset:55296
    ds_read_b64_tr_b16 v[230:231], v7 offset:55808
    s_add_u32 m0, s49, 97408
    s_nop 0
    buffer_load_dwordx4 v3, s[8:11], 0 offen offset:896 lds
    s_waitcnt lgkmcnt(6)
    v_mfma_f32_32x32x16_bf16 v[192:207], v[236:239], v[72:75], v[192:207]
    ds_read_b64_tr_b16 v[232:233], v6 offset:63488
    ds_read_b64_tr_b16 v[234:235], v6 offset:64000
    s_add_u32 m0, s49, 121984
    s_nop 0
    buffer_load_dwordx4 v2, s[8:11], s64 offen offset:896 lds
    s_waitcnt lgkmcnt(6)
    v_mfma_f32_32x32x16_bf16 v[208:223], v[240:243], v[72:75], v[208:223]
    ds_read_b64_tr_b16 v[236:237], v7 offset:63488
    ds_read_b64_tr_b16 v[238:239], v7 offset:64000
    s_add_u32 m0, s49, 146560
    s_nop 0
    buffer_load_dwordx4 v3, s[8:11], s64 offen offset:896 lds
    s_waitcnt lgkmcnt(6)
    v_mfma_f32_32x32x16_bf16 v[160:175], v[224:227], v[76:79], v[160:175]
    s_waitcnt vmcnt(20)
    s_barrier
    ds_read_b64_tr_b16 v[240:241], v6 offset:0
    ds_read_b64_tr_b16 v[242:243], v6 offset:512
    s_waitcnt lgkmcnt(6)
    v_mfma_f32_32x32x16_bf16 v[176:191], v[228:231], v[76:79], v[176:191]
    ds_read_b64_tr_b16 v[224:225], v7 offset:0
    ds_read_b64_tr_b16 v[226:227], v7 offset:512
    s_add_u32 m0, s49, 49152
    s_nop 0
    buffer_load_dwordx4 v4, s[16:19], s60 offen lds
    s_add_u32 s60, s60, 589824
    s_waitcnt lgkmcnt(6)
    v_mfma_f32_32x32x16_bf16 v[192:207], v[232:235], v[76:79], v[192:207]
    ds_read_b64_tr_b16 v[228:229], v6 offset:8192
    ds_read_b64_tr_b16 v[230:231], v6 offset:8704
    s_waitcnt lgkmcnt(6)
    v_mfma_f32_32x32x16_bf16 v[208:223], v[236:239], v[76:79], v[208:223]
    ds_read_b64_tr_b16 v[232:233], v7 offset:8192
    ds_read_b64_tr_b16 v[234:235], v7 offset:8704
    s_add_u32 m0, s49, 57344
    s_nop 0
    buffer_load_dwordx4 v4, s[16:19], s61 offen lds
    s_add_u32 s61, s61, 589824
    s_waitcnt lgkmcnt(6)
    v_mfma_f32_32x32x16_bf16 v[160:175], v[240:243], v[80:83], v[160:175]
    ds_read_b64_tr_b16 v[236:237], v6 offset:2048
    ds_read_b64_tr_b16 v[238:239], v6 offset:2560
    s_waitcnt vmcnt(16)
    ds_read_b128 v[96:99], v8 offset:16384
    s_waitcnt lgkmcnt(7)
    v_mfma_f32_32x32x16_bf16 v[176:191], v[224:227], v[80:83], v[176:191]
    ds_read_b64_tr_b16 v[240:241], v7 offset:2048
    ds_read_b64_tr_b16 v[242:243], v7 offset:2560
    ds_read_b128 v[100:103], v9 offset:16384
    s_waitcnt lgkmcnt(8)
    v_mfma_f32_32x32x16_bf16 v[192:207], v[228:231], v[80:83], v[192:207]
    ds_read_b64_tr_b16 v[224:225], v6 offset:10240
    ds_read_b64_tr_b16 v[226:227], v6 offset:10752
    ds_read_b128 v[104:107], v10 offset:16384
    s_waitcnt lgkmcnt(9)
    v_mfma_f32_32x32x16_bf16 v[208:223], v[232:235], v[80:83], v[208:223]
    ds_read_b64_tr_b16 v[228:229], v7 offset:10240
    ds_read_b64_tr_b16 v[230:231], v7 offset:10752
    ds_read_b128 v[108:111], v11 offset:16384
    s_waitcnt lgkmcnt(10)
    v_mfma_f32_32x32x16_bf16 v[160:175], v[236:239], v[84:87], v[160:175]
    ds_read_b64_tr_b16 v[232:233], v6 offset:4096
    ds_read_b64_tr_b16 v[234:235], v6 offset:4608
    s_waitcnt lgkmcnt(9)
    v_mfma_f32_32x32x16_bf16 v[176:191], v[240:243], v[84:87], v[176:191]
    ds_read_b64_tr_b16 v[236:237], v7 offset:4096
    ds_read_b64_tr_b16 v[238:239], v7 offset:4608
    s_waitcnt lgkmcnt(8)
    v_mfma_f32_32x32x16_bf16 v[192:207], v[224:227], v[84:87], v[192:207]
    ds_read_b64_tr_b16 v[240:241], v6 offset:12288
    ds_read_b64_tr_b16 v[242:243], v6 offset:12800
    s_waitcnt lgkmcnt(7)
    v_mfma_f32_32x32x16_bf16 v[208:223], v[228:231], v[84:87], v[208:223]
    ds_read_b64_tr_b16 v[224:225], v7 offset:12288
    ds_read_b64_tr_b16 v[226:227], v7 offset:12800
    s_waitcnt lgkmcnt(6)
    v_mfma_f32_32x32x16_bf16 v[160:175], v[232:235], v[88:91], v[160:175]
    ds_read_b64_tr_b16 v[228:229], v6 offset:6144
    ds_read_b64_tr_b16 v[230:231], v6 offset:6656
    s_add_u32 m0, s49, 80896
    s_nop 0
    buffer_load_dwordx4 v2, s[8:11], 0 offen offset:1024 lds
    s_waitcnt lgkmcnt(6)
    v_mfma_f32_32x32x16_bf16 v[176:191], v[236:239], v[88:91], v[176:191]
    ds_read_b64_tr_b16 v[232:233], v7 offset:6144
    ds_read_b64_tr_b16 v[234:235], v7 offset:6656
    s_add_u32 m0, s49, 105472
    s_nop 0
    buffer_load_dwordx4 v3, s[8:11], 0 offen offset:1024 lds
    s_waitcnt lgkmcnt(6)
    v_mfma_f32_32x32x16_bf16 v[192:207], v[240:243], v[88:91], v[192:207]
    ds_read_b64_tr_b16 v[236:237], v6 offset:14336
    ds_read_b64_tr_b16 v[238:239], v6 offset:14848
    s_add_u32 m0, s49, 130048
    s_nop 0
    buffer_load_dwordx4 v2, s[8:11], s64 offen offset:1024 lds
    s_waitcnt lgkmcnt(6)
    v_mfma_f32_32x32x16_bf16 v[208:223], v[224:227], v[88:91], v[208:223]
    ds_read_b64_tr_b16 v[240:241], v7 offset:14336
    ds_read_b64_tr_b16 v[242:243], v7 offset:14848
    s_add_u32 m0, s49, 154624
    s_nop 0
    buffer_load_dwordx4 v3, s[8:11], s64 offen offset:1024 lds
    s_waitcnt lgkmcnt(6)
    v_mfma_f32_32x32x16_bf16 v[160:175], v[228:231], v[92:95], v[160:175]
    s_waitcnt vmcnt(17)
    s_barrier
    ds_read_b64_tr_b16 v[224:225], v6 offset:16384
    ds_read_b64_tr_b16 v[226:227], v6 offset:16896
    s_add_u32 m0, s49, 0
    s_nop 0
    buffer_load_dwordx4 v4, s[16:19], s60 offen lds
    s_waitcnt lgkmcnt(6)
    v_mfma_f32_32x32x16_bf16 v[176:191], v[232:235], v[92:95], v[176:191]
    ds_read_b64_tr_b16 v[228:229], v7 offset:16384
    ds_read_b64_tr_b16 v[230:231], v7 offset:16896
    s_add_u32 m0, s49, 8192
    s_nop 0
    buffer_load_dwordx4 v4, s[16:19], s61 offen lds
    s_waitcnt vmcnt(15)
    ds_read_b128 v[112:115], v8 offset:0
    s_waitcnt lgkmcnt(7)
    v_mfma_f32_32x32x16_bf16 v[192:207], v[236:239], v[92:95], v[192:207]
    ds_read_b64_tr_b16 v[232:233], v6 offset:18432
    ds_read_b64_tr_b16 v[234:235], v6 offset:18944
    ds_read_b128 v[116:119], v9 offset:0
    s_waitcnt lgkmcnt(8)
    v_mfma_f32_32x32x16_bf16 v[208:223], v[240:243], v[92:95], v[208:223]
    ds_read_b64_tr_b16 v[236:237], v7 offset:18432
    ds_read_b64_tr_b16 v[238:239], v7 offset:18944
    ds_read_b128 v[120:123], v10 offset:0
    s_waitcnt lgkmcnt(9)
    v_mfma_f32_32x32x16_bf16 v[160:175], v[224:227], v[96:99], v[160:175]
    ds_read_b64_tr_b16 v[240:241], v6 offset:20480
    ds_read_b64_tr_b16 v[242:243], v6 offset:20992
    ds_read_b128 v[124:127], v11 offset:0
    s_waitcnt lgkmcnt(10)
    v_mfma_f32_32x32x16_bf16 v[176:191], v[228:231], v[96:99], v[176:191]
    ds_read_b64_tr_b16 v[224:225], v7 offset:20480
    ds_read_b64_tr_b16 v[226:227], v7 offset:20992
    s_waitcnt lgkmcnt(9)
    v_mfma_f32_32x32x16_bf16 v[160:175], v[232:235], v[100:103], v[160:175]
    ds_read_b64_tr_b16 v[228:229], v6 offset:22528
    ds_read_b64_tr_b16 v[230:231], v6 offset:23040
    s_waitcnt lgkmcnt(4)
    s_add_u32 m0, s49, 90112
    s_nop 0
    buffer_load_dwordx4 v4, s[16:19], s62 offen lds
    s_add_u32 s62, s62, 589824
    v_mfma_f32_32x32x16_bf16 v[176:191], v[236:239], v[100:103], v[176:191]
    ds_read_b64_tr_b16 v[232:233], v7 offset:22528
    ds_read_b64_tr_b16 v[234:235], v7 offset:23040
    s_add_u32 m0, s49, 114688
    s_nop 0
    buffer_load_dwordx4 v4, s[16:19], s62 offen lds
    s_add_u32 s62, s62, 589824
    s_add_u32 m0, s49, 139264
    s_nop 0
    buffer_load_dwordx4 v4, s[16:19], s62 offen lds
    s_add_u32 s62, s62, 589824
    v_mfma_f32_32x32x16_bf16 v[160:175], v[240:243], v[104:107], v[160:175]
    s_waitcnt vmcnt(9)
    s_barrier
    ds_read_b64_tr_b16 v[236:237], v6 offset:32768
    ds_read_b64_tr_b16 v[238:239], v6 offset:33280
    s_waitcnt lgkmcnt(6)
    v_mfma_f32_32x32x16_bf16 v[176:191], v[224:227], v[104:107], v[176:191]
    ds_read_b64_tr_b16 v[240:241], v7 offset:32768
    ds_read_b64_tr_b16 v[242:243], v7 offset:33280
    ds_read_b128 v[128:131], v8 offset:8192
    s_waitcnt lgkmcnt(7)
    v_mfma_f32_32x32x16_bf16 v[160:175], v[228:231], v[108:111], v[160:175]
    ds_read_b64_tr_b16 v[224:225], v6 offset:34816
    ds_read_b64_tr_b16 v[226:227], v6 offset:35328
    ds_read_b128 v[132:135], v9 offset:8192
    s_waitcnt lgkmcnt(8)
    v_mfma_f32_32x32x16_bf16 v[176:191], v[232:235], v[108:111], v[176:191]
    ds_read_b64_tr_b16 v[228:229], v7 offset:34816
    ds_read_b64_tr_b16 v[230:231], v7 offset:35328
    ds_read_b128 v[136:139], v10 offset:8192
    s_waitcnt lgkmcnt(9)
    v_mfma_f32_32x32x16_bf16 v[160:175], v[236:239], v[112:115], v[160:175]
    ds_read_b64_tr_b16 v[232:233], v6 offset:36864
    ds_read_b64_tr_b16 v[234:235], v6 offset:37376
    ds_read_b128 v[140:143], v11 offset:8192
    s_waitcnt lgkmcnt(10)
    v_mfma_f32_32x32x16_bf16 v[176:191], v[240:243], v[112:115], v[176:191]
    ds_read_b64_tr_b16 v[236:237], v7 offset:36864
    ds_read_b64_tr_b16 v[238:239], v7 offset:37376
    s_waitcnt lgkmcnt(9)
    v_mfma_f32_32x32x16_bf16 v[160:175], v[224:227], v[116:119], v[160:175]
    ds_read_b64_tr_b16 v[240:241], v6 offset:38912
    ds_read_b64_tr_b16 v[242:243], v6 offset:39424
    s_waitcnt lgkmcnt(4)
    s_add_u32 m0, s49, 98304
    s_nop 0
    buffer_load_dwordx4 v4, s[16:19], s62 offen lds
    s_add_u32 s62, s62, 589824
    v_mfma_f32_32x32x16_bf16 v[176:191], v[228:231], v[116:119], v[176:191]
    ds_read_b64_tr_b16 v[224:225], v7 offset:38912
    ds_read_b64_tr_b16 v[226:227], v7 offset:39424
    s_add_u32 m0, s49, 122880
    s_nop 0
    buffer_load_dwordx4 v4, s[16:19], s62 offen lds
    s_add_u32 s62, s62, 589824
    s_add_u32 m0, s49, 147456
    s_nop 0
    buffer_load_dwordx4 v4, s[16:19], s62 offen lds
    s_add_u32 s62, s62, 589824
    v_mfma_f32_32x32x16_bf16 v[160:175], v[232:235], v[120:123], v[160:175]
    ds_read_b64_tr_b16 v[228:229], v6 offset:49152
    ds_read_b64_tr_b16 v[230:231], v6 offset:49664
    s_waitcnt lgkmcnt(6)
    v_mfma_f32_32x32x16_bf16 v[176:191], v[236:239], v[120:123], v[176:191]
    ds_read_b64_tr_b16 v[232:233], v7 offset:49152
    ds_read_b64_tr_b16 v[234:235], v7 offset:49664
    s_waitcnt vmcnt(8)
    ds_read_b128 v[144:147], v8 offset:16384
    s_waitcnt lgkmcnt(7)
    v_mfma_f32_32x32x16_bf16 v[160:175], v[240:243], v[124:127], v[160:175]
    ds_read_b64_tr_b16 v[236:237], v6 offset:51200
    ds_read_b64_tr_b16 v[238:239], v6 offset:51712
    ds_read_b128 v[148:151], v9 offset:16384
    s_waitcnt lgkmcnt(8)
    v_mfma_f32_32x32x16_bf16 v[176:191], v[224:227], v[124:127], v[176:191]
    ds_read_b64_tr_b16 v[240:241], v7 offset:51200
    ds_read_b64_tr_b16 v[242:243], v7 offset:51712
    ds_read_b128 v[152:155], v10 offset:16384
    s_waitcnt lgkmcnt(9)
    v_mfma_f32_32x32x16_bf16 v[160:175], v[228:231], v[128:131], v[160:175]
    ds_read_b64_tr_b16 v[224:225], v6 offset:53248
    ds_read_b64_tr_b16 v[226:227], v6 offset:53760
    ds_read_b128 v[156:159], v11 offset:16384
    s_waitcnt lgkmcnt(10)
    v_mfma_f32_32x32x16_bf16 v[176:191], v[232:235], v[128:131], v[176:191]
    ds_read_b64_tr_b16 v[228:229], v7 offset:53248
    ds_read_b64_tr_b16 v[230:231], v7 offset:53760
    s_waitcnt lgkmcnt(9)
    v_mfma_f32_32x32x16_bf16 v[160:175], v[236:239], v[132:135], v[160:175]
    ds_read_b64_tr_b16 v[232:233], v6 offset:55296
    ds_read_b64_tr_b16 v[234:235], v6 offset:55808
    s_waitcnt lgkmcnt(4)
    s_add_u32 m0, s49, 106496
    s_nop 0
    buffer_load_dwordx4 v4, s[16:19], s62 offen lds
    s_add_u32 s62, s62, 589824
    v_mfma_f32_32x32x16_bf16 v[176:191], v[240:243], v[132:135], v[176:191]
    ds_read_b64_tr_b16 v[236:237], v7 offset:55296
    ds_read_b64_tr_b16 v[238:239], v7 offset:55808
    s_add_u32 m0, s49, 131072
    s_nop 0
    buffer_load_dwordx4 v4, s[16:19], s62 offen lds
    s_add_u32 s62, s62, 589824
    s_add_u32 m0, s49, 155648
    s_nop 0
    buffer_load_dwordx4 v4, s[16:19], s62 offen lds
    v_mfma_f32_32x32x16_bf16 v[160:175], v[224:227], v[136:139], v[160:175]
    s_waitcnt vmcnt(9)
    s_barrier
    ds_read_b64_tr_b16 v[240:241], v6 offset:0
    ds_read_b64_tr_b16 v[242:243], v6 offset:512
    s_waitcnt lgkmcnt(6)
    v_mfma_f32_32x32x16_bf16 v[176:191], v[228:231], v[136:139], v[176:191]
    ds_read_b64_tr_b16 v[224:225], v6 offset:2048
    ds_read_b64_tr_b16 v[226:227], v6 offset:2560
    s_waitcnt lgkmcnt(6)
    v_mfma_f32_32x32x16_bf16 v[160:175], v[232:235], v[140:143], v[160:175]
    ds_read_b64_tr_b16 v[228:229], v6 offset:4096
    ds_read_b64_tr_b16 v[230:231], v6 offset:4608
    s_waitcnt lgkmcnt(6)
    v_mfma_f32_32x32x16_bf16 v[176:191], v[236:239], v[140:143], v[176:191]
    ds_read_b64_tr_b16 v[232:233], v6 offset:6144
    ds_read_b64_tr_b16 v[234:235], v6 offset:6656
    s_waitcnt lgkmcnt(6)
    v_mfma_f32_32x32x16_bf16 v[160:175], v[240:243], v[144:147], v[160:175]
    ds_read_b64_tr_b16 v[236:237], v7 offset:0
    ds_read_b64_tr_b16 v[238:239], v7 offset:512
    s_waitcnt lgkmcnt(6)
    v_mfma_f32_32x32x16_bf16 v[160:175], v[224:227], v[148:151], v[160:175]
    ds_read_b64_tr_b16 v[240:241], v7 offset:2048
    ds_read_b64_tr_b16 v[242:243], v7 offset:2560
    s_waitcnt lgkmcnt(6)
    v_mfma_f32_32x32x16_bf16 v[160:175], v[228:231], v[152:155], v[160:175]
    ds_read_b64_tr_b16 v[224:225], v7 offset:4096
    ds_read_b64_tr_b16 v[226:227], v7 offset:4608
    s_waitcnt lgkmcnt(6)
    v_mfma_f32_32x32x16_bf16 v[160:175], v[232:235], v[156:159], v[160:175]
    ds_read_b64_tr_b16 v[228:229], v7 offset:6144
    ds_read_b64_tr_b16 v[230:231], v7 offset:6656
    s_waitcnt lgkmcnt(6)
    v_mfma_f32_32x32x16_bf16 v[176:191], v[236:239], v[144:147], v[176:191]
    ds_read_b64_tr_b16 v[232:233], v6 offset:24576
    ds_read_b64_tr_b16 v[234:235], v6 offset:25088
    s_waitcnt lgkmcnt(6)
    v_mfma_f32_32x32x16_bf16 v[176:191], v[240:243], v[148:151], v[176:191]
    ds_read_b64_tr_b16 v[236:237], v6 offset:26624
    ds_read_b64_tr_b16 v[238:239], v6 offset:27136
    s_waitcnt lgkmcnt(6)
    v_mfma_f32_32x32x16_bf16 v[176:191], v[224:227], v[152:155], v[176:191]
    v_pk_mul_f32 v[244:245], v[160:161], s[50:51] op_sel:[0,1] op_sel_hi:[1,1]
    v_pk_mul_f32 v[246:247], v[162:163], s[50:51] op_sel:[0,1] op_sel_hi:[1,1]
    v_pk_mul_f32 v[248:249], v[164:165], s[50:51] op_sel:[0,1] op_sel_hi:[1,1]
    v_pk_mul_f32 v[250:251], v[166:167], s[50:51] op_sel:[0,1] op_sel_hi:[1,1]
    v_exp_f32 v244, v244
    ds_read_b64_tr_b16 v[240:241], v6 offset:28672
    ds_read_b64_tr_b16 v[242:243], v6 offset:29184
    v_lshlrev_b32 v2, 7, v0
    s_mov_b64 exec, 0x3ff
    buffer_load_dword v3, v2, s[24:27], s6 offen
    s_add_u32 s6, s6, 327680
    s_mov_b64 exec, -1
    s_waitcnt lgkmcnt(6)
    v_mfma_f32_32x32x16_bf16 v[176:191], v[228:231], v[156:159], v[176:191]
    v_exp_f32 v245, v245
    v_exp_f32 v246, v246
    ds_read_b64_tr_b16 v[224:225], v6 offset:30720
    ds_read_b64_tr_b16 v[226:227], v6 offset:31232
    s_waitcnt lgkmcnt(6)
    v_mfma_f32_32x32x16_bf16 v[192:207], v[232:235], v[96:99], v[192:207]
    v_exp_f32 v247, v247
    v_exp_f32 v248, v248
    ds_read_b64_tr_b16 v[228:229], v6 offset:40960
    ds_read_b64_tr_b16 v[230:231], v6 offset:41472
    s_waitcnt lgkmcnt(6)
    v_mfma_f32_32x32x16_bf16 v[192:207], v[236:239], v[100:103], v[192:207]
    v_exp_f32 v249, v249
    v_exp_f32 v250, v250
    v_exp_f32 v251, v251
    ds_read_b64_tr_b16 v[232:233], v6 offset:43008
    ds_read_b64_tr_b16 v[234:235], v6 offset:43520
    s_waitcnt lgkmcnt(6)
    v_mfma_f32_32x32x16_bf16 v[192:207], v[240:243], v[104:107], v[192:207]
    v_pk_add_f32 v[244:245], v[244:245], 1.0 op_sel_hi:[1,0]
    v_pk_add_f32 v[246:247], v[246:247], 1.0 op_sel_hi:[1,0]
    v_pk_add_f32 v[248:249], v[248:249], 1.0 op_sel_hi:[1,0]
    v_pk_add_f32 v[250:251], v[250:251], 1.0 op_sel_hi:[1,0]
    v_rcp_f32 v244, v244
    ds_read_b64_tr_b16 v[236:237], v6 offset:45056
    ds_read_b64_tr_b16 v[238:239], v6 offset:45568
    s_waitcnt lgkmcnt(6)
    v_mfma_f32_32x32x16_bf16 v[192:207], v[224:227], v[108:111], v[192:207]
    v_rcp_f32 v245, v245
    v_rcp_f32 v246, v246
    ds_read_b64_tr_b16 v[240:241], v6 offset:47104
    ds_read_b64_tr_b16 v[242:243], v6 offset:47616
    s_waitcnt lgkmcnt(6)
    v_mfma_f32_32x32x16_bf16 v[192:207], v[228:231], v[112:115], v[192:207]
    v_rcp_f32 v247, v247
    v_rcp_f32 v248, v248
    ds_read_b64_tr_b16 v[224:225], v6 offset:57344
    ds_read_b64_tr_b16 v[226:227], v6 offset:57856
    s_waitcnt lgkmcnt(6)
    v_mfma_f32_32x32x16_bf16 v[192:207], v[232:235], v[116:119], v[192:207]
    v_rcp_f32 v249, v249
    v_rcp_f32 v250, v250
    v_rcp_f32 v251, v251
    ds_read_b64_tr_b16 v[228:229], v6 offset:59392
    ds_read_b64_tr_b16 v[230:231], v6 offset:59904
    s_waitcnt lgkmcnt(6)
    v_mfma_f32_32x32x16_bf16 v[192:207], v[236:239], v[120:123], v[192:207]
    v_pk_mul_f32 v[160:161], v[160:161], v[244:245]
    v_pk_mul_f32 v[162:163], v[162:163], v[246:247]
    v_pk_mul_f32 v[164:165], v[164:165], v[248:249]
    v_pk_mul_f32 v[166:167], v[166:167], v[250:251]
    v_cvt_pk_bf16_f32 v160, v160, v161
    v_cvt_pk_bf16_f32 v161, v162, v163
    v_cvt_pk_bf16_f32 v162, v164, v165
    v_cvt_pk_bf16_f32 v163, v166, v167
    buffer_store_dwordx4 v[160:163], v12, s[20:23], s65 offen offset:0 sc1
    ds_read_b64_tr_b16 v[232:233], v6 offset:61440
    ds_read_b64_tr_b16 v[234:235], v6 offset:61952
    s_waitcnt lgkmcnt(6)
    v_mfma_f32_32x32x16_bf16 v[192:207], v[240:243], v[124:127], v[192:207]
    v_pk_mul_f32 v[244:245], v[168:169], s[50:51] op_sel:[0,1] op_sel_hi:[1,1]
    v_pk_mul_f32 v[246:247], v[170:171], s[50:51] op_sel:[0,1] op_sel_hi:[1,1]
    v_pk_mul_f32 v[248:249], v[172:173], s[50:51] op_sel:[0,1] op_sel_hi:[1,1]
    v_pk_mul_f32 v[250:251], v[174:175], s[50:51] op_sel:[0,1] op_sel_hi:[1,1]
    v_exp_f32 v244, v244
    ds_read_b64_tr_b16 v[236:237], v6 offset:63488
    ds_read_b64_tr_b16 v[238:239], v6 offset:64000
    s_waitcnt lgkmcnt(6)
    v_mfma_f32_32x32x16_bf16 v[192:207], v[224:227], v[128:131], v[192:207]
    v_exp_f32 v245, v245
    v_exp_f32 v246, v246
    ds_read_b64_tr_b16 v[240:241], v6 offset:8192
    ds_read_b64_tr_b16 v[242:243], v6 offset:8704
    v_lshlrev_b32 v2, 7, v0
    s_mov_b64 exec, 0x3ff
    buffer_load_dword v3, v2, s[24:27], s6 offen
    s_add_u32 s6, s6, s5
    s_mov_b64 exec, -1
    s_waitcnt lgkmcnt(6)
    v_mfma_f32_32x32x16_bf16 v[192:207], v[228:231], v[132:135], v[192:207]
    v_exp_f32 v247, v247
    v_exp_f32 v248, v248
    ds_read_b64_tr_b16 v[224:225], v6 offset:10240
    ds_read_b64_tr_b16 v[226:227], v6 offset:10752
    s_waitcnt lgkmcnt(6)
    v_mfma_f32_32x32x16_bf16 v[192:207], v[232:235], v[136:139], v[192:207]
    v_exp_f32 v249, v249
    v_exp_f32 v250, v250
    v_exp_f32 v251, v251
    ds_read_b64_tr_b16 v[228:229], v6 offset:12288
    ds_read_b64_tr_b16 v[230:231], v6 offset:12800
    s_waitcnt lgkmcnt(6)
    v_mfma_f32_32x32x16_bf16 v[192:207], v[236:239], v[140:143], v[192:207]
    v_pk_add_f32 v[244:245], v[244:245], 1.0 op_sel_hi:[1,0]
    v_pk_add_f32 v[246:247], v[246:247], 1.0 op_sel_hi:[1,0]
    v_pk_add_f32 v[248:249], v[248:249], 1.0 op_sel_hi:[1,0]
    v_pk_add_f32 v[250:251], v[250:251], 1.0 op_sel_hi:[1,0]
    v_rcp_f32 v244, v244
    ds_read_b64_tr_b16 v[232:233], v6 offset:14336
    ds_read_b64_tr_b16 v[234:235], v6 offset:14848
    s_waitcnt lgkmcnt(6)
    v_mfma_f32_32x32x16_bf16 v[192:207], v[240:243], v[144:147], v[192:207]
    v_rcp_f32 v245, v245
    v_rcp_f32 v246, v246
    ds_read_b64_tr_b16 v[236:237], v7 offset:24576
    ds_read_b64_tr_b16 v[238:239], v7 offset:25088
    s_waitcnt lgkmcnt(6)
    v_mfma_f32_32x32x16_bf16 v[192:207], v[224:227], v[148:151], v[192:207]
    v_rcp_f32 v247, v247
    v_rcp_f32 v248, v248
    ds_read_b64_tr_b16 v[240:241], v7 offset:26624
    ds_read_b64_tr_b16 v[242:243], v7 offset:27136
    s_waitcnt lgkmcnt(6)
    v_mfma_f32_32x32x16_bf16 v[192:207], v[228:231], v[152:155], v[192:207]
    v_rcp_f32 v249, v249
    v_rcp_f32 v250, v250
    v_rcp_f32 v251, v251
    ds_read_b64_tr_b16 v[224:225], v7 offset:28672
    ds_read_b64_tr_b16 v[226:227], v7 offset:29184
    s_waitcnt lgkmcnt(6)
    v_mfma_f32_32x32x16_bf16 v[192:207], v[232:235], v[156:159], v[192:207]
    v_pk_mul_f32 v[168:169], v[168:169], v[244:245]
    v_pk_mul_f32 v[170:171], v[170:171], v[246:247]
    v_pk_mul_f32 v[172:173], v[172:173], v[248:249]
    v_pk_mul_f32 v[174:175], v[174:175], v[250:251]
    v_cvt_pk_bf16_f32 v168, v168, v169
    v_cvt_pk_bf16_f32 v169, v170, v171
    v_cvt_pk_bf16_f32 v170, v172, v173
    v_cvt_pk_bf16_f32 v171, v174, v175
    buffer_store_dwordx4 v[168:171], v12, s[20:23], s65 offen offset:1024 sc1
    s_lshl_b32 s52, s44, 3
    s_lshl_b32 s53, s46, 1
    s_add_u32 s53, s53, s52
    s_sub_u32 s76, s53, 8
    s_cmp_lt_u32 s53, 8
    s_cselect_b32 s76, s53, s76
    s_cselect_b32 s78, 0xf149f149, 0
    s_mul_i32 s79, s45, 18
    ds_read_b64_tr_b16 v[228:229], v7 offset:30720
    ds_read_b64_tr_b16 v[230:231], v7 offset:31232
    s_waitcnt lgkmcnt(6)
    v_mfma_f32_32x32x16_bf16 v[208:223], v[236:239], v[96:99], v[208:223]
    v_bfe_u32 v1, v0, 1, 1
    v_add_u32 v1, 1, v1
    v_mul_u32_u24 v1, 576, v1
    v_bfe_u32 v253, v0, 3, 1
    v_add_u32 v253, s76, v253
    s_add_u32 s80, s52, s46
    v_mov_b32 v252, s80
    v_and_b32 v13, 4, v0
    v_cmp_eq_u32 vcc, 0, v13
    s_nop 1
    v_cndmask_b32 v1, 0, v1, vcc
    ds_read_b64_tr_b16 v[232:233], v7 offset:40960
    ds_read_b64_tr_b16 v[234:235], v7 offset:41472
    s_waitcnt lgkmcnt(6)
    v_mfma_f32_32x32x16_bf16 v[208:223], v[240:243], v[100:103], v[208:223]
    v_cndmask_b32 v253, v252, v253, vcc
    v_and_b32 v252, 1, v0
    v_mul_u32_u24 v252, 17, v252
    v_add3_u32 v1, v1, v252, s79
    v_lshrrev_b32 v1, 6, v1
    v_lshl_add_u32 v1, v253, 5, v1
    v_lshlrev_b32 v252, 2, v1
    s_lshl_b32 s81, s80, 8
    s_add_u32 s81, s81, 29360128
    s_mul_i32 s76, s76, 110592
    s_mul_i32 s53, s45, 576
    s_add_u32 s76, s76, s53
    s_add_u32 s76, s76, 18432
    s_add_u32 s52, s52, s46
    s_mul_i32 s77, s52, 110592
    s_add_u32 s77, s77, s53
    s_mul_i32 s82, s46, 1280
    s_lshl_b32 s83, s82, 1
    v_lshlrev_b32 v12, 4, v0
    v_bfe_u32 v1, v0, 4, 1
    ds_read_b64_tr_b16 v[236:237], v7 offset:43008
    ds_read_b64_tr_b16 v[238:239], v7 offset:43520
    s_waitcnt lgkmcnt(6)
    v_mfma_f32_32x32x16_bf16 v[208:223], v[224:227], v[104:107], v[208:223]
    v_xor_b32 v1, v1, v0
    v_lshlrev_b32 v13, 4, v1
    v_bfe_u32 v1, v0, 2, 2
    v_mul_u32_u24 v5, 640, v1
    v_and_b32 v1, 3, v0
    v_lshl_add_u32 v5, v1, 4, v5
    v_lshrrev_b32 v1, 4, v0
    v_mul_u32_u24 v1, 20480, v1
    v_add3_u32 v5, v5, v1, s82
    ds_read_b64_tr_b16 v[240:241], v7 offset:45056
    ds_read_b64_tr_b16 v[242:243], v7 offset:45568
    v_lshlrev_b32 v2, 7, v0
    s_mov_b64 exec, 0x3ff
    buffer_load_dword v3, v2, s[24:27], s6 offen
    s_add_u32 s6, s6, 327680
    s_mov_b64 exec, -1
    s_waitcnt lgkmcnt(6)
    v_mfma_f32_32x32x16_bf16 v[208:223], v[228:231], v[108:111], v[208:223]
    v_mov_b32 v1, s82
    v_cmp_gt_u32 vcc, 32, v0
    s_nop 1
    v_cndmask_b32 v1, 0, v1, vcc
    v_add_u32 v5, v5, v1
    v_mov_b32 v8, 0x3f803f80
    v_mov_b32 v1, s78
    v_cmp_gt_u32 vcc, 16, v0
    s_nop 1
    v_cndmask_b32 v8, v8, v1, vcc
    v_and_b32 v1, 0x32, v0
    ds_read_b64_tr_b16 v[224:225], v7 offset:47104
    ds_read_b64_tr_b16 v[226:227], v7 offset:47616
    s_waitcnt lgkmcnt(6)
    v_mfma_f32_32x32x16_bf16 v[208:223], v[232:235], v[112:115], v[208:223]
    v_cmp_eq_u32 vcc, 0x02, v1
    s_nop 1
    v_cndmask_b32 v8, v8, 0, vcc
    v_cmp_eq_u32 vcc, 0x22, v1
    s_nop 1
    v_cndmask_b32 v8, v8, 0, vcc
    v_mov_b32 v9, v8
    v_mov_b32 v10, v8
    v_mov_b32 v11, v8
    v_pk_mul_f32 v[244:245], v[176:177], s[50:51] op_sel:[0,1] op_sel_hi:[1,1]
    v_pk_mul_f32 v[246:247], v[178:179], s[50:51] op_sel:[0,1] op_sel_hi:[1,1]
    ds_read_b64_tr_b16 v[228:229], v7 offset:57344
    ds_read_b64_tr_b16 v[230:231], v7 offset:57856
    s_waitcnt lgkmcnt(6)
    v_mfma_f32_32x32x16_bf16 v[208:223], v[236:239], v[116:119], v[208:223]
    v_pk_mul_f32 v[248:249], v[180:181], s[50:51] op_sel:[0,1] op_sel_hi:[1,1]
    v_pk_mul_f32 v[250:251], v[182:183], s[50:51] op_sel:[0,1] op_sel_hi:[1,1]
    v_exp_f32 v244, v244
    ds_read_b64_tr_b16 v[232:233], v7 offset:59392
    ds_read_b64_tr_b16 v[234:235], v7 offset:59904
    s_waitcnt lgkmcnt(6)
    v_mfma_f32_32x32x16_bf16 v[208:223], v[240:243], v[120:123], v[208:223]
    v_exp_f32 v245, v245
    v_exp_f32 v246, v246
    v_exp_f32 v247, v247
    ds_read_b64_tr_b16 v[236:237], v7 offset:61440
    ds_read_b64_tr_b16 v[238:239], v7 offset:61952
    s_waitcnt lgkmcnt(6)
    v_mfma_f32_32x32x16_bf16 v[208:223], v[224:227], v[124:127], v[208:223]
    v_exp_f32 v248, v248
    v_exp_f32 v249, v249
    ds_read_b64_tr_b16 v[240:241], v7 offset:63488
    ds_read_b64_tr_b16 v[242:243], v7 offset:64000
    s_waitcnt lgkmcnt(6)
    v_mfma_f32_32x32x16_bf16 v[208:223], v[228:231], v[128:131], v[208:223]
    v_exp_f32 v250, v250
    v_exp_f32 v251, v251
    v_pk_add_f32 v[244:245], v[244:245], 1.0 op_sel_hi:[1,0]
    v_pk_add_f32 v[246:247], v[246:247], 1.0 op_sel_hi:[1,0]
    ds_read_b64_tr_b16 v[224:225], v7 offset:8192
    ds_read_b64_tr_b16 v[226:227], v7 offset:8704
    s_waitcnt lgkmcnt(6)
    v_mfma_f32_32x32x16_bf16 v[208:223], v[232:235], v[132:135], v[208:223]
    v_pk_add_f32 v[248:249], v[248:249], 1.0 op_sel_hi:[1,0]
    v_pk_add_f32 v[250:251], v[250:251], 1.0 op_sel_hi:[1,0]
    v_rcp_f32 v244, v244
    ds_read_b64_tr_b16 v[228:229], v7 offset:10240
    ds_read_b64_tr_b16 v[230:231], v7 offset:10752
    s_waitcnt lgkmcnt(6)
    v_mfma_f32_32x32x16_bf16 v[208:223], v[236:239], v[136:139], v[208:223]
    v_rcp_f32 v245, v245
    v_rcp_f32 v246, v246
    v_rcp_f32 v247, v247
    ds_read_b64_tr_b16 v[232:233], v7 offset:12288
    ds_read_b64_tr_b16 v[234:235], v7 offset:12800
    s_waitcnt lgkmcnt(6)
    v_mfma_f32_32x32x16_bf16 v[208:223], v[240:243], v[140:143], v[208:223]
    v_rcp_f32 v248, v248
    v_rcp_f32 v249, v249
    ds_read_b64_tr_b16 v[236:237], v7 offset:14336
    ds_read_b64_tr_b16 v[238:239], v7 offset:14848
    s_waitcnt lgkmcnt(6)
    v_mfma_f32_32x32x16_bf16 v[208:223], v[224:227], v[144:147], v[208:223]
    v_rcp_f32 v250, v250
    v_rcp_f32 v251, v251
    v_pk_mul_f32 v[176:177], v[176:177], v[244:245]
    v_pk_mul_f32 v[178:179], v[178:179], v[246:247]
    s_waitcnt vmcnt(5)
    s_barrier
    v_add_u32 v6, 90112, v6
    ds_read_b64_tr_b16 v[240:241], v6 offset:0
    ds_read_b64_tr_b16 v[242:243], v6 offset:512
    v_lshlrev_b32 v2, 7, v0
    s_mov_b64 exec, 0x3ff
    buffer_load_dword v3, v2, s[24:27], s6 offen
    s_add_u32 s6, s6, 327680
    s_mov_b64 exec, -1
    s_waitcnt lgkmcnt(6)
    v_mfma_f32_32x32x16_bf16 v[208:223], v[228:231], v[148:151], v[208:223]
    v_pk_mul_f32 v[180:181], v[180:181], v[248:249]
    v_pk_mul_f32 v[182:183], v[182:183], v[250:251]
    v_cvt_pk_bf16_f32 v176, v176, v177
    v_cvt_pk_bf16_f32 v177, v178, v179
    v_cvt_pk_bf16_f32 v178, v180, v181
    v_cvt_pk_bf16_f32 v179, v182, v183
    buffer_store_dwordx4 v[176:179], v12, s[20:23], s65 offen offset:2048 sc1
    v_pk_mul_f32 v[244:245], v[184:185], s[50:51] op_sel:[0,1] op_sel_hi:[1,1]
    v_pk_mul_f32 v[246:247], v[186:187], s[50:51] op_sel:[0,1] op_sel_hi:[1,1]
    ds_read_b64_tr_b16 v[224:225], v6 offset:2048
    ds_read_b64_tr_b16 v[226:227], v6 offset:2560
    s_waitcnt lgkmcnt(6)
    v_mfma_f32_32x32x16_bf16 v[208:223], v[232:235], v[152:155], v[208:223]
    v_pk_mul_f32 v[248:249], v[188:189], s[50:51] op_sel:[0,1] op_sel_hi:[1,1]
    v_pk_mul_f32 v[250:251], v[190:191], s[50:51] op_sel:[0,1] op_sel_hi:[1,1]
    v_exp_f32 v244, v244
    ds_read_b64_tr_b16 v[228:229], v6 offset:4096
    ds_read_b64_tr_b16 v[230:231], v6 offset:4608
    s_waitcnt lgkmcnt(6)
    v_mfma_f32_32x32x16_bf16 v[208:223], v[236:239], v[156:159], v[208:223]
    v_exp_f32 v245, v245
    v_exp_f32 v246, v246
    v_exp_f32 v247, v247
    ds_read_b64_tr_b16 v[232:233], v6 offset:6144
    ds_read_b64_tr_b16 v[234:235], v6 offset:6656
    s_waitcnt lgkmcnt(6)
    v_mfma_f32_32x32x16_bf16 v[160:175], v[240:243], v[16:19], 0
    v_exp_f32 v248, v248
    v_exp_f32 v249, v249
    ds_read_b64_tr_b16 v[236:237], v6 offset:24576
    ds_read_b64_tr_b16 v[238:239], v6 offset:25088
    s_waitcnt lgkmcnt(6)
    v_mfma_f32_32x32x16_bf16 v[160:175], v[224:227], v[20:23], v[160:175]
    v_exp_f32 v250, v250
    v_exp_f32 v251, v251
    v_pk_add_f32 v[244:245], v[244:245], 1.0 op_sel_hi:[1,0]
    v_pk_add_f32 v[246:247], v[246:247], 1.0 op_sel_hi:[1,0]
    ds_read_b64_tr_b16 v[240:241], v6 offset:26624
    ds_read_b64_tr_b16 v[242:243], v6 offset:27136
    s_mov_b32 exec_hi, 0xff
    ds_write_b128 v5, v[8:11] offset:576
    s_mov_b32 exec_hi, -1
    s_waitcnt lgkmcnt(7)
    v_mfma_f32_32x32x16_bf16 v[160:175], v[228:231], v[24:27], v[160:175]
    v_pk_add_f32 v[248:249], v[248:249], 1.0 op_sel_hi:[1,0]
    v_pk_add_f32 v[250:251], v[250:251], 1.0 op_sel_hi:[1,0]
    v_rcp_f32 v244, v244
    ds_read_b64_tr_b16 v[224:225], v6 offset:28672
    ds_read_b64_tr_b16 v[226:227], v6 offset:29184
    s_waitcnt lgkmcnt(7)
    v_mfma_f32_32x32x16_bf16 v[160:175], v[232:235], v[28:31], v[160:175]
    v_rcp_f32 v245, v245
    v_rcp_f32 v246, v246
    v_rcp_f32 v247, v247
    ds_read_b64_tr_b16 v[228:229], v6 offset:30720
    ds_read_b64_tr_b16 v[230:231], v6 offset:31232
    s_waitcnt lgkmcnt(7)
    v_mfma_f32_32x32x16_bf16 v[160:175], v[236:239], v[32:35], v[160:175]
    v_rcp_f32 v248, v248
    v_rcp_f32 v249, v249
    ds_read_b64_tr_b16 v[232:233], v6 offset:49152
    ds_read_b64_tr_b16 v[234:235], v6 offset:49664
    s_waitcnt lgkmcnt(7)
    v_mfma_f32_32x32x16_bf16 v[160:175], v[240:243], v[36:39], v[160:175]
    v_rcp_f32 v250, v250
    v_rcp_f32 v251, v251
    v_pk_mul_f32 v[184:185], v[184:185], v[244:245]
    v_pk_mul_f32 v[186:187], v[186:187], v[246:247]
    ds_read_b64_tr_b16 v[236:237], v6 offset:51200
    ds_read_b64_tr_b16 v[238:239], v6 offset:51712
    s_waitcnt lgkmcnt(6)
    v_mfma_f32_32x32x16_bf16 v[160:175], v[224:227], v[40:43], v[160:175]
    v_pk_mul_f32 v[188:189], v[188:189], v[248:249]
    v_pk_mul_f32 v[190:191], v[190:191], v[250:251]
    v_cvt_pk_bf16_f32 v184, v184, v185
    v_cvt_pk_bf16_f32 v185, v186, v187
    v_cvt_pk_bf16_f32 v186, v188, v189
    v_cvt_pk_bf16_f32 v187, v190, v191
    buffer_store_dwordx4 v[184:187], v12, s[20:23], s65 offen offset:3072 sc1
    v_pk_mul_f32 v[244:245], v[192:193], s[50:51] op_sel:[0,1] op_sel_hi:[1,1]
    v_pk_mul_f32 v[246:247], v[194:195], s[50:51] op_sel:[0,1] op_sel_hi:[1,1]
    ds_read_b64_tr_b16 v[240:241], v6 offset:53248
    ds_read_b64_tr_b16 v[242:243], v6 offset:53760
    v_lshlrev_b32 v2, 7, v0
    s_mov_b64 exec, 0xff
    v_add_u32 v2, s7, v2
    s_cmp_lt_u32 s47, 2
    s_cbranch_scc1 L_t_21
    buffer_load_dword v3, v2, s[28:31], 0 offen
    s_branch L_t_22
L_t_21:
    buffer_load_dword v3, v2, s[24:27], 0 offen
L_t_22:
    s_mov_b64 exec, -1
    s_waitcnt lgkmcnt(6)
    v_mfma_f32_32x32x16_bf16 v[160:175], v[228:231], v[44:47], v[160:175]
    v_pk_mul_f32 v[248:249], v[196:197], s[50:51] op_sel:[0,1] op_sel_hi:[1,1]
    v_pk_mul_f32 v[250:251], v[198:199], s[50:51] op_sel:[0,1] op_sel_hi:[1,1]
    v_exp_f32 v244, v244
    ds_read_b64_tr_b16 v[224:225], v6 offset:55296
    ds_read_b64_tr_b16 v[226:227], v6 offset:55808
    s_waitcnt lgkmcnt(6)
    v_mfma_f32_32x32x16_bf16 v[160:175], v[232:235], v[48:51], v[160:175]
    v_exp_f32 v245, v245
    v_exp_f32 v246, v246
    v_exp_f32 v247, v247
    ds_read_b64_tr_b16 v[228:229], v6 offset:8192
    ds_read_b64_tr_b16 v[230:231], v6 offset:8704
    s_waitcnt lgkmcnt(6)
    v_mfma_f32_32x32x16_bf16 v[160:175], v[236:239], v[52:55], v[160:175]
    v_exp_f32 v248, v248
    v_exp_f32 v249, v249
    ds_read_b64_tr_b16 v[232:233], v6 offset:10240
    ds_read_b64_tr_b16 v[234:235], v6 offset:10752
    s_waitcnt lgkmcnt(6)
    v_mfma_f32_32x32x16_bf16 v[160:175], v[240:243], v[56:59], v[160:175]
    v_exp_f32 v250, v250
    v_exp_f32 v251, v251
    v_pk_add_f32 v[244:245], v[244:245], 1.0 op_sel_hi:[1,0]
    v_pk_add_f32 v[246:247], v[246:247], 1.0 op_sel_hi:[1,0]
    ds_read_b64_tr_b16 v[236:237], v6 offset:12288
    ds_read_b64_tr_b16 v[238:239], v6 offset:12800
    s_waitcnt lgkmcnt(6)
    v_mfma_f32_32x32x16_bf16 v[160:175], v[224:227], v[60:63], v[160:175]
    v_pk_add_f32 v[248:249], v[248:249], 1.0 op_sel_hi:[1,0]
    v_pk_add_f32 v[250:251], v[250:251], 1.0 op_sel_hi:[1,0]
    v_rcp_f32 v244, v244
    ds_read_b64_tr_b16 v[240:241], v6 offset:14336
    ds_read_b64_tr_b16 v[242:243], v6 offset:14848
    s_waitcnt lgkmcnt(6)
    v_mfma_f32_32x32x16_bf16 v[160:175], v[228:231], v[64:67], v[160:175]
    v_rcp_f32 v245, v245
    v_rcp_f32 v246, v246
    v_rcp_f32 v247, v247
    ds_read_b64_tr_b16 v[224:225], v6 offset:32768
    ds_read_b64_tr_b16 v[226:227], v6 offset:33280
    s_waitcnt lgkmcnt(6)
    v_mfma_f32_32x32x16_bf16 v[160:175], v[232:235], v[68:71], v[160:175]
    v_rcp_f32 v248, v248
    v_rcp_f32 v249, v249
    ds_read_b64_tr_b16 v[228:229], v6 offset:34816
    ds_read_b64_tr_b16 v[230:231], v6 offset:35328
    s_waitcnt lgkmcnt(6)
    v_mfma_f32_32x32x16_bf16 v[160:175], v[236:239], v[72:75], v[160:175]
    v_rcp_f32 v250, v250
    v_rcp_f32 v251, v251
    v_pk_mul_f32 v[192:193], v[192:193], v[244:245]
    v_pk_mul_f32 v[194:195], v[194:195], v[246:247]
    ds_read_b64_tr_b16 v[232:233], v6 offset:36864
    ds_read_b64_tr_b16 v[234:235], v6 offset:37376
    s_waitcnt lgkmcnt(6)
    v_mfma_f32_32x32x16_bf16 v[160:175], v[240:243], v[76:79], v[160:175]
    v_pk_mul_f32 v[196:197], v[196:197], v[248:249]
    v_pk_mul_f32 v[198:199], v[198:199], v[250:251]
    v_cvt_pk_bf16_f32 v192, v192, v193
    v_cvt_pk_bf16_f32 v193, v194, v195
    v_cvt_pk_bf16_f32 v194, v196, v197
    v_cvt_pk_bf16_f32 v195, v198, v199
    buffer_store_dwordx4 v[192:195], v12, s[20:23], s66 offen offset:0 sc1
    v_pk_mul_f32 v[244:245], v[200:201], s[50:51] op_sel:[0,1] op_sel_hi:[1,1]
    v_pk_mul_f32 v[246:247], v[202:203], s[50:51] op_sel:[0,1] op_sel_hi:[1,1]
    ds_read_b64_tr_b16 v[236:237], v6 offset:38912
    ds_read_b64_tr_b16 v[238:239], v6 offset:39424
    s_waitcnt lgkmcnt(6)
    v_mfma_f32_32x32x16_bf16 v[160:175], v[224:227], v[80:83], v[160:175]
    v_pk_mul_f32 v[248:249], v[204:205], s[50:51] op_sel:[0,1] op_sel_hi:[1,1]
    v_pk_mul_f32 v[250:251], v[206:207], s[50:51] op_sel:[0,1] op_sel_hi:[1,1]
    v_exp_f32 v244, v244
    ds_read_b64_tr_b16 v[240:241], v6 offset:57344
    ds_read_b64_tr_b16 v[242:243], v6 offset:57856
    buffer_load_dword v253, v252, s[20:23], s4 offen sc1
    s_waitcnt lgkmcnt(6)
    v_mfma_f32_32x32x16_bf16 v[160:175], v[228:231], v[84:87], v[160:175]
    v_exp_f32 v245, v245
    v_exp_f32 v246, v246
    v_exp_f32 v247, v247
    ds_read_b64_tr_b16 v[224:225], v6 offset:59392
    ds_read_b64_tr_b16 v[226:227], v6 offset:59904
    s_waitcnt lgkmcnt(6)
    v_mfma_f32_32x32x16_bf16 v[160:175], v[232:235], v[88:91], v[160:175]
    v_exp_f32 v248, v248
    v_exp_f32 v249, v249
    ds_read_b64_tr_b16 v[228:229], v6 offset:61440
    ds_read_b64_tr_b16 v[230:231], v6 offset:61952
    s_waitcnt lgkmcnt(6)
    v_mfma_f32_32x32x16_bf16 v[160:175], v[236:239], v[92:95], v[160:175]
    v_exp_f32 v250, v250
    v_exp_f32 v251, v251
    v_pk_add_f32 v[244:245], v[244:245], 1.0 op_sel_hi:[1,0]
    v_pk_add_f32 v[246:247], v[246:247], 1.0 op_sel_hi:[1,0]
    ds_read_b64_tr_b16 v[232:233], v6 offset:63488
    ds_read_b64_tr_b16 v[234:235], v6 offset:64000
    s_waitcnt lgkmcnt(6)
    v_mfma_f32_32x32x16_bf16 v[160:175], v[240:243], v[96:99], v[160:175]
    v_pk_add_f32 v[248:249], v[248:249], 1.0 op_sel_hi:[1,0]
    v_pk_add_f32 v[250:251], v[250:251], 1.0 op_sel_hi:[1,0]
    v_rcp_f32 v244, v244
    ds_read_b64_tr_b16 v[236:237], v6 offset:16384
    ds_read_b64_tr_b16 v[238:239], v6 offset:16896
    s_waitcnt lgkmcnt(6)
    v_mfma_f32_32x32x16_bf16 v[160:175], v[224:227], v[100:103], v[160:175]
    v_rcp_f32 v245, v245
    v_rcp_f32 v246, v246
    v_rcp_f32 v247, v247
    ds_read_b64_tr_b16 v[240:241], v6 offset:18432
    ds_read_b64_tr_b16 v[242:243], v6 offset:18944
    s_waitcnt lgkmcnt(6)
    v_mfma_f32_32x32x16_bf16 v[160:175], v[228:231], v[104:107], v[160:175]
    v_rcp_f32 v248, v248
    v_rcp_f32 v249, v249
    ds_read_b64_tr_b16 v[224:225], v6 offset:20480
    ds_read_b64_tr_b16 v[226:227], v6 offset:20992
    s_waitcnt lgkmcnt(6)
    v_mfma_f32_32x32x16_bf16 v[160:175], v[232:235], v[108:111], v[160:175]
    v_rcp_f32 v250, v250
    v_rcp_f32 v251, v251
    v_pk_mul_f32 v[200:201], v[200:201], v[244:245]
    v_pk_mul_f32 v[202:203], v[202:203], v[246:247]
    ds_read_b64_tr_b16 v[228:229], v6 offset:22528
    ds_read_b64_tr_b16 v[230:231], v6 offset:23040
    s_waitcnt lgkmcnt(6)
    v_mfma_f32_32x32x16_bf16 v[160:175], v[236:239], v[112:115], v[160:175]
    v_pk_mul_f32 v[204:205], v[204:205], v[248:249]
    v_pk_mul_f32 v[206:207], v[206:207], v[250:251]
    v_cvt_pk_bf16_f32 v200, v200, v201
    v_cvt_pk_bf16_f32 v201, v202, v203
    v_cvt_pk_bf16_f32 v202, v204, v205
    v_cvt_pk_bf16_f32 v203, v206, v207
    buffer_store_dwordx4 v[200:203], v12, s[20:23], s66 offen offset:1024 sc1
    v_pk_mul_f32 v[244:245], v[208:209], s[50:51] op_sel:[0,1] op_sel_hi:[1,1]
    v_pk_mul_f32 v[246:247], v[210:211], s[50:51] op_sel:[0,1] op_sel_hi:[1,1]
    ds_read_b64_tr_b16 v[232:233], v6 offset:40960
    ds_read_b64_tr_b16 v[234:235], v6 offset:41472
    s_waitcnt vmcnt(1)
    s_mov_b32 s59, 30000
L_pl_24:
    v_cmp_ne_u32 vcc, s50, v253
    s_nop 4
    s_cbranch_vccz L_pd_23
    buffer_load_dword v253, v252, s[20:23], s4 offen sc1
    s_waitcnt vmcnt(0)
    s_sub_u32 s59, s59, 1
    s_cmp_lg_u32 s59, 0
    s_cbranch_scc1 L_pl_24
L_pd_23:
    v_and_b32 v1, 31, v0
    v_lshlrev_b32 v1, 3, v1
    buffer_load_dwordx2 v[2:3], v1, s[20:23], s81 offen sc1
    s_mov_b32 exec_hi, 0xf
    s_add_u32 m0, s82, 40960
    s_add_u32 s52, s77, 0
    buffer_load_dwordx4 v12, s[20:23], s52 offen sc1 lds
    s_mov_b32 exec_hi, -1
    s_waitcnt lgkmcnt(6)
    v_mfma_f32_32x32x16_bf16 v[160:175], v[240:243], v[116:119], v[160:175]
    v_pk_mul_f32 v[248:249], v[212:213], s[50:51] op_sel:[0,1] op_sel_hi:[1,1]
    v_pk_mul_f32 v[250:251], v[214:215], s[50:51] op_sel:[0,1] op_sel_hi:[1,1]
    v_exp_f32 v244, v244
    ds_read_b64_tr_b16 v[236:237], v6 offset:43008
    ds_read_b64_tr_b16 v[238:239], v6 offset:43520
    s_waitcnt lgkmcnt(6)
    v_mfma_f32_32x32x16_bf16 v[160:175], v[224:227], v[120:123], v[160:175]
    v_exp_f32 v245, v245
    v_exp_f32 v246, v246
    v_exp_f32 v247, v247
    ds_read_b64_tr_b16 v[240:241], v6 offset:45056
    ds_read_b64_tr_b16 v[242:243], v6 offset:45568
    s_mov_b32 exec_hi, 0xf
    s_add_u32 m0, s82, 41600
    s_add_u32 s52, s77, 55296
    buffer_load_dwordx4 v12, s[20:23], s52 offen sc1 lds
    s_mov_b32 exec_hi, -1
    s_waitcnt lgkmcnt(6)
    v_mfma_f32_32x32x16_bf16 v[160:175], v[228:231], v[124:127], v[160:175]
    v_exp_f32 v248, v248
    v_exp_f32 v249, v249
    ds_read_b64_tr_b16 v[224:225], v6 offset:47104
    ds_read_b64_tr_b16 v[226:227], v6 offset:47616
    s_waitcnt lgkmcnt(6)
    v_mfma_f32_32x32x16_bf16 v[160:175], v[232:235], v[128:131], v[160:175]
    v_exp_f32 v250, v250
    v_exp_f32 v251, v251
    v_pk_add_f32 v[244:245], v[244:245], 1.0 op_sel_hi:[1,0]
    v_pk_add_f32 v[246:247], v[246:247], 1.0 op_sel_hi:[1,0]
    v_add_u32 v6, 65536, v6
    ds_read_b64_tr_b16 v[228:229], v6 offset:0
    ds_read_b64_tr_b16 v[230:231], v6 offset:512
    s_mov_b32 exec_hi, 0xf
    s_add_u32 m0, s83, 0
    s_add_u32 s52, s76, 0
    buffer_load_dwordx4 v12, s[20:23], s52 offen sc1 lds
    s_mov_b32 exec_hi, -1
    s_waitcnt lgkmcnt(6)
    v_mfma_f32_32x32x16_bf16 v[160:175], v[236:239], v[132:135], v[160:175]
    v_pk_add_f32 v[248:249], v[248:249], 1.0 op_sel_hi:[1,0]
    v_pk_add_f32 v[250:251], v[250:251], 1.0 op_sel_hi:[1,0]
    v_rcp_f32 v244, v244
    ds_read_b64_tr_b16 v[232:233], v6 offset:2048
    ds_read_b64_tr_b16 v[234:235], v6 offset:2560
    s_waitcnt lgkmcnt(6)
    v_mfma_f32_32x32x16_bf16 v[160:175], v[240:243], v[136:139], v[160:175]
    v_rcp_f32 v245, v245
    v_rcp_f32 v246, v246
    v_rcp_f32 v247, v247
    ds_read_b64_tr_b16 v[236:237], v6 offset:4096
    ds_read_b64_tr_b16 v[238:239], v6 offset:4608
    s_mov_b32 exec_hi, 0xf
    s_add_u32 m0, s83, 640
    s_add_u32 s52, s76, 55296
    buffer_load_dwordx4 v12, s[20:23], s52 offen sc1 lds
    s_mov_b32 exec_hi, -1
    s_waitcnt lgkmcnt(6)
    v_mfma_f32_32x32x16_bf16 v[160:175], v[224:227], v[140:143], v[160:175]
    v_rcp_f32 v248, v248
    v_rcp_f32 v249, v249
    ds_read_b64_tr_b16 v[240:241], v6 offset:6144
    ds_read_b64_tr_b16 v[242:243], v6 offset:6656
    s_waitcnt lgkmcnt(6)
    v_mfma_f32_32x32x16_bf16 v[160:175], v[228:231], v[144:147], v[160:175]
    v_rcp_f32 v250, v250
    v_rcp_f32 v251, v251
    v_pk_mul_f32 v[208:209], v[208:209], v[244:245]
    v_pk_mul_f32 v[210:211], v[210:211], v[246:247]
    v_add_u32 v7, 90112, v7
    ds_read_b64_tr_b16 v[224:225], v7 offset:0
    ds_read_b64_tr_b16 v[226:227], v7 offset:512
    s_mov_b32 exec_hi, 0xf
    s_add_u32 m0, s83, 1280
    s_add_u32 s52, s76, 110592
    buffer_load_dwordx4 v12, s[20:23], s52 offen sc1 lds
    s_mov_b32 exec_hi, -1
    s_waitcnt lgkmcnt(6)
    v_mfma_f32_32x32x16_bf16 v[160:175], v[232:235], v[148:151], v[160:175]
    v_pk_mul_f32 v[212:213], v[212:213], v[248:249]
    v_pk_mul_f32 v[214:215], v[214:215], v[250:251]
    v_cvt_pk_bf16_f32 v208, v208, v209
    v_cvt_pk_bf16_f32 v209, v210, v211
    v_cvt_pk_bf16_f32 v210, v212, v213
    v_cvt_pk_bf16_f32 v211, v214, v215
    buffer_store_dwordx4 v[208:211], v12, s[20:23], s66 offen offset:2048 sc1
    v_pk_mul_f32 v[244:245], v[216:217], s[50:51] op_sel:[0,1] op_sel_hi:[1,1]
    v_pk_mul_f32 v[246:247], v[218:219], s[50:51] op_sel:[0,1] op_sel_hi:[1,1]
    ds_read_b64_tr_b16 v[228:229], v7 offset:2048
    ds_read_b64_tr_b16 v[230:231], v7 offset:2560
    s_waitcnt lgkmcnt(6)
    v_mfma_f32_32x32x16_bf16 v[160:175], v[236:239], v[152:155], v[160:175]
    v_pk_mul_f32 v[248:249], v[220:221], s[50:51] op_sel:[0,1] op_sel_hi:[1,1]
    v_pk_mul_f32 v[250:251], v[222:223], s[50:51] op_sel:[0,1] op_sel_hi:[1,1]
    v_exp_f32 v244, v244
    ds_read_b64_tr_b16 v[232:233], v7 offset:4096
    ds_read_b64_tr_b16 v[234:235], v7 offset:4608
    v_mov_b32 v254, s50
    s_mov_b64 exec, 1
    buffer_store_dword v254, off, s[20:23], s3 offset:0 sc1
    s_mov_b64 exec, -1
    s_mov_b32 exec_hi, 0xf
    s_add_u32 m0, s83, 1920
    s_add_u32 s52, s76, 165888
    buffer_load_dwordx4 v12, s[20:23], s52 offen sc1 lds
    s_mov_b32 exec_hi, -1
    s_waitcnt lgkmcnt(6)
    v_mfma_f32_32x32x16_bf16 v[160:175], v[240:243], v[156:159], v[160:175]
    v_exp_f32 v245, v245
    v_exp_f32 v246, v246
    v_exp_f32 v247, v247
    ds_read_b64_tr_b16 v[236:237], v7 offset:6144
    ds_read_b64_tr_b16 v[238:239], v7 offset:6656
    s_waitcnt lgkmcnt(6)
    v_mfma_f32_32x32x16_bf16 v[176:191], v[224:227], v[16:19], 0
    v_exp_f32 v248, v248
    v_exp_f32 v249, v249
    ds_read_b64_tr_b16 v[240:241], v7 offset:24576
    ds_read_b64_tr_b16 v[242:243], v7 offset:25088
    s_mov_b32 exec_hi, 0xf
    s_add_u32 m0, s83, 20480
    s_add_u32 s52, s76, 18432
    buffer_load_dwordx4 v13, s[20:23], s52 offen sc1 lds
    s_mov_b32 exec_hi, -1
    s_waitcnt lgkmcnt(6)
    v_mfma_f32_32x32x16_bf16 v[176:191], v[228:231], v[20:23], v[176:191]
    v_exp_f32 v250, v250
    v_exp_f32 v251, v251
    v_pk_add_f32 v[244:245], v[244:245], 1.0 op_sel_hi:[1,0]
    v_pk_add_f32 v[246:247], v[246:247], 1.0 op_sel_hi:[1,0]
    ds_read_b64_tr_b16 v[224:225], v7 offset:26624
    ds_read_b64_tr_b16 v[226:227], v7 offset:27136
    s_waitcnt lgkmcnt(6)
    v_mfma_f32_32x32x16_bf16 v[176:191], v[232:235], v[24:27], v[176:191]
    v_pk_add_f32 v[248:249], v[248:249], 1.0 op_sel_hi:[1,0]
    v_pk_add_f32 v[250:251], v[250:251], 1.0 op_sel_hi:[1,0]
    v_rcp_f32 v244, v244
    ds_read_b64_tr_b16 v[228:229], v7 offset:28672
    ds_read_b64_tr_b16 v[230:231], v7 offset:29184
    s_mov_b32 exec_hi, 0xf
    s_add_u32 m0, s83, 21120
    s_add_u32 s52, s76, 73728
    buffer_load_dwordx4 v13, s[20:23], s52 offen sc1 lds
    s_mov_b32 exec_hi, -1
    s_waitcnt lgkmcnt(6)
    v_mfma_f32_32x32x16_bf16 v[176:191], v[236:239], v[28:31], v[176:191]
    v_rcp_f32 v245, v245
    v_rcp_f32 v246, v246
    v_rcp_f32 v247, v247
    ds_read_b64_tr_b16 v[232:233], v7 offset:30720
    ds_read_b64_tr_b16 v[234:235], v7 offset:31232
    s_waitcnt lgkmcnt(6)
    v_mfma_f32_32x32x16_bf16 v[176:191], v[240:243], v[32:35], v[176:191]
    v_rcp_f32 v248, v248
    v_rcp_f32 v249, v249
    ds_read_b64_tr_b16 v[236:237], v7 offset:49152
    ds_read_b64_tr_b16 v[238:239], v7 offset:49664
    s_mov_b32 exec_hi, 0xf
    s_add_u32 m0, s83, 21760
    s_add_u32 s52, s76, 129024
    buffer_load_dwordx4 v13, s[20:23], s52 offen sc1 lds
    s_mov_b32 exec_hi, -1
    s_waitcnt lgkmcnt(6)
    v_mfma_f32_32x32x16_bf16 v[176:191], v[224:227], v[36:39], v[176:191]
    v_rcp_f32 v250, v250
    v_rcp_f32 v251, v251
    v_pk_mul_f32 v[216:217], v[216:217], v[244:245]
    v_pk_mul_f32 v[218:219], v[218:219], v[246:247]
    ds_read_b64_tr_b16 v[240:241], v7 offset:51200
    ds_read_b64_tr_b16 v[242:243], v7 offset:51712
    s_waitcnt lgkmcnt(6)
    v_mfma_f32_32x32x16_bf16 v[176:191], v[228:231], v[40:43], v[176:191]
    v_pk_mul_f32 v[220:221], v[220:221], v[248:249]
    v_pk_mul_f32 v[222:223], v[222:223], v[250:251]
    v_cvt_pk_bf16_f32 v216, v216, v217
    v_cvt_pk_bf16_f32 v217, v218, v219
    v_cvt_pk_bf16_f32 v218, v220, v221
    v_cvt_pk_bf16_f32 v219, v222, v223
    buffer_store_dwordx4 v[216:219], v12, s[20:23], s66 offen offset:3072 sc1
    v_pk_mul_f32 v[244:245], v[160:161], s[50:51] op_sel:[0,1] op_sel_hi:[1,1]
    v_pk_mul_f32 v[246:247], v[162:163], s[50:51] op_sel:[0,1] op_sel_hi:[1,1]
    ds_read_b64_tr_b16 v[224:225], v7 offset:53248
    ds_read_b64_tr_b16 v[226:227], v7 offset:53760
    s_mov_b32 exec_hi, 0xf
    s_add_u32 m0, s83, 22400
    s_add_u32 s52, s76, 184320
    buffer_load_dwordx4 v13, s[20:23], s52 offen sc1 lds
    s_mov_b32 exec_hi, -1
    s_waitcnt lgkmcnt(6)
    v_mfma_f32_32x32x16_bf16 v[176:191], v[232:235], v[44:47], v[176:191]
    v_pk_mul_f32 v[248:249], v[164:165], s[50:51] op_sel:[0,1] op_sel_hi:[1,1]
    v_pk_mul_f32 v[250:251], v[166:167], s[50:51] op_sel:[0,1] op_sel_hi:[1,1]
    v_exp_f32 v244, v244
    ds_read_b64_tr_b16 v[228:229], v7 offset:55296
    ds_read_b64_tr_b16 v[230:231], v7 offset:55808
    s_waitcnt lgkmcnt(6)
    v_mfma_f32_32x32x16_bf16 v[176:191], v[236:239], v[48:51], v[176:191]
    v_exp_f32 v245, v245
    v_exp_f32 v246, v246
    v_exp_f32 v247, v247
    ds_read_b64_tr_b16 v[232:233], v7 offset:8192
    ds_read_b64_tr_b16 v[234:235], v7 offset:8704
    s_waitcnt lgkmcnt(6)
    v_mfma_f32_32x32x16_bf16 v[176:191], v[240:243], v[52:55], v[176:191]
    v_exp_f32 v248, v248
    v_exp_f32 v249, v249
    ds_read_b64_tr_b16 v[236:237], v7 offset:10240
    ds_read_b64_tr_b16 v[238:239], v7 offset:10752
    s_waitcnt lgkmcnt(6)
    v_mfma_f32_32x32x16_bf16 v[176:191], v[224:227], v[56:59], v[176:191]
    v_exp_f32 v250, v250
    v_exp_f32 v251, v251
    v_pk_add_f32 v[244:245], v[244:245], 1.0 op_sel_hi:[1,0]
    v_pk_add_f32 v[246:247], v[246:247], 1.0 op_sel_hi:[1,0]
    ds_read_b64_tr_b16 v[240:241], v7 offset:12288
    ds_read_b64_tr_b16 v[242:243], v7 offset:12800
    s_waitcnt lgkmcnt(6)
    v_mfma_f32_32x32x16_bf16 v[176:191], v[228:231], v[60:63], v[176:191]
    v_pk_add_f32 v[248:249], v[248:249], 1.0 op_sel_hi:[1,0]
    v_pk_add_f32 v[250:251], v[250:251], 1.0 op_sel_hi:[1,0]
    v_rcp_f32 v244, v244
    ds_read_b64_tr_b16 v[224:225], v7 offset:14336
    ds_read_b64_tr_b16 v[226:227], v7 offset:14848
    s_waitcnt lgkmcnt(6)
    v_mfma_f32_32x32x16_bf16 v[176:191], v[232:235], v[64:67], v[176:191]
    v_rcp_f32 v245, v245
    v_rcp_f32 v246, v246
    v_rcp_f32 v247, v247
    ds_read_b64_tr_b16 v[228:229], v7 offset:32768
    ds_read_b64_tr_b16 v[230:231], v7 offset:33280
    s_waitcnt lgkmcnt(6)
    v_mfma_f32_32x32x16_bf16 v[176:191], v[236:239], v[68:71], v[176:191]
    v_rcp_f32 v248, v248
    v_rcp_f32 v249, v249
    ds_read_b64_tr_b16 v[232:233], v7 offset:34816
    ds_read_b64_tr_b16 v[234:235], v7 offset:35328
    s_waitcnt lgkmcnt(6)
    v_mfma_f32_32x32x16_bf16 v[176:191], v[240:243], v[72:75], v[176:191]
    v_rcp_f32 v250, v250
    v_rcp_f32 v251, v251
    v_pk_mul_f32 v[160:161], v[160:161], v[244:245]
    v_pk_mul_f32 v[162:163], v[162:163], v[246:247]
    ds_read_b64_tr_b16 v[236:237], v7 offset:36864
    ds_read_b64_tr_b16 v[238:239], v7 offset:37376
    s_waitcnt lgkmcnt(6)
    v_mfma_f32_32x32x16_bf16 v[176:191], v[224:227], v[76:79], v[176:191]
    v_pk_mul_f32 v[164:165], v[164:165], v[248:249]
    v_pk_mul_f32 v[166:167], v[166:167], v[250:251]
    v_cvt_pk_bf16_f32 v160, v160, v161
    v_cvt_pk_bf16_f32 v161, v162, v163
    v_cvt_pk_bf16_f32 v162, v164, v165
    v_cvt_pk_bf16_f32 v163, v166, v167
    buffer_store_dwordx4 v[160:163], v12, s[20:23], s67 offen offset:0 sc1
    v_pk_mul_f32 v[244:245], v[168:169], s[50:51] op_sel:[0,1] op_sel_hi:[1,1]
    v_pk_mul_f32 v[246:247], v[170:171], s[50:51] op_sel:[0,1] op_sel_hi:[1,1]
    ds_read_b64_tr_b16 v[240:241], v7 offset:38912
    ds_read_b64_tr_b16 v[242:243], v7 offset:39424
    s_waitcnt lgkmcnt(6)
    v_mfma_f32_32x32x16_bf16 v[176:191], v[228:231], v[80:83], v[176:191]
    v_pk_mul_f32 v[248:249], v[172:173], s[50:51] op_sel:[0,1] op_sel_hi:[1,1]
    v_pk_mul_f32 v[250:251], v[174:175], s[50:51] op_sel:[0,1] op_sel_hi:[1,1]
    v_exp_f32 v244, v244
    ds_read_b64_tr_b16 v[224:225], v7 offset:57344
    ds_read_b64_tr_b16 v[226:227], v7 offset:57856
    s_waitcnt lgkmcnt(6)
    v_mfma_f32_32x32x16_bf16 v[176:191], v[232:235], v[84:87], v[176:191]
    v_exp_f32 v245, v245
    v_exp_f32 v246, v246
    v_exp_f32 v247, v247
    ds_read_b64_tr_b16 v[228:229], v7 offset:59392
    ds_read_b64_tr_b16 v[230:231], v7 offset:59904
    s_waitcnt lgkmcnt(6)
    v_mfma_f32_32x32x16_bf16 v[176:191], v[236:239], v[88:91], v[176:191]
    v_exp_f32 v248, v248
    v_exp_f32 v249, v249
    ds_read_b64_tr_b16 v[232:233], v7 offset:61440
    ds_read_b64_tr_b16 v[234:235], v7 offset:61952
    s_waitcnt lgkmcnt(6)
    v_mfma_f32_32x32x16_bf16 v[176:191], v[240:243], v[92:95], v[176:191]
    v_exp_f32 v250, v250
    v_exp_f32 v251, v251
    v_pk_add_f32 v[244:245], v[244:245], 1.0 op_sel_hi:[1,0]
    v_pk_add_f32 v[246:247], v[246:247], 1.0 op_sel_hi:[1,0]
    ds_read_b64_tr_b16 v[236:237], v7 offset:63488
    ds_read_b64_tr_b16 v[238:239], v7 offset:64000
    s_waitcnt lgkmcnt(6)
    v_mfma_f32_32x32x16_bf16 v[176:191], v[224:227], v[96:99], v[176:191]
    v_pk_add_f32 v[248:249], v[248:249], 1.0 op_sel_hi:[1,0]
    v_pk_add_f32 v[250:251], v[250:251], 1.0 op_sel_hi:[1,0]
    v_rcp_f32 v244, v244
    ds_read_b64_tr_b16 v[240:241], v7 offset:16384
    ds_read_b64_tr_b16 v[242:243], v7 offset:16896
    s_waitcnt lgkmcnt(6)
    v_mfma_f32_32x32x16_bf16 v[176:191], v[228:231], v[100:103], v[176:191]
    v_rcp_f32 v245, v245
    v_rcp_f32 v246, v246
    v_rcp_f32 v247, v247
    ds_read_b64_tr_b16 v[224:225], v7 offset:18432
    ds_read_b64_tr_b16 v[226:227], v7 offset:18944
    s_waitcnt lgkmcnt(6)
    v_mfma_f32_32x32x16_bf16 v[176:191], v[232:235], v[104:107], v[176:191]
    v_rcp_f32 v248, v248
    v_rcp_f32 v249, v249
    ds_read_b64_tr_b16 v[228:229], v7 offset:20480
    ds_read_b64_tr_b16 v[230:231], v7 offset:20992
    s_waitcnt lgkmcnt(6)
    v_mfma_f32_32x32x16_bf16 v[176:191], v[236:239], v[108:111], v[176:191]
    v_rcp_f32 v250, v250
    v_rcp_f32 v251, v251
    v_pk_mul_f32 v[168:169], v[168:169], v[244:245]
    v_pk_mul_f32 v[170:171], v[170:171], v[246:247]
    ds_read_b64_tr_b16 v[232:233], v7 offset:22528
    ds_read_b64_tr_b16 v[234:235], v7 offset:23040
    s_waitcnt lgkmcnt(6)
    v_mfma_f32_32x32x16_bf16 v[176:191], v[240:243], v[112:115], v[176:191]
    v_pk_mul_f32 v[172:173], v[172:173], v[248:249]
    v_pk_mul_f32 v[174:175], v[174:175], v[250:251]
    v_cvt_pk_bf16_f32 v168, v168, v169
    v_cvt_pk_bf16_f32 v169, v170, v171
    v_cvt_pk_bf16_f32 v170, v172, v173
    v_cvt_pk_bf16_f32 v171, v174, v175
    buffer_store_dwordx4 v[168:171], v12, s[20:23], s67 offen offset:1024 sc1
    ds_read_b64_tr_b16 v[236:237], v7 offset:40960
    ds_read_b64_tr_b16 v[238:239], v7 offset:41472
    s_waitcnt lgkmcnt(6)
    v_mfma_f32_32x32x16_bf16 v[176:191], v[224:227], v[116:119], v[176:191]
    ds_read_b64_tr_b16 v[240:241], v7 offset:43008
    ds_read_b64_tr_b16 v[242:243], v7 offset:43520
    s_waitcnt lgkmcnt(6)
    v_mfma_f32_32x32x16_bf16 v[176:191], v[228:231], v[120:123], v[176:191]
    ds_read_b64_tr_b16 v[224:225], v7 offset:45056
    ds_read_b64_tr_b16 v[226:227], v7 offset:45568
    s_waitcnt lgkmcnt(6)
    v_mfma_f32_32x32x16_bf16 v[176:191], v[232:235], v[124:127], v[176:191]
    ds_read_b64_tr_b16 v[228:229], v7 offset:47104
    ds_read_b64_tr_b16 v[230:231], v7 offset:47616
    s_waitcnt lgkmcnt(6)
    v_mfma_f32_32x32x16_bf16 v[176:191], v[236:239], v[128:131], v[176:191]
    v_add_u32 v7, 65536, v7
    ds_read_b64_tr_b16 v[232:233], v7 offset:0
    ds_read_b64_tr_b16 v[234:235], v7 offset:512
    s_waitcnt lgkmcnt(6)
    v_mfma_f32_32x32x16_bf16 v[176:191], v[240:243], v[132:135], v[176:191]
    ds_read_b64_tr_b16 v[236:237], v7 offset:2048
    ds_read_b64_tr_b16 v[238:239], v7 offset:2560
    s_waitcnt lgkmcnt(6)
    v_mfma_f32_32x32x16_bf16 v[176:191], v[224:227], v[136:139], v[176:191]
    ds_read_b64_tr_b16 v[240:241], v7 offset:4096
    ds_read_b64_tr_b16 v[242:243], v7 offset:4608
    s_waitcnt lgkmcnt(6)
    v_mfma_f32_32x32x16_bf16 v[176:191], v[228:231], v[140:143], v[176:191]
    ds_read_b64_tr_b16 v[224:225], v7 offset:6144
    ds_read_b64_tr_b16 v[226:227], v7 offset:6656
    s_waitcnt lgkmcnt(6)
    v_mfma_f32_32x32x16_bf16 v[176:191], v[232:235], v[144:147], v[176:191]
    s_waitcnt lgkmcnt(4)
    v_mfma_f32_32x32x16_bf16 v[176:191], v[236:239], v[148:151], v[176:191]
    s_waitcnt lgkmcnt(2)
    v_mfma_f32_32x32x16_bf16 v[176:191], v[240:243], v[152:155], v[176:191]
    s_waitcnt lgkmcnt(0)
    v_mfma_f32_32x32x16_bf16 v[176:191], v[224:227], v[156:159], v[176:191]
    s_waitcnt vmcnt(3)
    s_add_u32 s52, s3, 8192
    v_mov_b32 v254, s50
    s_mov_b64 exec, 1
    buffer_store_dword v254, off, s[20:23], s52 offset:0 sc1
    s_mov_b64 exec, -1
L_passB_2:
    s_cmp_ge_u32 s73, 12
    s_cbranch_scc1 L_noex2_25
    s_lshr_b32 s52, s46, 2
    s_and_b32 s53, s45, 1
    s_cmp_lg_u32 s52, s53
    s_cbranch_scc1 L_noex2_25
    ds_read_b64_tr_b16 v[224:225], v14 offset:0
    ds_read_b64_tr_b16 v[226:227], v14 offset:256
    ds_read_b64_tr_b16 v[228:229], v14 offset:1024
    ds_read_b64_tr_b16 v[230:231], v14 offset:1280
    ds_read_b64_tr_b16 v[232:233], v14 offset:2048
    ds_read_b64_tr_b16 v[234:235], v14 offset:2304
    ds_read_b64_tr_b16 v[236:237], v14 offset:3072
    ds_read_b64_tr_b16 v[238:239], v14 offset:3328
    s_waitcnt lgkmcnt(6)
    v_mfma_f32_32x32x16_bf16 v[192:207], v[224:227], v[16:19], 0
    v_pk_mul_f32 v[244:245], v[176:177], s[50:51] op_sel:[0,1] op_sel_hi:[1,1]
    v_pk_mul_f32 v[246:247], v[178:179], s[50:51] op_sel:[0,1] op_sel_hi:[1,1]
    v_pk_mul_f32 v[248:249], v[180:181], s[50:51] op_sel:[0,1] op_sel_hi:[1,1]
    v_pk_mul_f32 v[250:251], v[182:183], s[50:51] op_sel:[0,1] op_sel_hi:[1,1]
    ds_read_b64_tr_b16 v[240:241], v14 offset:4096
    ds_read_b64_tr_b16 v[242:243], v14 offset:4352
    s_waitcnt lgkmcnt(6)
    v_mfma_f32_32x32x16_bf16 v[192:207], v[228:231], v[20:23], v[192:207]
    v_exp_f32 v244, v244
    v_exp_f32 v245, v245
    ds_read_b64_tr_b16 v[224:225], v14 offset:5120
    ds_read_b64_tr_b16 v[226:227], v14 offset:5376
    s_waitcnt lgkmcnt(6)
    v_mfma_f32_32x32x16_bf16 v[192:207], v[232:235], v[24:27], v[192:207]
    v_exp_f32 v246, v246
    v_exp_f32 v247, v247
    ds_read_b64_tr_b16 v[228:229], v14 offset:6144
    ds_read_b64_tr_b16 v[230:231], v14 offset:6400
    s_waitcnt lgkmcnt(6)
    v_mfma_f32_32x32x16_bf16 v[192:207], v[236:239], v[28:31], v[192:207]
    v_exp_f32 v248, v248
    v_exp_f32 v249, v249
    ds_read_b64_tr_b16 v[232:233], v14 offset:7168
    ds_read_b64_tr_b16 v[234:235], v14 offset:7424
    s_waitcnt lgkmcnt(6)
    v_mfma_f32_32x32x16_bf16 v[192:207], v[240:243], v[32:35], v[192:207]
    v_exp_f32 v250, v250
    ds_read_b64_tr_b16 v[236:237], v14 offset:8192
    ds_read_b64_tr_b16 v[238:239], v14 offset:8448
    s_waitcnt lgkmcnt(6)
    v_mfma_f32_32x32x16_bf16 v[192:207], v[224:227], v[36:39], v[192:207]
    v_exp_f32 v251, v251
    v_pk_add_f32 v[244:245], v[244:245], 1.0 op_sel_hi:[1,0]
    v_pk_add_f32 v[246:247], v[246:247], 1.0 op_sel_hi:[1,0]
    v_pk_add_f32 v[248:249], v[248:249], 1.0 op_sel_hi:[1,0]
    v_pk_add_f32 v[250:251], v[250:251], 1.0 op_sel_hi:[1,0]
    ds_read_b64_tr_b16 v[240:241], v14 offset:9216
    ds_read_b64_tr_b16 v[242:243], v14 offset:9472
    s_waitcnt lgkmcnt(6)
    v_mfma_f32_32x32x16_bf16 v[192:207], v[228:231], v[40:43], v[192:207]
    v_rcp_f32 v244, v244
    v_rcp_f32 v245, v245
    ds_read_b64_tr_b16 v[224:225], v14 offset:10240
    ds_read_b64_tr_b16 v[226:227], v14 offset:10496
    s_waitcnt lgkmcnt(6)
    v_mfma_f32_32x32x16_bf16 v[192:207], v[232:235], v[44:47], v[192:207]
    v_rcp_f32 v246, v246
    v_rcp_f32 v247, v247
    ds_read_b64_tr_b16 v[228:229], v14 offset:11264
    ds_read_b64_tr_b16 v[230:231], v14 offset:11520
    s_waitcnt lgkmcnt(6)
    v_mfma_f32_32x32x16_bf16 v[192:207], v[236:239], v[48:51], v[192:207]
    v_rcp_f32 v248, v248
    ds_read_b64_tr_b16 v[232:233], v14 offset:12288
    ds_read_b64_tr_b16 v[234:235], v14 offset:12544
    s_waitcnt lgkmcnt(6)
    v_mfma_f32_32x32x16_bf16 v[192:207], v[240:243], v[52:55], v[192:207]
    v_rcp_f32 v249, v249
    v_rcp_f32 v250, v250
    ds_read_b64_tr_b16 v[236:237], v14 offset:13312
    ds_read_b64_tr_b16 v[238:239], v14 offset:13568
    s_waitcnt lgkmcnt(6)
    v_mfma_f32_32x32x16_bf16 v[192:207], v[224:227], v[56:59], v[192:207]
    v_rcp_f32 v251, v251
    v_pk_mul_f32 v[176:177], v[176:177], v[244:245]
    v_pk_mul_f32 v[178:179], v[178:179], v[246:247]
    v_pk_mul_f32 v[180:181], v[180:181], v[248:249]
    v_pk_mul_f32 v[182:183], v[182:183], v[250:251]
    v_cvt_pk_bf16_f32 v176, v176, v177
    ds_read_b64_tr_b16 v[240:241], v14 offset:14336
    ds_read_b64_tr_b16 v[242:243], v14 offset:14592
    s_waitcnt lgkmcnt(6)
    v_mfma_f32_32x32x16_bf16 v[192:207], v[228:231], v[60:63], v[192:207]
    v_cvt_pk_bf16_f32 v177, v178, v179
    v_cvt_pk_bf16_f32 v178, v180, v181
    v_cvt_pk_bf16_f32 v179, v182, v183
    buffer_store_dwordx4 v[176:179], v12, s[20:23], s67 offen offset:2048 sc1
    v_pk_mul_f32 v[244:245], v[184:185], s[50:51] op_sel:[0,1] op_sel_hi:[1,1]
    v_pk_mul_f32 v[246:247], v[186:187], s[50:51] op_sel:[0,1] op_sel_hi:[1,1]
    v_pk_mul_f32 v[248:249], v[188:189], s[50:51] op_sel:[0,1] op_sel_hi:[1,1]
    ds_read_b64_tr_b16 v[224:225], v14 offset:15360
    ds_read_b64_tr_b16 v[226:227], v14 offset:15616
    s_waitcnt lgkmcnt(6)
    v_mfma_f32_32x32x16_bf16 v[192:207], v[232:235], v[64:67], v[192:207]
    v_pk_mul_f32 v[250:251], v[190:191], s[50:51] op_sel:[0,1] op_sel_hi:[1,1]
    v_exp_f32 v244, v244
    ds_read_b64_tr_b16 v[228:229], v14 offset:16384
    ds_read_b64_tr_b16 v[230:231], v14 offset:16640
    s_waitcnt lgkmcnt(6)
    v_mfma_f32_32x32x16_bf16 v[192:207], v[236:239], v[68:71], v[192:207]
    v_exp_f32 v245, v245
    v_exp_f32 v246, v246
    ds_read_b64_tr_b16 v[232:233], v14 offset:17408
    ds_read_b64_tr_b16 v[234:235], v14 offset:17664
    s_waitcnt lgkmcnt(6)
    v_mfma_f32_32x32x16_bf16 v[192:207], v[240:243], v[72:75], v[192:207]
    v_exp_f32 v247, v247
    v_exp_f32 v248, v248
    ds_read_b64_tr_b16 v[236:237], v14 offset:18432
    ds_read_b64_tr_b16 v[238:239], v14 offset:18688
    s_waitcnt lgkmcnt(6)
    v_mfma_f32_32x32x16_bf16 v[192:207], v[224:227], v[76:79], v[192:207]
    v_exp_f32 v249, v249
    ds_read_b64_tr_b16 v[240:241], v14 offset:19456
    ds_read_b64_tr_b16 v[242:243], v14 offset:19712
    s_waitcnt lgkmcnt(6)
    v_mfma_f32_32x32x16_bf16 v[192:207], v[228:231], v[80:83], v[192:207]
    v_exp_f32 v250, v250
    v_exp_f32 v251, v251
    v_pk_add_f32 v[244:245], v[244:245], 1.0 op_sel_hi:[1,0]
    v_pk_add_f32 v[246:247], v[246:247], 1.0 op_sel_hi:[1,0]
    ds_read_b64_tr_b16 v[224:225], v14 offset:20480
    ds_read_b64_tr_b16 v[226:227], v14 offset:20736
    s_waitcnt lgkmcnt(6)
    v_mfma_f32_32x32x16_bf16 v[192:207], v[232:235], v[84:87], v[192:207]
    v_pk_add_f32 v[248:249], v[248:249], 1.0 op_sel_hi:[1,0]
    v_pk_add_f32 v[250:251], v[250:251], 1.0 op_sel_hi:[1,0]
    v_rcp_f32 v244, v244
    ds_read_b64_tr_b16 v[228:229], v14 offset:21504
    ds_read_b64_tr_b16 v[230:231], v14 offset:21760
    s_waitcnt lgkmcnt(6)
    v_mfma_f32_32x32x16_bf16 v[192:207], v[236:239], v[88:91], v[192:207]
    v_rcp_f32 v245, v245
    v_rcp_f32 v246, v246
    ds_read_b64_tr_b16 v[232:233], v14 offset:22528
    ds_read_b64_tr_b16 v[234:235], v14 offset:22784
    s_waitcnt lgkmcnt(6)
    v_mfma_f32_32x32x16_bf16 v[192:207], v[240:243], v[92:95], v[192:207]
    v_rcp_f32 v247, v247
    ds_read_b64_tr_b16 v[236:237], v14 offset:23552
    ds_read_b64_tr_b16 v[238:239], v14 offset:23808
    s_waitcnt lgkmcnt(6)
    v_mfma_f32_32x32x16_bf16 v[192:207], v[224:227], v[96:99], v[192:207]
    v_rcp_f32 v248, v248
    v_rcp_f32 v249, v249
    ds_read_b64_tr_b16 v[240:241], v14 offset:24576
    ds_read_b64_tr_b16 v[242:243], v14 offset:24832
    s_waitcnt lgkmcnt(6)
    v_mfma_f32_32x32x16_bf16 v[192:207], v[228:231], v[100:103], v[192:207]
    v_rcp_f32 v250, v250
    v_rcp_f32 v251, v251
    v_pk_mul_f32 v[184:185], v[184:185], v[244:245]
    ds_read_b64_tr_b16 v[224:225], v14 offset:25600
    ds_read_b64_tr_b16 v[226:227], v14 offset:25856
    s_waitcnt lgkmcnt(6)
    v_mfma_f32_32x32x16_bf16 v[192:207], v[232:235], v[104:107], v[192:207]
    v_pk_mul_f32 v[186:187], v[186:187], v[246:247]
    v_pk_mul_f32 v[188:189], v[188:189], v[248:249]
    v_pk_mul_f32 v[190:191], v[190:191], v[250:251]
    v_cvt_pk_bf16_f32 v184, v184, v185
    v_cvt_pk_bf16_f32 v185, v186, v187
    v_cvt_pk_bf16_f32 v186, v188, v189
    v_cvt_pk_bf16_f32 v187, v190, v191
    ds_read_b64_tr_b16 v[228:229], v14 offset:26624
    ds_read_b64_tr_b16 v[230:231], v14 offset:26880
    s_waitcnt lgkmcnt(6)
    v_mfma_f32_32x32x16_bf16 v[192:207], v[236:239], v[108:111], v[192:207]
    buffer_store_dwordx4 v[184:187], v12, s[20:23], s67 offen offset:3072 sc1
    ds_read_b64_tr_b16 v[232:233], v14 offset:27648
    ds_read_b64_tr_b16 v[234:235], v14 offset:27904
    s_waitcnt lgkmcnt(6)
    v_mfma_f32_32x32x16_bf16 v[192:207], v[240:243], v[112:115], v[192:207]
    ds_read_b64_tr_b16 v[236:237], v14 offset:28672
    ds_read_b64_tr_b16 v[238:239], v14 offset:28928
    s_waitcnt lgkmcnt(6)
    v_mfma_f32_32x32x16_bf16 v[192:207], v[224:227], v[116:119], v[192:207]
    ds_read_b64_tr_b16 v[240:241], v14 offset:29696
    ds_read_b64_tr_b16 v[242:243], v14 offset:29952
    s_waitcnt lgkmcnt(6)
    v_mfma_f32_32x32x16_bf16 v[192:207], v[228:231], v[120:123], v[192:207]
    ds_read_b64_tr_b16 v[224:225], v14 offset:30720
    ds_read_b64_tr_b16 v[226:227], v14 offset:30976
    s_waitcnt lgkmcnt(6)
    v_mfma_f32_32x32x16_bf16 v[192:207], v[232:235], v[124:127], v[192:207]
    ds_read_b64_tr_b16 v[228:229], v14 offset:31744
    ds_read_b64_tr_b16 v[230:231], v14 offset:32000
    s_waitcnt lgkmcnt(6)
    v_mfma_f32_32x32x16_bf16 v[192:207], v[236:239], v[128:131], v[192:207]
    ds_read_b64_tr_b16 v[232:233], v14 offset:32768
    ds_read_b64_tr_b16 v[234:235], v14 offset:33024
    s_waitcnt lgkmcnt(6)
    v_mfma_f32_32x32x16_bf16 v[192:207], v[240:243], v[132:135], v[192:207]
    ds_read_b64_tr_b16 v[236:237], v14 offset:33792
    ds_read_b64_tr_b16 v[238:239], v14 offset:34048
    s_waitcnt lgkmcnt(6)
    v_mfma_f32_32x32x16_bf16 v[192:207], v[224:227], v[136:139], v[192:207]
    ds_read_b64_tr_b16 v[240:241], v14 offset:34816
    ds_read_b64_tr_b16 v[242:243], v14 offset:35072
    s_waitcnt lgkmcnt(6)
    v_mfma_f32_32x32x16_bf16 v[192:207], v[228:231], v[140:143], v[192:207]
    ds_read_b64_tr_b16 v[224:225], v14 offset:35840
    ds_read_b64_tr_b16 v[226:227], v14 offset:36096
    s_waitcnt lgkmcnt(6)
    v_mfma_f32_32x32x16_bf16 v[192:207], v[232:235], v[144:147], v[192:207]
    s_waitcnt lgkmcnt(4)
    v_mfma_f32_32x32x16_bf16 v[192:207], v[236:239], v[148:151], v[192:207]
    s_waitcnt lgkmcnt(2)
    v_mfma_f32_32x32x16_bf16 v[192:207], v[240:243], v[152:155], v[192:207]
    s_waitcnt lgkmcnt(0)
    v_mfma_f32_32x32x16_bf16 v[192:207], v[224:227], v[156:159], v[192:207]
    s_waitcnt vmcnt(4)
    s_mov_b32 s59, 30000
L_gl_29:
    v_cmp_ne_u32 vcc, s50, v3
    s_nop 4
    s_cbranch_vccz L_gd_28
    v_and_b32 v1, 31, v0
    v_lshlrev_b32 v1, 3, v1
    buffer_load_dwordx2 v[2:3], v1, s[20:23], s81 offen sc1
    s_waitcnt vmcnt(0)
    s_sub_u32 s59, s59, 1
    s_cmp_lg_u32 s59, 0
    s_cbranch_scc1 L_gl_29
L_gd_28:
    v_and_b32 v1, 0xffff0000, v2
    s_nop 1
    v_pk_mul_f32 v[244:245], v[192:193], s[50:51] op_sel:[0,1] op_sel_hi:[1,1]
    v_pk_mul_f32 v[246:247], v[194:195], s[50:51] op_sel:[0,1] op_sel_hi:[1,1]
    v_pk_mul_f32 v[248:249], v[196:197], s[50:51] op_sel:[0,1] op_sel_hi:[1,1]
    v_pk_mul_f32 v[250:251], v[198:199], s[50:51] op_sel:[0,1] op_sel_hi:[1,1]
    v_exp_f32 v244, v244
    v_exp_f32 v245, v245
    v_exp_f32 v246, v246
    v_exp_f32 v247, v247
    v_exp_f32 v248, v248
    v_exp_f32 v249, v249
    v_exp_f32 v250, v250
    v_exp_f32 v251, v251
    v_pk_mul_f32 v[192:193], v[192:193], v[0:1] op_sel:[0,1] op_sel_hi:[1,1]
    v_pk_mul_f32 v[194:195], v[194:195], v[0:1] op_sel:[0,1] op_sel_hi:[1,1]
    v_pk_mul_f32 v[196:197], v[196:197], v[0:1] op_sel:[0,1] op_sel_hi:[1,1]
    v_pk_mul_f32 v[198:199], v[198:199], v[0:1] op_sel:[0,1] op_sel_hi:[1,1]
    v_pk_add_f32 v[244:245], v[244:245], 1.0 op_sel_hi:[1,0]
    v_pk_add_f32 v[246:247], v[246:247], 1.0 op_sel_hi:[1,0]
    v_pk_add_f32 v[248:249], v[248:249], 1.0 op_sel_hi:[1,0]
    v_pk_add_f32 v[250:251], v[250:251], 1.0 op_sel_hi:[1,0]
    v_rcp_f32 v244, v244
    v_rcp_f32 v245, v245
    v_rcp_f32 v246, v246
    v_rcp_f32 v247, v247
    v_rcp_f32 v248, v248
    v_rcp_f32 v249, v249
    v_rcp_f32 v250, v250
    v_rcp_f32 v251, v251
    v_pk_mul_f32 v[192:193], v[192:193], v[244:245]
    v_pk_mul_f32 v[194:195], v[194:195], v[246:247]
    v_pk_mul_f32 v[196:197], v[196:197], v[248:249]
    v_pk_mul_f32 v[198:199], v[198:199], v[250:251]
    v_cvt_pk_bf16_f32 v192, v192, v193
    v_cvt_pk_bf16_f32 v193, v194, v195
    v_cvt_pk_bf16_f32 v194, v196, v197
    v_cvt_pk_bf16_f32 v195, v198, v199
    buffer_store_dwordx4 v[192:195], v12, s[20:23], s68 offen offset:0 sc1
    v_pk_mul_f32 v[244:245], v[200:201], s[50:51] op_sel:[0,1] op_sel_hi:[1,1]
    v_pk_mul_f32 v[246:247], v[202:203], s[50:51] op_sel:[0,1] op_sel_hi:[1,1]
    v_pk_mul_f32 v[248:249], v[204:205], s[50:51] op_sel:[0,1] op_sel_hi:[1,1]
    v_pk_mul_f32 v[250:251], v[206:207], s[50:51] op_sel:[0,1] op_sel_hi:[1,1]
    v_exp_f32 v244, v244
    v_exp_f32 v245, v245
    v_exp_f32 v246, v246
    v_exp_f32 v247, v247
    v_exp_f32 v248, v248
    v_exp_f32 v249, v249
    v_exp_f32 v250, v250
    v_exp_f32 v251, v251
    v_pk_mul_f32 v[200:201], v[200:201], v[0:1] op_sel:[0,1] op_sel_hi:[1,1]
    v_pk_mul_f32 v[202:203], v[202:203], v[0:1] op_sel:[0,1] op_sel_hi:[1,1]
    v_pk_mul_f32 v[204:205], v[204:205], v[0:1] op_sel:[0,1] op_sel_hi:[1,1]
    v_pk_mul_f32 v[206:207], v[206:207], v[0:1] op_sel:[0,1] op_sel_hi:[1,1]
    v_pk_add_f32 v[244:245], v[244:245], 1.0 op_sel_hi:[1,0]
    v_pk_add_f32 v[246:247], v[246:247], 1.0 op_sel_hi:[1,0]
    v_pk_add_f32 v[248:249], v[248:249], 1.0 op_sel_hi:[1,0]
    v_pk_add_f32 v[250:251], v[250:251], 1.0 op_sel_hi:[1,0]
    v_rcp_f32 v244, v244
    v_rcp_f32 v245, v245
    v_rcp_f32 v246, v246
    v_rcp_f32 v247, v247
    v_rcp_f32 v248, v248
    v_rcp_f32 v249, v249
    v_rcp_f32 v250, v250
    v_rcp_f32 v251, v251
    v_pk_mul_f32 v[200:201], v[200:201], v[244:245]
    v_pk_mul_f32 v[202:203], v[202:203], v[246:247]
    v_pk_mul_f32 v[204:205], v[204:205], v[248:249]
    v_pk_mul_f32 v[206:207], v[206:207], v[250:251]
    v_cvt_pk_bf16_f32 v200, v200, v201
    v_cvt_pk_bf16_f32 v201, v202, v203
    v_cvt_pk_bf16_f32 v202, v204, v205
    v_cvt_pk_bf16_f32 v203, v206, v207
    buffer_store_dwordx4 v[200:203], v12, s[20:23], s68 offen offset:1024 sc1
    s_waitcnt vmcnt(2)
    s_add_u32 s52, s3, 32768
    v_mov_b32 v254, s50
    s_mov_b64 exec, 1
    buffer_store_dword v254, off, s[20:23], s52 offset:0 sc1
    s_mov_b64 exec, -1
    s_branch L_p1done_26
L_noex2_25:
    s_nop 3
    v_pk_mul_f32 v[244:245], v[176:177], s[50:51] op_sel:[0,1] op_sel_hi:[1,1]
    v_pk_mul_f32 v[246:247], v[178:179], s[50:51] op_sel:[0,1] op_sel_hi:[1,1]
    v_pk_mul_f32 v[248:249], v[180:181], s[50:51] op_sel:[0,1] op_sel_hi:[1,1]
    v_pk_mul_f32 v[250:251], v[182:183], s[50:51] op_sel:[0,1] op_sel_hi:[1,1]
    v_exp_f32 v244, v244
    v_exp_f32 v245, v245
    v_exp_f32 v246, v246
    v_exp_f32 v247, v247
    v_exp_f32 v248, v248
    v_exp_f32 v249, v249
    v_exp_f32 v250, v250
    v_exp_f32 v251, v251
    v_pk_add_f32 v[244:245], v[244:245], 1.0 op_sel_hi:[1,0]
    v_pk_add_f32 v[246:247], v[246:247], 1.0 op_sel_hi:[1,0]
    v_pk_add_f32 v[248:249], v[248:249], 1.0 op_sel_hi:[1,0]
    v_pk_add_f32 v[250:251], v[250:251], 1.0 op_sel_hi:[1,0]
    v_rcp_f32 v244, v244
    v_rcp_f32 v245, v245
    v_rcp_f32 v246, v246
    v_rcp_f32 v247, v247
    v_rcp_f32 v248, v248
    v_rcp_f32 v249, v249
    v_rcp_f32 v250, v250
    v_rcp_f32 v251, v251
    v_pk_mul_f32 v[176:177], v[176:177], v[244:245]
    v_pk_mul_f32 v[178:179], v[178:179], v[246:247]
    v_pk_mul_f32 v[180:181], v[180:181], v[248:249]
    v_pk_mul_f32 v[182:183], v[182:183], v[250:251]
    v_cvt_pk_bf16_f32 v176, v176, v177
    v_cvt_pk_bf16_f32 v177, v178, v179
    v_cvt_pk_bf16_f32 v178, v180, v181
    v_cvt_pk_bf16_f32 v179, v182, v183
    buffer_store_dwordx4 v[176:179], v12, s[20:23], s67 offen offset:2048 sc1
    v_pk_mul_f32 v[244:245], v[184:185], s[50:51] op_sel:[0,1] op_sel_hi:[1,1]
    v_pk_mul_f32 v[246:247], v[186:187], s[50:51] op_sel:[0,1] op_sel_hi:[1,1]
    v_pk_mul_f32 v[248:249], v[188:189], s[50:51] op_sel:[0,1] op_sel_hi:[1,1]
    v_pk_mul_f32 v[250:251], v[190:191], s[50:51] op_sel:[0,1] op_sel_hi:[1,1]
    v_exp_f32 v244, v244
    v_exp_f32 v245, v245
    v_exp_f32 v246, v246
    v_exp_f32 v247, v247
    v_exp_f32 v248, v248
    v_exp_f32 v249, v249
    v_exp_f32 v250, v250
    v_exp_f32 v251, v251
    v_pk_add_f32 v[244:245], v[244:245], 1.0 op_sel_hi:[1,0]
    v_pk_add_f32 v[246:247], v[246:247], 1.0 op_sel_hi:[1,0]
    v_pk_add_f32 v[248:249], v[248:249], 1.0 op_sel_hi:[1,0]
    v_pk_add_f32 v[250:251], v[250:251], 1.0 op_sel_hi:[1,0]
    v_rcp_f32 v244, v244
    v_rcp_f32 v245, v245
    v_rcp_f32 v246, v246
    v_rcp_f32 v247, v247
    v_rcp_f32 v248, v248
    v_rcp_f32 v249, v249
    v_rcp_f32 v250, v250
    v_rcp_f32 v251, v251
    v_pk_mul_f32 v[184:185], v[184:185], v[244:245]
    v_pk_mul_f32 v[186:187], v[186:187], v[246:247]
    v_pk_mul_f32 v[188:189], v[188:189], v[248:249]
    v_pk_mul_f32 v[190:191], v[190:191], v[250:251]
    v_cvt_pk_bf16_f32 v184, v184, v185
    v_cvt_pk_bf16_f32 v185, v186, v187
    v_cvt_pk_bf16_f32 v186, v188, v189
    v_cvt_pk_bf16_f32 v187, v190, v191
    buffer_store_dwordx4 v[184:187], v12, s[20:23], s67 offen offset:3072 sc1
L_p1done_26:
    s_lshl_b32 s52, s44, 3
    s_add_u32 s52, s52, s46
    s_mul_i32 s52, s52, 331776
    s_lshl_b32 s53, s45, 10
    s_add_u32 s78, s52, s53
    s_add_u32 s78, s78, 7634944
    s_lshr_b32 s53, s45, 2
    s_lshl_b32 s53, s53, 9
    s_add_u32 s79, s52, s53
    s_and_b32 s53, s45, 3
    s_lshl_b32 s53, s53, 2
    s_add_u32 s79, s79, s53
    s_add_u32 s79, s79, 7667712
    s_mov_b32 s80, 0x3eae1a93
    v_lshlrev_b32 v7, 4, v0
    v_mov_b32 v1, 0x7ffffff0
    v_cmp_gt_u32 vcc, 32, v0
    s_nop 1
    v_cndmask_b32 v7, v1, v7, vcc
    v_bfe_u32 v1, v0, 4, 1
    v_mul_u32_u24 v9, 640, v1
    v_and_b32 v1, 1, v0
    v_lshl_add_u32 v9, v1, 4, v9
    v_bfe_u32 v1, v0, 1, 1
    v_lshl_add_u32 v9, v1, 3, v9
    v_add_u32 v9, s82, v9
    v_bfe_u32 v1, v0, 2, 2
    v_mov_b32 v6, 3
    v_cndmask_b32 v6, v6, v1, vcc
    v_lshl_add_u32 v6, v6, 5, v9
    v_lshl_add_u32 v9, v1, 5, v9
    v_lshrrev_b32 v1, 5, v0
    v_lshl_add_u32 v8, v1, 8, v9
    v_and_b32 v4, 31, v0
    v_and_b32 v1, 1, v0
    v_add_u32 v1, 18, v1
    v_min_u32 v4, v4, v1
    v_bfe_u32 v1, v4, 3, 1
    v_lshlrev_b32 v4, 5, v4
    v_lshrrev_b32 v5, 5, v0
    v_xor_b32 v1, v1, v5
    v_lshl_add_u32 v4, v1, 4, v4
    v_add_u32 v4, s82, v4
    v_and_b32 v1, 31, v0
    v_lshlrev_b32 v5, 2, v5
    v_sub_u32 v1, v1, v5
    v_mov_b32 v5, 0xf149f2ca
    v_cmp_le_i32 s[52:53], 0, v1
    v_cmp_le_i32 s[54:55], 1, v1
    v_cmp_le_i32 s[56:57], 2, v1
    v_cmp_le_i32 s[58:59], 3, v1
    v_cndmask_b32 v144, v5, 0, s[52:53]
    v_cndmask_b32 v16, 0, v5, s[52:53]
    v_cndmask_b32 v145, v5, 0, s[54:55]
    v_cndmask_b32 v17, 0, v5, s[54:55]
    v_cndmask_b32 v146, v5, 0, s[56:57]
    v_cndmask_b32 v18, 0, v5, s[56:57]
    v_cndmask_b32 v147, v5, 0, s[58:59]
    v_cndmask_b32 v19, 0, v5, s[58:59]
    v_cmp_le_i32 s[52:53], 8, v1
    v_cmp_le_i32 s[54:55], 9, v1
    v_cmp_le_i32 s[56:57], 10, v1
    v_cmp_le_i32 s[58:59], 11, v1
    v_cndmask_b32 v148, v5, 0, s[52:53]
    v_cndmask_b32 v20, 0, v5, s[52:53]
    v_cndmask_b32 v149, v5, 0, s[54:55]
    v_cndmask_b32 v21, 0, v5, s[54:55]
    v_cndmask_b32 v150, v5, 0, s[56:57]
    v_cndmask_b32 v22, 0, v5, s[56:57]
    v_cndmask_b32 v151, v5, 0, s[58:59]
    v_cndmask_b32 v23, 0, v5, s[58:59]
    v_cmp_le_i32 s[52:53], 16, v1
    v_cmp_le_i32 s[54:55], 17, v1
    v_cmp_le_i32 s[56:57], 18, v1
    v_cmp_le_i32 s[58:59], 19, v1
    v_cndmask_b32 v152, v5, 0, s[52:53]
    v_cndmask_b32 v24, 0, v5, s[52:53]
    v_cndmask_b32 v153, v5, 0, s[54:55]
    v_cndmask_b32 v25, 0, v5, s[54:55]
    v_cndmask_b32 v154, v5, 0, s[56:57]
    v_cndmask_b32 v26, 0, v5, s[56:57]
    v_cndmask_b32 v155, v5, 0, s[58:59]
    v_cndmask_b32 v27, 0, v5, s[58:59]
    v_cmp_le_i32 s[52:53], 24, v1
    v_cmp_le_i32 s[54:55], 25, v1
    v_cmp_le_i32 s[56:57], 26, v1
    v_cmp_le_i32 s[58:59], 27, v1
    v_cndmask_b32 v156, v5, 0, s[52:53]
    v_cndmask_b32 v28, 0, v5, s[52:53]
    v_cndmask_b32 v157, v5, 0, s[54:55]
    v_cndmask_b32 v29, 0, v5, s[54:55]
    v_cndmask_b32 v158, v5, 0, s[56:57]
    v_cndmask_b32 v30, 0, v5, s[56:57]
    v_cndmask_b32 v159, v5, 0, s[58:59]
    v_cndmask_b32 v31, 0, v5, s[58:59]
    s_lshr_b32 s60, s47, 1
    s_mov_b64 s[84:85], s[24:25]
    s_mov_b32 s86, 5308416
    s_mov_b32 s87, 0x00020000
    s_lshr_b32 s52, s48, 1
    s_mul_i32 s52, s52, 576
    s_and_b32 s53, s48, 1
    s_lshl_b32 s54, s53, 8
    s_add_u32 s52, s52, s54
    s_lshl_b32 s53, s53, 2
    s_cmp_eq_u32 s60, 3
    s_cselect_b32 s54, 1152, 0
    v_add_u32 v1, 0, v0
    v_mul_u32_u24 v238, 205, v1
    v_lshrrev_b32 v238, 12, v238
    v_mul_u32_u24 v239, 20, v238
    v_sub_u32 v239, v1, v239
    v_add_u32 v239, s53, v239
    v_subrev_u32 v1, 20, v239
    v_min_u32 v239, v239, v1
    v_mul_u32_u24 v1, 1152, v238
    v_lshl_add_u32 v1, v239, 4, v1
    v_add_u32 v224, s52, v1
    v_lshrrev_b32 v239, 2, v238
    v_mul_u32_u24 v239, 68, v239
    v_bfe_u32 v240, v238, 1, 1
    v_lshl_add_u32 v239, v240, 4, v239
    v_mul_u32_u24 v239, s54, v239
    v_add_u32 v227, v224, v239
    v_add_u32 v1, 64, v0
    v_mul_u32_u24 v238, 205, v1
    v_lshrrev_b32 v238, 12, v238
    v_mul_u32_u24 v239, 20, v238
    v_sub_u32 v239, v1, v239
    v_add_u32 v239, s53, v239
    v_subrev_u32 v1, 20, v239
    v_min_u32 v239, v239, v1
    v_mul_u32_u24 v1, 1152, v238
    v_lshl_add_u32 v1, v239, 4, v1
    v_add_u32 v225, s52, v1
    v_lshrrev_b32 v239, 2, v238
    v_mul_u32_u24 v239, 68, v239
    v_bfe_u32 v240, v238, 1, 1
    v_lshl_add_u32 v239, v240, 4, v239
    v_mul_u32_u24 v239, s54, v239
    v_add_u32 v228, v225, v239
    v_add_u32 v1, 128, v0
    v_mul_u32_u24 v238, 205, v1
    v_lshrrev_b32 v238, 12, v238
    v_mul_u32_u24 v239, 20, v238
    v_sub_u32 v239, v1, v239
    v_add_u32 v239, s53, v239
    v_subrev_u32 v1, 20, v239
    v_min_u32 v239, v239, v1
    v_mul_u32_u24 v1, 1152, v238
    v_lshl_add_u32 v1, v239, 4, v1
    v_add_u32 v226, s52, v1
    v_lshrrev_b32 v239, 2, v238
    v_mul_u32_u24 v239, 68, v239
    v_bfe_u32 v240, v238, 1, 1
    v_lshl_add_u32 v239, v240, 4, v239
    v_mul_u32_u24 v239, s54, v239
    v_add_u32 v229, v226, v239
    s_mul_i32 s52, s60, 18432
    s_mul_i32 s53, s46, 2304
    s_add_u32 s88, s52, s53
    s_add_u32 s88, s88, 5013504
    s_mul_i32 s52, s52, 68
    s_lshl_b32 s53, s53, 2
    s_add_u32 s61, s52, s53
    s_mov_b32 s62, 73728
    s_lshr_b32 s52, s46, 1
    s_mul_i32 s54, s52, 2304
    s_mul_i32 s64, s60, 248832
    s_add_u32 s64, s64, s54
    s_sub_u32 s64, s64, 248832
    s_cmp_eq_u32 s60, 0
    s_cselect_b32 s64, 5087232, s64
    s_add_u32 s64, s64, s53
    s_mul_i32 s65, s52, 165888
    s_and_b32 s52, s46, 1
    s_mul_i32 s52, s52, 41472
    s_add_u32 s65, s65, s52
    s_add_u32 s65, s65, 18432
    s_mul_i32 s66, s46, 2560
    s_waitcnt vmcnt(4)
    s_mov_b32 s59, 30000
L_gl_31:
    v_cmp_ne_u32 vcc, s50, v3
    s_nop 4
    s_cbranch_vccz L_gd_30
    v_and_b32 v1, 31, v0
    v_lshlrev_b32 v1, 3, v1
    buffer_load_dwordx2 v[2:3], v1, s[20:23], s81 offen sc1
    s_waitcnt vmcnt(0)
    s_sub_u32 s59, s59, 1
    s_cmp_lg_u32 s59, 0
    s_cbranch_scc1 L_gl_31
L_gd_30:
    v_lshlrev_b32 v220, 16, v2
    s_barrier
    ds_read_b64_tr_b16 v[194:195], v8 offset:40960
    ds_read_b64_tr_b16 v[196:197], v8 offset:41088
    ds_read_b64_tr_b16 v[198:199], v6 offset:41472
    ds_read_b64_tr_b16 v[176:177], v8 offset:0
    ds_read_b64_tr_b16 v[178:179], v8 offset:128
    ds_read_b64_tr_b16 v[180:181], v9 offset:512
    ds_read_b64_tr_b16 v[182:183], v8 offset:1280
    ds_read_b64_tr_b16 v[184:185], v8 offset:1408
    ds_read_b64_tr_b16 v[186:187], v9 offset:1792
    ds_read_b64_tr_b16 v[188:189], v8 offset:2560
    ds_read_b64_tr_b16 v[190:191], v8 offset:2688
    ds_read_b64_tr_b16 v[192:193], v9 offset:3072
    s_waitcnt lgkmcnt(6)
    v_mfma_f32_32x32x16_bf16 v[16:31], v[176:179], v[194:197], v[16:31]
    v_mfma_f32_32x32x8_bf16 v[16:31], v[180:181], v[198:199], v[16:31]
    s_mul_i32 s52, s46, 640
    s_add_u32 m0, s52, 53248
    s_mov_b32 exec_hi, 0xff
    buffer_load_dwordx4 v224, s[84:87], s88 offen lds
    s_mov_b32 exec_hi, -1
    ds_read_b64_tr_b16 v[176:177], v8 offset:3840
    ds_read_b64_tr_b16 v[178:179], v8 offset:3968
    ds_read_b64_tr_b16 v[180:181], v9 offset:4352
    s_waitcnt lgkmcnt(6)
    v_mfma_f32_32x32x16_bf16 v[32:47], v[182:185], v[194:197], 0
    v_mfma_f32_32x32x8_bf16 v[32:47], v[186:187], v[198:199], v[32:47]
    s_add_u32 m0, s66, 61440
    s_nop 0
    buffer_load_dwordx4 v224, s[84:87], s61 offen lds
    ds_read_b64_tr_b16 v[182:183], v8 offset:5120
    ds_read_b64_tr_b16 v[184:185], v8 offset:5248
    ds_read_b64_tr_b16 v[186:187], v9 offset:5632
    s_waitcnt lgkmcnt(6)
    v_mfma_f32_32x32x16_bf16 v[48:63], v[188:191], v[194:197], 0
    v_max_f32 v216, v16, v17
    v_max_f32 v217, v18, v19
    v_max_f32 v218, v20, v21
    v_max_f32 v219, v22, v23
    v_mfma_f32_32x32x8_bf16 v[48:63], v[192:193], v[198:199], v[48:63]
    v_max3_f32 v216, v24, v25, v216
    v_max3_f32 v217, v26, v27, v217
    v_max3_f32 v218, v28, v29, v218
    v_max3_f32 v219, v30, v31, v219
    s_add_u32 m0, s66, 62464
    s_nop 0
    buffer_load_dwordx4 v225, s[84:87], s61 offen lds
    ds_read_b64_tr_b16 v[188:189], v8 offset:6400
    ds_read_b64_tr_b16 v[190:191], v8 offset:6528
    ds_read_b64_tr_b16 v[192:193], v9 offset:6912
    s_waitcnt lgkmcnt(6)
    v_mfma_f32_32x32x16_bf16 v[64:79], v[176:179], v[194:197], 0
    v_max3_f32 v216, v32, v33, v216
    v_max3_f32 v217, v34, v35, v217
    v_max3_f32 v218, v36, v37, v218
    v_max3_f32 v219, v38, v39, v219
    v_mfma_f32_32x32x8_bf16 v[64:79], v[180:181], v[198:199], v[64:79]
    v_max3_f32 v216, v40, v41, v216
    v_max3_f32 v217, v42, v43, v217
    v_max3_f32 v218, v44, v45, v218
    v_max3_f32 v219, v46, v47, v219
    s_add_u32 m0, s66, 63488
    s_mov_b32 exec_hi, 0
    buffer_load_dwordx4 v226, s[84:87], s61 offen lds
    s_mov_b32 exec_hi, -1
    s_add_u32 s61, s61, s62
    ds_read_b64_tr_b16 v[176:177], v8 offset:7680
    ds_read_b64_tr_b16 v[178:179], v8 offset:7808
    ds_read_b64_tr_b16 v[180:181], v9 offset:8192
    s_waitcnt lgkmcnt(6)
    v_mfma_f32_32x32x16_bf16 v[80:95], v[182:185], v[194:197], 0
    v_max3_f32 v216, v48, v49, v216
    v_max3_f32 v217, v50, v51, v217
    v_max3_f32 v218, v52, v53, v218
    v_max3_f32 v219, v54, v55, v219
    v_mfma_f32_32x32x8_bf16 v[80:95], v[186:187], v[198:199], v[80:95]
    v_max3_f32 v216, v56, v57, v216
    v_max3_f32 v217, v58, v59, v217
    v_max3_f32 v218, v60, v61, v218
    v_max3_f32 v219, v62, v63, v219
    s_add_u32 m0, s66, 81920
    s_nop 0
    buffer_load_dwordx4 v224, s[84:87], s61 offen lds
    ds_read_b64_tr_b16 v[182:183], v8 offset:8960
    ds_read_b64_tr_b16 v[184:185], v8 offset:9088
    ds_read_b64_tr_b16 v[186:187], v9 offset:9472
    s_waitcnt lgkmcnt(6)
    v_mfma_f32_32x32x16_bf16 v[96:111], v[188:191], v[194:197], 0
    v_max3_f32 v216, v64, v65, v216
    v_max3_f32 v217, v66, v67, v217
    v_max3_f32 v218, v68, v69, v218
    v_max3_f32 v219, v70, v71, v219
    v_mfma_f32_32x32x8_bf16 v[96:111], v[192:193], v[198:199], v[96:111]
    v_max3_f32 v216, v72, v73, v216
    v_max3_f32 v217, v74, v75, v217
    v_max3_f32 v218, v76, v77, v218
    v_max3_f32 v219, v78, v79, v219
    s_add_u32 m0, s66, 82944
    s_nop 0
    buffer_load_dwordx4 v225, s[84:87], s61 offen lds
    ds_read_b64_tr_b16 v[188:189], v8 offset:10240
    ds_read_b64_tr_b16 v[190:191], v8 offset:10368
    ds_read_b64_tr_b16 v[192:193], v9 offset:10752
    s_waitcnt lgkmcnt(6)
    v_mfma_f32_32x32x16_bf16 v[112:127], v[176:179], v[194:197], 0
    v_max3_f32 v216, v80, v81, v216
    v_max3_f32 v217, v82, v83, v217
    v_max3_f32 v218, v84, v85, v218
    v_max3_f32 v219, v86, v87, v219
    v_mfma_f32_32x32x8_bf16 v[112:127], v[180:181], v[198:199], v[112:127]
    v_max3_f32 v216, v88, v89, v216
    v_max3_f32 v217, v90, v91, v217
    v_max3_f32 v218, v92, v93, v218
    v_max3_f32 v219, v94, v95, v219
    s_add_u32 m0, s66, 83968
    s_mov_b32 exec_hi, 0
    buffer_load_dwordx4 v226, s[84:87], s61 offen lds
    s_mov_b32 exec_hi, -1
    s_add_u32 s61, s61, s62
    s_waitcnt lgkmcnt(3)
    v_mfma_f32_32x32x16_bf16 v[128:143], v[182:185], v[194:197], 0
    v_max3_f32 v216, v96, v97, v216
    v_max3_f32 v217, v98, v99, v217
    v_max3_f32 v218, v100, v101, v218
    v_max3_f32 v219, v102, v103, v219
    v_mfma_f32_32x32x8_bf16 v[128:143], v[186:187], v[198:199], v[128:143]
    v_max3_f32 v216, v104, v105, v216
    v_max3_f32 v217, v106, v107, v217
    v_max3_f32 v218, v108, v109, v218
    v_max3_f32 v219, v110, v111, v219
    s_add_u32 m0, s66, 102400
    s_nop 0
    buffer_load_dwordx4 v224, s[84:87], s61 offen lds
    s_waitcnt lgkmcnt(0)
    v_mfma_f32_32x32x16_bf16 v[144:159], v[188:191], v[194:197], v[144:159]
    v_max3_f32 v216, v112, v113, v216
    v_max3_f32 v217, v114, v115, v217
    v_max3_f32 v218, v116, v117, v218
    v_max3_f32 v219, v118, v119, v219
    v_mfma_f32_32x32x8_bf16 v[144:159], v[192:193], v[198:199], v[144:159]
    v_max3_f32 v216, v120, v121, v216
    v_max3_f32 v217, v122, v123, v217
    v_max3_f32 v218, v124, v125, v218
    v_max3_f32 v219, v126, v127, v219
    s_add_u32 m0, s66, 103424
    s_nop 0
    buffer_load_dwordx4 v225, s[84:87], s61 offen lds
    ds_read_b128 v[200:203], v4 offset:20480
    ds_read_b128 v[204:207], v4 offset:21120
    ds_read_b128 v[208:211], v4 offset:21760
    v_max3_f32 v216, v128, v129, v216
    v_max3_f32 v217, v130, v131, v217
    v_max3_f32 v218, v132, v133, v218
    v_max3_f32 v219, v134, v135, v219
    v_max3_f32 v216, v136, v137, v216
    v_max3_f32 v217, v138, v139, v217
    v_max3_f32 v218, v140, v141, v218
    v_max3_f32 v219, v142, v143, v219
    v_max3_f32 v216, v144, v145, v216
    v_max3_f32 v217, v146, v147, v217
    v_max3_f32 v218, v148, v149, v218
    v_max3_f32 v219, v150, v151, v219
    v_max3_f32 v216, v152, v153, v216
    v_max3_f32 v217, v154, v155, v217
    v_max3_f32 v218, v156, v157, v218
    v_max3_f32 v219, v158, v159, v219
    v_max3_f32 v216, v216, v217, v218
    v_max_f32 v216, v216, v219
    v_mov_b32 v217, v216
    s_nop 1
    v_permlane32_swap_b32 v216, v217
    v_max_f32 v216, v216, v217
    v_mul_f32 v222, s80, v216
    s_lshr_b32 s67, s46, 2
    s_lshl_b32 s52, s67, 1
    s_and_b32 s68, s46, 3
    s_xor_b32 s68, s68, s52
    s_lshr_b32 s52, s68, 1
    s_and_b32 s53, s48, 1
    s_cmp_eq_u32 s52, s53
    s_cselect_b32 s69, 1, 0
    s_lshl_b32 s52, s44, 1
    s_and_b32 s53, s47, 1
    s_add_u32 s52, s52, s53
    s_lshl_b32 s53, s52, 2
    s_add_u32 s54, s53, s48
    s_add_u32 s53, s53, s68
    s_mul_i32 s63, s53, 331776
    s_add_u32 s63, s63, 7340032
    s_lshl_b32 s55, s60, 10
    s_add_u32 s89, s63, s55
    s_add_u32 s89, s89, 278528
    s_mul_i32 s55, s55, 68
    s_add_u32 s63, s63, s55
    s_lshl_b32 s55, s67, 11
    s_add_u32 s63, s63, s55
    s_lshl_b32 s74, s53, 8
    s_add_u32 s74, s74, 29360128
    s_mul_i32 s70, s54, 147456
    s_add_u32 s70, s70, 30408704
    s_lshl_b32 s71, s54, 7
    s_lshl_b32 s55, s46, 4
    s_add_u32 s71, s71, s55
    s_add_u32 s71, s71, 29450240
    s_mul_i32 s72, s53, 36864
    s_lshr_b32 s52, s48, 1
    s_mul_i32 s52, s52, 576
    s_add_u32 s72, s72, s52
    s_lshl_b32 s52, s67, 5
    s_add_u32 s73, s72, s52
    s_add_u32 s73, s73, 256
    s_and_b32 s52, s48, 1
    s_mul_i32 s52, s52, 320
    s_add_u32 s72, s72, s52
    s_lshl_b32 s52, s67, 2
    s_xor_b32 s52, s52, s60
    s_lshl_b32 s53, s52, 5
    s_add_u32 s72, s72, s53
    s_and_b32 s75, s68, 1
    s_lshl_b32 s75, s75, 1
    s_add_u32 s75, s75, s67
    v_bfe_u32 v1, v0, 2, 2
    v_lshrrev_b32 v238, 5, v0
    v_lshl_add_u32 v1, v238, 2, v1
    v_mul_u32_u24 v238, 320, v1
    v_and_b32 v1, 3, v0
    v_lshl_add_u32 v238, v1, 3, v238
    s_mul_i32 s53, s67, 10240
    s_add_u32 s53, s53, 53248
    v_add_u32 v238, s53, v238
    v_bfe_u32 v239, v0, 4, 1
    v_xor_b32 v1, s52, v239
    v_xor_b32 v230, 0, v1
    v_lshl_add_u32 v230, v230, 5, v238
    v_xor_b32 v231, 2, v1
    v_lshl_add_u32 v231, v231, 5, v238
    v_xor_b32 v232, 4, v1
    v_lshl_add_u32 v232, v232, 5, v238
    v_xor_b32 v233, 6, v1
    v_lshl_add_u32 v233, v233, 5, v238
    v_xor_b32 v1, s67, v239
    v_lshl_add_u32 v234, v1, 5, v238
    v_add_u32 v234, 256, v234
    v_lshlrev_b32 v235, 4, v0
    s_sub_u32 s4, s74, 29360128
    s_lshr_b32 s4, s4, 1
    s_add_u32 s4, s4, 29425664
    s_lshl_b32 s52, s60, 3
    s_add_u32 s52, s52, 2048
    s_add_u32 s53, s60, 27
    v_mov_b32 v1, s53
    v_cmp_eq_u32 vcc, 8, v0
    s_nop 1
    v_cndmask_b32 v1, 31, v1, vcc
    v_add_u32 v252, s52, v0
    v_cmp_gt_u32 vcc, 8, v0
    s_nop 1
    v_cndmask_b32 v252, v1, v252, vcc
    v_lshlrev_b32 v252, 2, v252
    v_pk_fma_f32 v[16:17], v[16:17], s[80:81], v[222:223] op_sel_hi:[1,0,0] neg_lo:[0,0,1] neg_hi:[0,0,1]
    v_pk_fma_f32 v[18:19], v[18:19], s[80:81], v[222:223] op_sel_hi:[1,0,0] neg_lo:[0,0,1] neg_hi:[0,0,1]
    v_pk_fma_f32 v[20:21], v[20:21], s[80:81], v[222:223] op_sel_hi:[1,0,0] neg_lo:[0,0,1] neg_hi:[0,0,1]
    v_pk_fma_f32 v[22:23], v[22:23], s[80:81], v[222:223] op_sel_hi:[1,0,0] neg_lo:[0,0,1] neg_hi:[0,0,1]
    v_exp_f32 v16, v16
    v_exp_f32 v17, v17
    v_exp_f32 v18, v18
    v_exp_f32 v19, v19
    v_exp_f32 v20, v20
    v_exp_f32 v21, v21
    v_exp_f32 v22, v22
    v_exp_f32 v23, v23
    v_cvt_pk_bf16_f32 v16, v16, v17
    v_cvt_pk_bf16_f32 v17, v18, v19
    v_cvt_pk_bf16_f32 v18, v20, v21
    v_cvt_pk_bf16_f32 v19, v22, v23
    v_pk_fma_f32 v[24:25], v[24:25], s[80:81], v[222:223] op_sel_hi:[1,0,0] neg_lo:[0,0,1] neg_hi:[0,0,1]
    v_pk_fma_f32 v[26:27], v[26:27], s[80:81], v[222:223] op_sel_hi:[1,0,0] neg_lo:[0,0,1] neg_hi:[0,0,1]
    v_pk_fma_f32 v[28:29], v[28:29], s[80:81], v[222:223] op_sel_hi:[1,0,0] neg_lo:[0,0,1] neg_hi:[0,0,1]
    v_pk_fma_f32 v[30:31], v[30:31], s[80:81], v[222:223] op_sel_hi:[1,0,0] neg_lo:[0,0,1] neg_hi:[0,0,1]
    v_exp_f32 v24, v24
    v_exp_f32 v25, v25
    v_exp_f32 v26, v26
    v_exp_f32 v27, v27
    s_waitcnt lgkmcnt(2)
    v_mfma_f32_32x32x16_bf16 v[160:175], v[200:203], v[16:19], 0
    ds_read_b128 v[212:215], v4 offset:22400
    s_add_u32 m0, s66, 104448
    s_mov_b32 exec_hi, 0
    buffer_load_dwordx4 v226, s[84:87], s61 offen lds
    s_mov_b32 exec_hi, -1
    s_add_u32 s61, s61, s62
    v_exp_f32 v28, v28
    v_exp_f32 v29, v29
    v_exp_f32 v30, v30
    v_exp_f32 v31, v31
    v_cvt_pk_bf16_f32 v24, v24, v25
    v_cvt_pk_bf16_f32 v25, v26, v27
    v_cvt_pk_bf16_f32 v26, v28, v29
    v_cvt_pk_bf16_f32 v27, v30, v31
    v_pk_fma_f32 v[32:33], v[32:33], s[80:81], v[222:223] op_sel_hi:[1,0,0] neg_lo:[0,0,1] neg_hi:[0,0,1]
    v_pk_fma_f32 v[34:35], v[34:35], s[80:81], v[222:223] op_sel_hi:[1,0,0] neg_lo:[0,0,1] neg_hi:[0,0,1]
    v_pk_fma_f32 v[36:37], v[36:37], s[80:81], v[222:223] op_sel_hi:[1,0,0] neg_lo:[0,0,1] neg_hi:[0,0,1]
    v_pk_fma_f32 v[38:39], v[38:39], s[80:81], v[222:223] op_sel_hi:[1,0,0] neg_lo:[0,0,1] neg_hi:[0,0,1]
    v_exp_f32 v32, v32
    v_exp_f32 v33, v33
    v_exp_f32 v34, v34
    v_exp_f32 v35, v35
    s_waitcnt lgkmcnt(2)
    v_mfma_f32_32x32x16_bf16 v[160:175], v[204:207], v[24:27], v[160:175]
    ds_read_b128 v[200:203], v4 offset:23040
    s_add_u32 m0, s66, 122880
    s_nop 0
    buffer_load_dwordx4 v224, s[84:87], s61 offen lds
    buffer_load_dword v253, v252, s[20:23], s4 offen sc1
    v_exp_f32 v36, v36
    v_exp_f32 v37, v37
    v_exp_f32 v38, v38
    v_exp_f32 v39, v39
    v_cvt_pk_bf16_f32 v32, v32, v33
    v_cvt_pk_bf16_f32 v33, v34, v35
    v_cvt_pk_bf16_f32 v34, v36, v37
    v_cvt_pk_bf16_f32 v35, v38, v39
    v_pk_fma_f32 v[40:41], v[40:41], s[80:81], v[222:223] op_sel_hi:[1,0,0] neg_lo:[0,0,1] neg_hi:[0,0,1]
    v_pk_fma_f32 v[42:43], v[42:43], s[80:81], v[222:223] op_sel_hi:[1,0,0] neg_lo:[0,0,1] neg_hi:[0,0,1]
    v_pk_fma_f32 v[44:45], v[44:45], s[80:81], v[222:223] op_sel_hi:[1,0,0] neg_lo:[0,0,1] neg_hi:[0,0,1]
    v_pk_fma_f32 v[46:47], v[46:47], s[80:81], v[222:223] op_sel_hi:[1,0,0] neg_lo:[0,0,1] neg_hi:[0,0,1]
    v_exp_f32 v40, v40
    v_exp_f32 v41, v41
    v_exp_f32 v42, v42
    v_exp_f32 v43, v43
    s_waitcnt lgkmcnt(2)
    v_mfma_f32_32x32x16_bf16 v[160:175], v[208:211], v[32:35], v[160:175]
    ds_read_b128 v[204:207], v4 offset:23680
    s_add_u32 m0, s66, 123904
    s_nop 0
    buffer_load_dwordx4 v225, s[84:87], s61 offen lds
    v_exp_f32 v44, v44
    v_exp_f32 v45, v45
    v_exp_f32 v46, v46
    v_exp_f32 v47, v47
    v_cvt_pk_bf16_f32 v40, v40, v41
    v_cvt_pk_bf16_f32 v41, v42, v43
    v_cvt_pk_bf16_f32 v42, v44, v45
    v_cvt_pk_bf16_f32 v43, v46, v47
    v_pk_fma_f32 v[48:49], v[48:49], s[80:81], v[222:223] op_sel_hi:[1,0,0] neg_lo:[0,0,1] neg_hi:[0,0,1]
    v_pk_fma_f32 v[50:51], v[50:51], s[80:81], v[222:223] op_sel_hi:[1,0,0] neg_lo:[0,0,1] neg_hi:[0,0,1]
    v_pk_fma_f32 v[52:53], v[52:53], s[80:81], v[222:223] op_sel_hi:[1,0,0] neg_lo:[0,0,1] neg_hi:[0,0,1]
    v_pk_fma_f32 v[54:55], v[54:55], s[80:81], v[222:223] op_sel_hi:[1,0,0] neg_lo:[0,0,1] neg_hi:[0,0,1]
    v_exp_f32 v48, v48
    v_exp_f32 v49, v49
    v_exp_f32 v50, v50
    v_exp_f32 v51, v51
    s_waitcnt lgkmcnt(2)
    v_mfma_f32_32x32x16_bf16 v[160:175], v[212:215], v[40:43], v[160:175]
    ds_read_b128 v[208:211], v4 offset:24320
    s_add_u32 m0, s66, 124928
    s_mov_b32 exec_hi, 0
    buffer_load_dwordx4 v226, s[84:87], s61 offen lds
    s_mov_b32 exec_hi, -1
    s_add_u32 s61, s61, s62
    s_waitcnt vmcnt(14)
    s_add_u32 s52, s3, 32768
    v_mov_b32 v254, s50
    s_mov_b64 exec, 1
    buffer_store_dword v254, off, s[20:23], s52 offset:0 sc1
    s_mov_b64 exec, -1
    v_exp_f32 v52, v52
    v_exp_f32 v53, v53
    v_exp_f32 v54, v54
    v_exp_f32 v55, v55
    v_cvt_pk_bf16_f32 v48, v48, v49
    v_cvt_pk_bf16_f32 v49, v50, v51
    v_cvt_pk_bf16_f32 v50, v52, v53
    v_cvt_pk_bf16_f32 v51, v54, v55
    v_pk_fma_f32 v[56:57], v[56:57], s[80:81], v[222:223] op_sel_hi:[1,0,0] neg_lo:[0,0,1] neg_hi:[0,0,1]
    v_pk_fma_f32 v[58:59], v[58:59], s[80:81], v[222:223] op_sel_hi:[1,0,0] neg_lo:[0,0,1] neg_hi:[0,0,1]
    v_pk_fma_f32 v[60:61], v[60:61], s[80:81], v[222:223] op_sel_hi:[1,0,0] neg_lo:[0,0,1] neg_hi:[0,0,1]
    v_pk_fma_f32 v[62:63], v[62:63], s[80:81], v[222:223] op_sel_hi:[1,0,0] neg_lo:[0,0,1] neg_hi:[0,0,1]
    v_exp_f32 v56, v56
    v_exp_f32 v57, v57
    v_exp_f32 v58, v58
    v_exp_f32 v59, v59
    s_waitcnt lgkmcnt(2)
    v_mfma_f32_32x32x16_bf16 v[160:175], v[200:203], v[48:51], v[160:175]
    ds_read_b128 v[212:215], v4 offset:24960
    s_add_u32 m0, s66, 143360
    s_nop 0
    buffer_load_dwordx4 v224, s[84:87], s61 offen lds
    v_exp_f32 v60, v60
    v_exp_f32 v61, v61
    v_exp_f32 v62, v62
    v_exp_f32 v63, v63
    v_cvt_pk_bf16_f32 v56, v56, v57
    v_cvt_pk_bf16_f32 v57, v58, v59
    v_cvt_pk_bf16_f32 v58, v60, v61
    v_cvt_pk_bf16_f32 v59, v62, v63
    v_pk_fma_f32 v[64:65], v[64:65], s[80:81], v[222:223] op_sel_hi:[1,0,0] neg_lo:[0,0,1] neg_hi:[0,0,1]
    v_pk_fma_f32 v[66:67], v[66:67], s[80:81], v[222:223] op_sel_hi:[1,0,0] neg_lo:[0,0,1] neg_hi:[0,0,1]
    v_pk_fma_f32 v[68:69], v[68:69], s[80:81], v[222:223] op_sel_hi:[1,0,0] neg_lo:[0,0,1] neg_hi:[0,0,1]
    v_pk_fma_f32 v[70:71], v[70:71], s[80:81], v[222:223] op_sel_hi:[1,0,0] neg_lo:[0,0,1] neg_hi:[0,0,1]
    v_exp_f32 v64, v64
    v_exp_f32 v65, v65
    v_exp_f32 v66, v66
    v_exp_f32 v67, v67
    s_waitcnt lgkmcnt(2)
    v_mfma_f32_32x32x16_bf16 v[160:175], v[204:207], v[56:59], v[160:175]
    ds_read_b128 v[200:203], v4 offset:25600
    s_add_u32 m0, s66, 144384
    s_nop 0
    buffer_load_dwordx4 v225, s[84:87], s61 offen lds
    v_exp_f32 v68, v68
    v_exp_f32 v69, v69
    v_exp_f32 v70, v70
    v_exp_f32 v71, v71
    v_cvt_pk_bf16_f32 v64, v64, v65
    v_cvt_pk_bf16_f32 v65, v66, v67
    v_cvt_pk_bf16_f32 v66, v68, v69
    v_cvt_pk_bf16_f32 v67, v70, v71
    v_pk_fma_f32 v[72:73], v[72:73], s[80:81], v[222:223] op_sel_hi:[1,0,0] neg_lo:[0,0,1] neg_hi:[0,0,1]
    v_pk_fma_f32 v[74:75], v[74:75], s[80:81], v[222:223] op_sel_hi:[1,0,0] neg_lo:[0,0,1] neg_hi:[0,0,1]
    v_pk_fma_f32 v[76:77], v[76:77], s[80:81], v[222:223] op_sel_hi:[1,0,0] neg_lo:[0,0,1] neg_hi:[0,0,1]
    v_pk_fma_f32 v[78:79], v[78:79], s[80:81], v[222:223] op_sel_hi:[1,0,0] neg_lo:[0,0,1] neg_hi:[0,0,1]
    v_exp_f32 v72, v72
    v_exp_f32 v73, v73
    v_exp_f32 v74, v74
    v_exp_f32 v75, v75
    s_waitcnt lgkmcnt(2)
    v_mfma_f32_32x32x16_bf16 v[160:175], v[208:211], v[64:67], v[160:175]
    ds_read_b128 v[204:207], v4 offset:26240
    s_add_u32 m0, s66, 145408
    s_mov_b32 exec_hi, 0
    buffer_load_dwordx4 v226, s[84:87], s61 offen lds
    s_mov_b32 exec_hi, -1
    s_add_u32 s61, s61, s62
    s_waitcnt vmcnt(5)
    s_mov_b32 s59, 30000
L_pl_34:
    v_cmp_ne_u32 vcc, s50, v253
    s_nop 4
    s_cbranch_vccz L_pd_33
    buffer_load_dword v253, v252, s[20:23], s4 offen sc1
    s_waitcnt vmcnt(0)
    s_sub_u32 s59, s59, 1
    s_cmp_lg_u32 s59, 0
    s_cbranch_scc1 L_pl_34
L_pd_33:
    s_lshl_b32 s52, s67, 30
    v_add_u32 v1, s52, v235
    buffer_load_dwordx4 v[56:59], v1, s[20:23], s89 offen sc1
    buffer_load_dwordx4 v[16:19], v235, s[20:23], s63 offen offset:0 sc1
    v_exp_f32 v76, v76
    v_exp_f32 v77, v77
    v_exp_f32 v78, v78
    v_exp_f32 v79, v79
    v_cvt_pk_bf16_f32 v72, v72, v73
    v_cvt_pk_bf16_f32 v73, v74, v75
    v_cvt_pk_bf16_f32 v74, v76, v77
    v_cvt_pk_bf16_f32 v75, v78, v79
    v_pk_fma_f32 v[80:81], v[80:81], s[80:81], v[222:223] op_sel_hi:[1,0,0] neg_lo:[0,0,1] neg_hi:[0,0,1]
    v_pk_fma_f32 v[82:83], v[82:83], s[80:81], v[222:223] op_sel_hi:[1,0,0] neg_lo:[0,0,1] neg_hi:[0,0,1]
    v_pk_fma_f32 v[84:85], v[84:85], s[80:81], v[222:223] op_sel_hi:[1,0,0] neg_lo:[0,0,1] neg_hi:[0,0,1]
    v_pk_fma_f32 v[86:87], v[86:87], s[80:81], v[222:223] op_sel_hi:[1,0,0] neg_lo:[0,0,1] neg_hi:[0,0,1]
    v_exp_f32 v80, v80
    v_exp_f32 v81, v81
    v_exp_f32 v82, v82
    v_exp_f32 v83, v83
    s_waitcnt lgkmcnt(2)
    v_mfma_f32_32x32x16_bf16 v[160:175], v[212:215], v[72:75], v[160:175]
    ds_read_b128 v[208:211], v4 offset:26880
    buffer_load_dwordx4 v[20:23], v235, s[20:23], s63 offen offset:1024 sc1
    s_add_u32 s63, s63, 4096
    buffer_load_dwordx4 v[24:27], v235, s[20:23], s63 offen offset:0 sc1
    v_exp_f32 v84, v84
    v_exp_f32 v85, v85
    v_exp_f32 v86, v86
    v_exp_f32 v87, v87
    v_cvt_pk_bf16_f32 v80, v80, v81
    v_cvt_pk_bf16_f32 v81, v82, v83
    v_cvt_pk_bf16_f32 v82, v84, v85
    v_cvt_pk_bf16_f32 v83, v86, v87
    v_pk_fma_f32 v[88:89], v[88:89], s[80:81], v[222:223] op_sel_hi:[1,0,0] neg_lo:[0,0,1] neg_hi:[0,0,1]
    v_pk_fma_f32 v[90:91], v[90:91], s[80:81], v[222:223] op_sel_hi:[1,0,0] neg_lo:[0,0,1] neg_hi:[0,0,1]
    v_pk_fma_f32 v[92:93], v[92:93], s[80:81], v[222:223] op_sel_hi:[1,0,0] neg_lo:[0,0,1] neg_hi:[0,0,1]
    v_pk_fma_f32 v[94:95], v[94:95], s[80:81], v[222:223] op_sel_hi:[1,0,0] neg_lo:[0,0,1] neg_hi:[0,0,1]
    v_exp_f32 v88, v88
    v_exp_f32 v89, v89
    v_exp_f32 v90, v90
    v_exp_f32 v91, v91
    s_waitcnt lgkmcnt(2)
    v_mfma_f32_32x32x16_bf16 v[160:175], v[200:203], v[80:83], v[160:175]
    ds_read_b128 v[212:215], v4 offset:27520
    buffer_load_dwordx4 v[28:31], v235, s[20:23], s63 offen offset:1024 sc1
    s_add_u32 s63, s63, 4096
    buffer_load_dwordx4 v[32:35], v235, s[20:23], s63 offen offset:0 sc1
    v_exp_f32 v92, v92
    v_exp_f32 v93, v93
    v_exp_f32 v94, v94
    v_exp_f32 v95, v95
    v_cvt_pk_bf16_f32 v88, v88, v89
    v_cvt_pk_bf16_f32 v89, v90, v91
    v_cvt_pk_bf16_f32 v90, v92, v93
    v_cvt_pk_bf16_f32 v91, v94, v95
    v_pk_fma_f32 v[96:97], v[96:97], s[80:81], v[222:223] op_sel_hi:[1,0,0] neg_lo:[0,0,1] neg_hi:[0,0,1]
    v_pk_fma_f32 v[98:99], v[98:99], s[80:81], v[222:223] op_sel_hi:[1,0,0] neg_lo:[0,0,1] neg_hi:[0,0,1]
    v_pk_fma_f32 v[100:101], v[100:101], s[80:81], v[222:223] op_sel_hi:[1,0,0] neg_lo:[0,0,1] neg_hi:[0,0,1]
    v_pk_fma_f32 v[102:103], v[102:103], s[80:81], v[222:223] op_sel_hi:[1,0,0] neg_lo:[0,0,1] neg_hi:[0,0,1]
    v_exp_f32 v96, v96
    v_exp_f32 v97, v97
    v_exp_f32 v98, v98
    v_exp_f32 v99, v99
    s_waitcnt lgkmcnt(2)
    v_mfma_f32_32x32x16_bf16 v[160:175], v[204:207], v[88:91], v[160:175]
    ds_read_b128 v[200:203], v4 offset:28160
    buffer_load_dwordx4 v[36:39], v235, s[20:23], s63 offen offset:1024 sc1
    s_add_u32 s63, s63, 4096
    buffer_load_dwordx4 v[40:43], v235, s[20:23], s63 offen offset:0 sc1
    v_exp_f32 v100, v100
    v_exp_f32 v101, v101
    v_exp_f32 v102, v102
    v_exp_f32 v103, v103
    v_cvt_pk_bf16_f32 v96, v96, v97
    v_cvt_pk_bf16_f32 v97, v98, v99
    v_cvt_pk_bf16_f32 v98, v100, v101
    v_cvt_pk_bf16_f32 v99, v102, v103
    v_pk_fma_f32 v[104:105], v[104:105], s[80:81], v[222:223] op_sel_hi:[1,0,0] neg_lo:[0,0,1] neg_hi:[0,0,1]
    v_pk_fma_f32 v[106:107], v[106:107], s[80:81], v[222:223] op_sel_hi:[1,0,0] neg_lo:[0,0,1] neg_hi:[0,0,1]
    v_pk_fma_f32 v[108:109], v[108:109], s[80:81], v[222:223] op_sel_hi:[1,0,0] neg_lo:[0,0,1] neg_hi:[0,0,1]
    v_pk_fma_f32 v[110:111], v[110:111], s[80:81], v[222:223] op_sel_hi:[1,0,0] neg_lo:[0,0,1] neg_hi:[0,0,1]
    v_exp_f32 v104, v104
    v_exp_f32 v105, v105
    v_exp_f32 v106, v106
    v_exp_f32 v107, v107
    s_waitcnt lgkmcnt(2)
    v_mfma_f32_32x32x16_bf16 v[160:175], v[208:211], v[96:99], v[160:175]
    ds_read_b128 v[204:207], v4 offset:28800
    buffer_load_dwordx4 v[44:47], v235, s[20:23], s63 offen offset:1024 sc1
    s_add_u32 s63, s63, 4096
    buffer_load_dwordx4 v[48:51], v235, s[20:23], s63 offen offset:0 sc1
    v_exp_f32 v108, v108
    v_exp_f32 v109, v109
    v_exp_f32 v110, v110
    v_exp_f32 v111, v111
    v_cvt_pk_bf16_f32 v104, v104, v105
    v_cvt_pk_bf16_f32 v105, v106, v107
    v_cvt_pk_bf16_f32 v106, v108, v109
    v_cvt_pk_bf16_f32 v107, v110, v111
    v_pk_fma_f32 v[112:113], v[112:113], s[80:81], v[222:223] op_sel_hi:[1,0,0] neg_lo:[0,0,1] neg_hi:[0,0,1]
    v_pk_fma_f32 v[114:115], v[114:115], s[80:81], v[222:223] op_sel_hi:[1,0,0] neg_lo:[0,0,1] neg_hi:[0,0,1]
    v_pk_fma_f32 v[116:117], v[116:117], s[80:81], v[222:223] op_sel_hi:[1,0,0] neg_lo:[0,0,1] neg_hi:[0,0,1]
    v_pk_fma_f32 v[118:119], v[118:119], s[80:81], v[222:223] op_sel_hi:[1,0,0] neg_lo:[0,0,1] neg_hi:[0,0,1]
    v_exp_f32 v112, v112
    v_exp_f32 v113, v113
    v_exp_f32 v114, v114
    v_exp_f32 v115, v115
    s_waitcnt lgkmcnt(2)
    v_mfma_f32_32x32x16_bf16 v[160:175], v[212:215], v[104:107], v[160:175]
    ds_read_b128 v[208:211], v4 offset:29440
    buffer_load_dwordx4 v[52:55], v235, s[20:23], s63 offen offset:1024 sc1
    s_add_u32 s63, s63, 4096
    v_exp_f32 v116, v116
    v_exp_f32 v117, v117
    v_exp_f32 v118, v118
    v_exp_f32 v119, v119
    v_cvt_pk_bf16_f32 v112, v112, v113
    v_cvt_pk_bf16_f32 v113, v114, v115
    v_cvt_pk_bf16_f32 v114, v116, v117
    v_cvt_pk_bf16_f32 v115, v118, v119
    v_pk_fma_f32 v[120:121], v[120:121], s[80:81], v[222:223] op_sel_hi:[1,0,0] neg_lo:[0,0,1] neg_hi:[0,0,1]
    v_pk_fma_f32 v[122:123], v[122:123], s[80:81], v[222:223] op_sel_hi:[1,0,0] neg_lo:[0,0,1] neg_hi:[0,0,1]
    v_pk_fma_f32 v[124:125], v[124:125], s[80:81], v[222:223] op_sel_hi:[1,0,0] neg_lo:[0,0,1] neg_hi:[0,0,1]
    v_pk_fma_f32 v[126:127], v[126:127], s[80:81], v[222:223] op_sel_hi:[1,0,0] neg_lo:[0,0,1] neg_hi:[0,0,1]
    v_exp_f32 v120, v120
    v_exp_f32 v121, v121
    v_exp_f32 v122, v122
    v_exp_f32 v123, v123
    s_waitcnt lgkmcnt(2)
    v_mfma_f32_32x32x16_bf16 v[160:175], v[200:203], v[112:115], v[160:175]
    ds_read_b128 v[212:215], v4 offset:30080
    s_mul_i32 s52, s60, 36864
    s_add_u32 s52, s52, s70
    s_xor_b32 s89, s60, 1
    s_mul_i32 s89, s89, 9216
    s_add_u32 s89, s89, s52
    s_xor_b32 s90, s60, 2
    s_mul_i32 s90, s90, 9216
    s_add_u32 s90, s90, s52
    s_xor_b32 s91, s60, 3
    s_mul_i32 s91, s91, 9216
    s_add_u32 s91, s91, s52
    v_mov_b32 v176, -1
    v_mov_b32 v177, -1
    v_mov_b32 v178, -1
    v_mov_b32 v179, -1
    v_add_u32 v180, s49, v235
    v_add_u32 v181, 8192, v235
    buffer_store_dwordx4 v[176:179], v180, s[20:23], s89 offen sc1
    buffer_store_dwordx4 v[176:179], v180, s[20:23], s90 offen sc1
    buffer_store_dwordx4 v[176:179], v180, s[20:23], s91 offen sc1
    v_exp_f32 v124, v124
    v_exp_f32 v125, v125
    v_exp_f32 v126, v126
    v_exp_f32 v127, v127
    v_cvt_pk_bf16_f32 v120, v120, v121
    v_cvt_pk_bf16_f32 v121, v122, v123
    v_cvt_pk_bf16_f32 v122, v124, v125
    v_cvt_pk_bf16_f32 v123, v126, v127
    v_pk_fma_f32 v[128:129], v[128:129], s[80:81], v[222:223] op_sel_hi:[1,0,0] neg_lo:[0,0,1] neg_hi:[0,0,1]
    v_pk_fma_f32 v[130:131], v[130:131], s[80:81], v[222:223] op_sel_hi:[1,0,0] neg_lo:[0,0,1] neg_hi:[0,0,1]
    v_pk_fma_f32 v[132:133], v[132:133], s[80:81], v[222:223] op_sel_hi:[1,0,0] neg_lo:[0,0,1] neg_hi:[0,0,1]
    v_pk_fma_f32 v[134:135], v[134:135], s[80:81], v[222:223] op_sel_hi:[1,0,0] neg_lo:[0,0,1] neg_hi:[0,0,1]
    v_exp_f32 v128, v128
    v_exp_f32 v129, v129
    v_exp_f32 v130, v130
    v_exp_f32 v131, v131
    s_waitcnt lgkmcnt(2)
    v_mfma_f32_32x32x16_bf16 v[160:175], v[204:207], v[120:123], v[160:175]
    ds_read_b128 v[200:203], v4 offset:30720
    s_cmp_lg_u32 s75, s60
    s_cbranch_scc1 L_noclr_35
    s_cmp_eq_u32 s69, 0
    s_cbranch_scc1 L_noclr_35
    buffer_store_dwordx4 v[176:179], v181, s[20:23], s89 offen sc1
    buffer_store_dwordx4 v[176:179], v181, s[20:23], s90 offen sc1
    buffer_store_dwordx4 v[176:179], v181, s[20:23], s91 offen sc1
L_noclr_35:
    v_exp_f32 v132, v132
    v_exp_f32 v133, v133
    v_exp_f32 v134, v134
    v_exp_f32 v135, v135
    v_cvt_pk_bf16_f32 v128, v128, v129
    v_cvt_pk_bf16_f32 v129, v130, v131
    v_cvt_pk_bf16_f32 v130, v132, v133
    v_cvt_pk_bf16_f32 v131, v134, v135
    v_pk_fma_f32 v[136:137], v[136:137], s[80:81], v[222:223] op_sel_hi:[1,0,0] neg_lo:[0,0,1] neg_hi:[0,0,1]
    v_pk_fma_f32 v[138:139], v[138:139], s[80:81], v[222:223] op_sel_hi:[1,0,0] neg_lo:[0,0,1] neg_hi:[0,0,1]
    v_pk_fma_f32 v[140:141], v[140:141], s[80:81], v[222:223] op_sel_hi:[1,0,0] neg_lo:[0,0,1] neg_hi:[0,0,1]
    v_pk_fma_f32 v[142:143], v[142:143], s[80:81], v[222:223] op_sel_hi:[1,0,0] neg_lo:[0,0,1] neg_hi:[0,0,1]
    v_exp_f32 v136, v136
    v_exp_f32 v137, v137
    v_exp_f32 v138, v138
    v_exp_f32 v139, v139
    s_waitcnt lgkmcnt(2)
    v_mfma_f32_32x32x16_bf16 v[160:175], v[208:211], v[128:131], v[160:175]
    ds_read_b128 v[204:207], v4 offset:31360
    v_exp_f32 v140, v140
    v_exp_f32 v141, v141
    v_exp_f32 v142, v142
    v_exp_f32 v143, v143
    v_cvt_pk_bf16_f32 v136, v136, v137
    v_cvt_pk_bf16_f32 v137, v138, v139
    v_cvt_pk_bf16_f32 v138, v140, v141
    v_cvt_pk_bf16_f32 v139, v142, v143
    v_pk_fma_f32 v[144:145], v[144:145], s[80:81], v[222:223] op_sel_hi:[1,0,0] neg_lo:[0,0,1] neg_hi:[0,0,1]
    v_pk_fma_f32 v[146:147], v[146:147], s[80:81], v[222:223] op_sel_hi:[1,0,0] neg_lo:[0,0,1] neg_hi:[0,0,1]
    v_pk_fma_f32 v[148:149], v[148:149], s[80:81], v[222:223] op_sel_hi:[1,0,0] neg_lo:[0,0,1] neg_hi:[0,0,1]
    v_pk_fma_f32 v[150:151], v[150:151], s[80:81], v[222:223] op_sel_hi:[1,0,0] neg_lo:[0,0,1] neg_hi:[0,0,1]
    v_exp_f32 v144, v144
    v_exp_f32 v145, v145
    v_exp_f32 v146, v146
    v_exp_f32 v147, v147
    s_waitcnt lgkmcnt(2)
    v_mfma_f32_32x32x16_bf16 v[160:175], v[212:215], v[136:139], v[160:175]
    v_exp_f32 v148, v148
    v_exp_f32 v149, v149
    v_exp_f32 v150, v150
    v_exp_f32 v151, v151
    v_cvt_pk_bf16_f32 v144, v144, v145
    v_cvt_pk_bf16_f32 v145, v146, v147
    v_cvt_pk_bf16_f32 v146, v148, v149
    v_cvt_pk_bf16_f32 v147, v150, v151
    v_pk_fma_f32 v[152:153], v[152:153], s[80:81], v[222:223] op_sel_hi:[1,0,0] neg_lo:[0,0,1] neg_hi:[0,0,1]
    v_pk_fma_f32 v[154:155], v[154:155], s[80:81], v[222:223] op_sel_hi:[1,0,0] neg_lo:[0,0,1] neg_hi:[0,0,1]
    v_pk_fma_f32 v[156:157], v[156:157], s[80:81], v[222:223] op_sel_hi:[1,0,0] neg_lo:[0,0,1] neg_hi:[0,0,1]
    v_pk_fma_f32 v[158:159], v[158:159], s[80:81], v[222:223] op_sel_hi:[1,0,0] neg_lo:[0,0,1] neg_hi:[0,0,1]
    v_exp_f32 v152, v152
    v_exp_f32 v153, v153
    v_exp_f32 v154, v154
    v_exp_f32 v155, v155
    s_waitcnt lgkmcnt(1)
    v_mfma_f32_32x32x16_bf16 v[160:175], v[200:203], v[144:147], v[160:175]
    v_exp_f32 v156, v156
    v_exp_f32 v157, v157
    v_exp_f32 v158, v158
    v_exp_f32 v159, v159
    v_cvt_pk_bf16_f32 v152, v152, v153
    v_cvt_pk_bf16_f32 v153, v154, v155
    v_cvt_pk_bf16_f32 v154, v156, v157
    v_cvt_pk_bf16_f32 v155, v158, v159
    s_waitcnt lgkmcnt(0)
    s_nop 0
    v_mfma_f32_32x32x16_bf16 v[160:175], v[204:207], v[152:155], v[160:175]
    s_nop 11
    v_rcp_f32 v221, v170
    s_nop 0
    v_mul_f32 v221, v221, v220
    v_mul_f32 v160, v160, v221
    v_mul_f32 v161, v161, v221
    v_mul_f32 v162, v162, v221
    v_mul_f32 v163, v163, v221
    v_mul_f32 v164, v164, v221
    v_mul_f32 v165, v165, v221
    v_mul_f32 v166, v166, v221
    v_mul_f32 v167, v167, v221
    v_mul_f32 v168, v168, v221
    v_mul_f32 v169, v169, v221
    v_cvt_pk_bf16_f32 v160, v160, v161
    v_cvt_pk_bf16_f32 v161, v162, v163
    v_cvt_pk_bf16_f32 v162, v164, v165
    v_cvt_pk_bf16_f32 v163, v166, v167
    v_cvt_pk_bf16_f32 v164, v168, v169
    buffer_store_dwordx4 v[160:163], v12, s[20:23], s78 offen sc1
    buffer_store_dword v164, v7, s[20:23], s79 offen sc1
    s_lshl_b32 s52, s60, 3
    s_add_u32 s52, s52, 8192
    v_and_b32 v252, 7, v0
    v_add_lshl_u32 v252, v252, s52, 2
    s_barrier
    s_cmp_eq_u32 s69, 0
    s_cbranch_scc1 L_nt4_36
    ds_read_b64_tr_b16 v[60:61], v230
    ds_read_b64_tr_b16 v[62:63], v230 offset:2560
    s_add_u32 m0, s66, 0
    s_nop 0
    buffer_load_dwordx4 v224, s[84:87], s61 offen lds
    ds_read_b64_tr_b16 v[64:65], v231
    ds_read_b64_tr_b16 v[66:67], v231 offset:2560
    s_add_u32 m0, s66, 1024
    s_nop 0
    buffer_load_dwordx4 v225, s[84:87], s61 offen lds
    ds_read_b64_tr_b16 v[68:69], v232
    ds_read_b64_tr_b16 v[70:71], v232 offset:2560
    s_add_u32 m0, s66, 2048
    s_mov_b32 exec_hi, 0
    buffer_load_dwordx4 v226, s[84:87], s61 offen lds
    s_mov_b32 exec_hi, -1
    s_add_u32 s61, s61, s62
    ds_read_b64_tr_b16 v[72:73], v233
    ds_read_b64_tr_b16 v[74:75], v233 offset:2560
    s_add_u32 m0, s66, 20480
    s_nop 0
    buffer_load_dwordx4 v224, s[84:87], s61 offen lds
    s_waitcnt vmcnt(19)
    s_waitcnt lgkmcnt(6)
    v_mfma_f32_32x32x16_bf16 v[80:95], v[60:63], v[56:59], 0
    ds_read_b64_tr_b16 v[76:77], v234
    ds_read_b64_tr_b16 v[78:79], v234 offset:2560
    s_add_u32 m0, s66, 21504
    s_nop 0
    buffer_load_dwordx4 v225, s[84:87], s61 offen lds
    s_waitcnt lgkmcnt(6)
    v_mfma_f32_32x32x16_bf16 v[96:111], v[64:67], v[56:59], 0
    ds_read_b64_tr_b16 v[60:61], v230 offset:8192
    ds_read_b64_tr_b16 v[62:63], v230 offset:10752
    s_add_u32 m0, s66, 22528
    s_mov_b32 exec_hi, 0
    buffer_load_dwordx4 v226, s[84:87], s61 offen lds
    s_mov_b32 exec_hi, -1
    s_add_u32 s61, s61, s62
    s_waitcnt lgkmcnt(6)
    v_mfma_f32_32x32x16_bf16 v[112:127], v[68:71], v[56:59], 0
    ds_read_b64_tr_b16 v[64:65], v231 offset:8192
    ds_read_b64_tr_b16 v[66:67], v231 offset:10752
    s_waitcnt lgkmcnt(6)
    v_mfma_f32_32x32x16_bf16 v[128:143], v[72:75], v[56:59], 0
    ds_read_b64_tr_b16 v[68:69], v232 offset:8192
    ds_read_b64_tr_b16 v[70:71], v232 offset:10752
    s_waitcnt lgkmcnt(6)
    v_mfma_f32_32x32x16_bf16 v[144:159], v[76:79], v[56:59], 0
    ds_read_b64_tr_b16 v[72:73], v233 offset:8192
    ds_read_b64_tr_b16 v[74:75], v233 offset:10752
    s_waitcnt vmcnt(20)
    s_waitcnt lgkmcnt(6)
    v_mfma_f32_32x32x16_bf16 v[80:95], v[60:63], v[16:19], v[80:95]
    ds_read_b64_tr_b16 v[76:77], v234 offset:8192
    ds_read_b64_tr_b16 v[78:79], v234 offset:10752
    s_waitcnt lgkmcnt(6)
    v_mfma_f32_32x32x16_bf16 v[96:111], v[64:67], v[16:19], v[96:111]
    ds_read_b64_tr_b16 v[60:61], v230 offset:13312
    ds_read_b64_tr_b16 v[62:63], v230 offset:15872
    s_waitcnt lgkmcnt(6)
    v_mfma_f32_32x32x16_bf16 v[112:127], v[68:71], v[16:19], v[112:127]
    ds_read_b64_tr_b16 v[64:65], v231 offset:13312
    ds_read_b64_tr_b16 v[66:67], v231 offset:15872
    s_waitcnt lgkmcnt(6)
    v_mfma_f32_32x32x16_bf16 v[128:143], v[72:75], v[16:19], v[128:143]
    ds_read_b64_tr_b16 v[68:69], v232 offset:13312
    ds_read_b64_tr_b16 v[70:71], v232 offset:15872
    s_waitcnt lgkmcnt(6)
    v_mfma_f32_32x32x16_bf16 v[144:159], v[76:79], v[16:19], v[144:159]
    buffer_load_dwordx4 v[16:19], v235, s[20:23], s63 offen offset:0 sc1
    ds_read_b64_tr_b16 v[72:73], v233 offset:13312
    ds_read_b64_tr_b16 v[74:75], v233 offset:15872
    s_waitcnt vmcnt(20)
    s_waitcnt lgkmcnt(6)
    v_mfma_f32_32x32x16_bf16 v[80:95], v[60:63], v[20:23], v[80:95]
    ds_read_b64_tr_b16 v[76:77], v234 offset:13312
    ds_read_b64_tr_b16 v[78:79], v234 offset:15872
    s_waitcnt lgkmcnt(6)
    v_mfma_f32_32x32x16_bf16 v[96:111], v[64:67], v[20:23], v[96:111]
    ds_read_b64_tr_b16 v[60:61], v230 offset:28672
    ds_read_b64_tr_b16 v[62:63], v230 offset:31232
    s_waitcnt lgkmcnt(6)
    v_mfma_f32_32x32x16_bf16 v[112:127], v[68:71], v[20:23], v[112:127]
    ds_read_b64_tr_b16 v[64:65], v231 offset:28672
    ds_read_b64_tr_b16 v[66:67], v231 offset:31232
    s_waitcnt lgkmcnt(6)
    v_mfma_f32_32x32x16_bf16 v[128:143], v[72:75], v[20:23], v[128:143]
    ds_read_b64_tr_b16 v[68:69], v232 offset:28672
    ds_read_b64_tr_b16 v[70:71], v232 offset:31232
    s_waitcnt lgkmcnt(6)
    v_mfma_f32_32x32x16_bf16 v[144:159], v[76:79], v[20:23], v[144:159]
    buffer_load_dwordx4 v[20:23], v235, s[20:23], s63 offen offset:1024 sc1
    s_add_u32 s63, s63, 4096
    ds_read_b64_tr_b16 v[72:73], v233 offset:28672
    ds_read_b64_tr_b16 v[74:75], v233 offset:31232
    s_waitcnt vmcnt(20)
    s_waitcnt lgkmcnt(6)
    v_mfma_f32_32x32x16_bf16 v[80:95], v[60:63], v[24:27], v[80:95]
    ds_read_b64_tr_b16 v[76:77], v234 offset:28672
    ds_read_b64_tr_b16 v[78:79], v234 offset:31232
    s_waitcnt lgkmcnt(6)
    v_mfma_f32_32x32x16_bf16 v[96:111], v[64:67], v[24:27], v[96:111]
    ds_read_b64_tr_b16 v[60:61], v230 offset:33792
    ds_read_b64_tr_b16 v[62:63], v230 offset:36352
    s_waitcnt lgkmcnt(6)
    v_mfma_f32_32x32x16_bf16 v[112:127], v[68:71], v[24:27], v[112:127]
    ds_read_b64_tr_b16 v[64:65], v231 offset:33792
    ds_read_b64_tr_b16 v[66:67], v231 offset:36352
    s_waitcnt lgkmcnt(6)
    v_mfma_f32_32x32x16_bf16 v[128:143], v[72:75], v[24:27], v[128:143]
    ds_read_b64_tr_b16 v[68:69], v232 offset:33792
    ds_read_b64_tr_b16 v[70:71], v232 offset:36352
    s_waitcnt lgkmcnt(6)
    v_mfma_f32_32x32x16_bf16 v[144:159], v[76:79], v[24:27], v[144:159]
    buffer_load_dwordx4 v[24:27], v235, s[20:23], s63 offen offset:0 sc1
    ds_read_b64_tr_b16 v[72:73], v233 offset:33792
    ds_read_b64_tr_b16 v[74:75], v233 offset:36352
    s_waitcnt vmcnt(20)
    s_waitcnt lgkmcnt(6)
    v_mfma_f32_32x32x16_bf16 v[80:95], v[60:63], v[28:31], v[80:95]
    ds_read_b64_tr_b16 v[76:77], v234 offset:33792
    ds_read_b64_tr_b16 v[78:79], v234 offset:36352
    s_waitcnt lgkmcnt(6)
    v_mfma_f32_32x32x16_bf16 v[96:111], v[64:67], v[28:31], v[96:111]
    s_barrier
    s_waitcnt vmcnt(9)
    s_add_u32 s52, s3, 16384
    v_mov_b32 v254, s50
    s_mov_b64 exec, 1
    buffer_store_dword v254, off, s[20:23], s52 offset:0 sc1
    s_mov_b64 exec, -1
    ds_read_b64_tr_b16 v[60:61], v230 offset:49152
    ds_read_b64_tr_b16 v[62:63], v230 offset:51712
    s_waitcnt lgkmcnt(6)
    v_mfma_f32_32x32x16_bf16 v[112:127], v[68:71], v[28:31], v[112:127]
    ds_read_b64_tr_b16 v[64:65], v231 offset:49152
    ds_read_b64_tr_b16 v[66:67], v231 offset:51712
    s_add_u32 m0, s66, 40960
    s_nop 0
    buffer_load_dwordx4 v224, s[84:87], s61 offen lds
    s_waitcnt lgkmcnt(6)
    v_mfma_f32_32x32x16_bf16 v[128:143], v[72:75], v[28:31], v[128:143]
    ds_read_b64_tr_b16 v[68:69], v232 offset:49152
    ds_read_b64_tr_b16 v[70:71], v232 offset:51712
    s_waitcnt lgkmcnt(6)
    v_mfma_f32_32x32x16_bf16 v[144:159], v[76:79], v[28:31], v[144:159]
    buffer_load_dwordx4 v[28:31], v235, s[20:23], s63 offen offset:1024 sc1
    s_add_u32 s63, s63, 4096
    ds_read_b64_tr_b16 v[72:73], v233 offset:49152
    ds_read_b64_tr_b16 v[74:75], v233 offset:51712
    s_add_u32 m0, s66, 41984
    s_nop 0
    buffer_load_dwordx4 v225, s[84:87], s61 offen lds
    s_waitcnt lgkmcnt(6)
    v_mfma_f32_32x32x16_bf16 v[80:95], v[60:63], v[32:35], v[80:95]
    ds_read_b64_tr_b16 v[76:77], v234 offset:49152
    ds_read_b64_tr_b16 v[78:79], v234 offset:51712
    s_waitcnt lgkmcnt(6)
    v_mfma_f32_32x32x16_bf16 v[96:111], v[64:67], v[32:35], v[96:111]
    ds_read_b64_tr_b16 v[60:61], v230 offset:54272
    ds_read_b64_tr_b16 v[62:63], v230 offset:56832
    s_waitcnt lgkmcnt(6)
    v_mfma_f32_32x32x16_bf16 v[112:127], v[68:71], v[32:35], v[112:127]
    ds_read_b64_tr_b16 v[64:65], v231 offset:54272
    ds_read_b64_tr_b16 v[66:67], v231 offset:56832
    s_add_u32 m0, s66, 43008
    s_mov_b32 exec_hi, 0
    buffer_load_dwordx4 v226, s[84:87], s61 offen lds
    s_mov_b32 exec_hi, -1
    s_add_u32 s61, s61, s62
    s_waitcnt lgkmcnt(6)
    v_mfma_f32_32x32x16_bf16 v[128:143], v[72:75], v[32:35], v[128:143]
    ds_read_b64_tr_b16 v[68:69], v232 offset:54272
    ds_read_b64_tr_b16 v[70:71], v232 offset:56832
    s_waitcnt lgkmcnt(6)
    v_mfma_f32_32x32x16_bf16 v[144:159], v[76:79], v[32:35], v[144:159]
    buffer_load_dwordx4 v[32:35], v235, s[20:23], s63 offen offset:0 sc1
    ds_read_b64_tr_b16 v[72:73], v233 offset:54272
    ds_read_b64_tr_b16 v[74:75], v233 offset:56832
    s_add_u32 m0, s66, 61440
    s_nop 0
    buffer_load_dwordx4 v224, s[84:87], s61 offen lds
    s_waitcnt lgkmcnt(6)
    v_mfma_f32_32x32x16_bf16 v[80:95], v[60:63], v[36:39], v[80:95]
    ds_read_b64_tr_b16 v[76:77], v234 offset:54272
    ds_read_b64_tr_b16 v[78:79], v234 offset:56832
    s_waitcnt lgkmcnt(6)
    v_mfma_f32_32x32x16_bf16 v[96:111], v[64:67], v[36:39], v[96:111]
    v_add_u32 v230, 69632, v230
    v_add_u32 v231, 69632, v231
    v_add_u32 v232, 69632, v232
    v_add_u32 v233, 69632, v233
    v_add_u32 v234, 69632, v234
    ds_read_b64_tr_b16 v[60:61], v230 offset:0
    ds_read_b64_tr_b16 v[62:63], v230 offset:2560
    s_waitcnt lgkmcnt(6)
    v_mfma_f32_32x32x16_bf16 v[112:127], v[68:71], v[36:39], v[112:127]
    ds_read_b64_tr_b16 v[64:65], v231 offset:0
    ds_read_b64_tr_b16 v[66:67], v231 offset:2560
    s_add_u32 m0, s66, 62464
    s_nop 0
    buffer_load_dwordx4 v225, s[84:87], s61 offen lds
    s_waitcnt lgkmcnt(6)
    v_mfma_f32_32x32x16_bf16 v[128:143], v[72:75], v[36:39], v[128:143]
    ds_read_b64_tr_b16 v[68:69], v232 offset:0
    ds_read_b64_tr_b16 v[70:71], v232 offset:2560
    s_waitcnt lgkmcnt(6)
    v_mfma_f32_32x32x16_bf16 v[144:159], v[76:79], v[36:39], v[144:159]
    buffer_load_dword v253, v252, s[20:23], s4 offen sc1
    buffer_load_dwordx4 v[36:39], v235, s[20:23], s63 offen offset:1024 sc1
    s_add_u32 s63, s63, 4096
    ds_read_b64_tr_b16 v[72:73], v233 offset:0
    ds_read_b64_tr_b16 v[74:75], v233 offset:2560
    s_add_u32 m0, s66, 63488
    s_mov_b32 exec_hi, 0
    buffer_load_dwordx4 v226, s[84:87], s61 offen lds
    s_mov_b32 exec_hi, -1
    s_add_u32 s61, s61, s62
    s_waitcnt lgkmcnt(6)
    v_mfma_f32_32x32x16_bf16 v[80:95], v[60:63], v[40:43], v[80:95]
    ds_read_b64_tr_b16 v[76:77], v234 offset:0
    ds_read_b64_tr_b16 v[78:79], v234 offset:2560
    s_waitcnt lgkmcnt(6)
    v_mfma_f32_32x32x16_bf16 v[96:111], v[64:67], v[40:43], v[96:111]
    ds_read_b64_tr_b16 v[60:61], v230 offset:5120
    ds_read_b64_tr_b16 v[62:63], v230 offset:7680
    s_waitcnt lgkmcnt(6)
    v_mfma_f32_32x32x16_bf16 v[112:127], v[68:71], v[40:43], v[112:127]
    ds_read_b64_tr_b16 v[64:65], v231 offset:5120
    ds_read_b64_tr_b16 v[66:67], v231 offset:7680
    s_add_u32 m0, s66, 81920
    s_nop 0
    buffer_load_dwordx4 v224, s[84:87], s61 offen lds
    s_waitcnt lgkmcnt(6)
    v_mfma_f32_32x32x16_bf16 v[128:143], v[72:75], v[40:43], v[128:143]
    ds_read_b64_tr_b16 v[68:69], v232 offset:5120
    ds_read_b64_tr_b16 v[70:71], v232 offset:7680
    s_waitcnt lgkmcnt(6)
    v_mfma_f32_32x32x16_bf16 v[144:159], v[76:79], v[40:43], v[144:159]
    buffer_load_dwordx4 v[40:43], v235, s[20:23], s63 offen offset:0 sc1
    ds_read_b64_tr_b16 v[72:73], v233 offset:5120
    ds_read_b64_tr_b16 v[74:75], v233 offset:7680
    s_add_u32 m0, s66, 82944
    s_nop 0
    buffer_load_dwordx4 v225, s[84:87], s61 offen lds
    s_waitcnt lgkmcnt(6)
    v_mfma_f32_32x32x16_bf16 v[80:95], v[60:63], v[44:47], v[80:95]
    ds_read_b64_tr_b16 v[76:77], v234 offset:5120
    ds_read_b64_tr_b16 v[78:79], v234 offset:7680
    s_waitcnt lgkmcnt(6)
    v_mfma_f32_32x32x16_bf16 v[96:111], v[64:67], v[44:47], v[96:111]
    s_add_u32 m0, s66, 83968
    s_mov_b32 exec_hi, 0
    buffer_load_dwordx4 v226, s[84:87], s61 offen lds
    s_mov_b32 exec_hi, -1
    s_add_u32 s61, s61, s62
    s_waitcnt vmcnt(20)
    s_barrier
    ds_read_b64_tr_b16 v[60:61], v230 offset:20480
    ds_read_b64_tr_b16 v[62:63], v230 offset:23040
    s_waitcnt lgkmcnt(6)
    v_mfma_f32_32x32x16_bf16 v[112:127], v[68:71], v[44:47], v[112:127]
    ds_read_b64_tr_b16 v[64:65], v231 offset:20480
    ds_read_b64_tr_b16 v[66:67], v231 offset:23040
    s_add_u32 m0, s66, 102400
    s_nop 0
    buffer_load_dwordx4 v224, s[84:87], s61 offen lds
    s_waitcnt lgkmcnt(6)
    v_mfma_f32_32x32x16_bf16 v[128:143], v[72:75], v[44:47], v[128:143]
    ds_read_b64_tr_b16 v[68:69], v232 offset:20480
    ds_read_b64_tr_b16 v[70:71], v232 offset:23040
    s_waitcnt lgkmcnt(6)
    v_mfma_f32_32x32x16_bf16 v[144:159], v[76:79], v[44:47], v[144:159]
    buffer_load_dwordx4 v[44:47], v235, s[20:23], s63 offen offset:1024 sc1
    s_add_u32 s63, s63, 4096
    ds_read_b64_tr_b16 v[72:73], v233 offset:20480
    ds_read_b64_tr_b16 v[74:75], v233 offset:23040
    s_add_u32 m0, s66, 103424
    s_nop 0
    buffer_load_dwordx4 v225, s[84:87], s61 offen lds
    s_waitcnt lgkmcnt(6)
    v_mfma_f32_32x32x16_bf16 v[80:95], v[60:63], v[48:51], v[80:95]
    ds_read_b64_tr_b16 v[76:77], v234 offset:20480
    ds_read_b64_tr_b16 v[78:79], v234 offset:23040
    s_waitcnt lgkmcnt(6)
    v_mfma_f32_32x32x16_bf16 v[96:111], v[64:67], v[48:51], v[96:111]
    ds_read_b64_tr_b16 v[60:61], v230 offset:25600
    ds_read_b64_tr_b16 v[62:63], v230 offset:28160
    s_waitcnt lgkmcnt(6)
    v_mfma_f32_32x32x16_bf16 v[112:127], v[68:71], v[48:51], v[112:127]
    ds_read_b64_tr_b16 v[64:65], v231 offset:25600
    ds_read_b64_tr_b16 v[66:67], v231 offset:28160
    s_add_u32 m0, s66, 104448
    s_mov_b32 exec_hi, 0
    buffer_load_dwordx4 v226, s[84:87], s61 offen lds
    s_mov_b32 exec_hi, -1
    s_add_u32 s61, s61, s62
    s_waitcnt lgkmcnt(6)
    v_mfma_f32_32x32x16_bf16 v[128:143], v[72:75], v[48:51], v[128:143]
    ds_read_b64_tr_b16 v[68:69], v232 offset:25600
    ds_read_b64_tr_b16 v[70:71], v232 offset:28160
    s_waitcnt lgkmcnt(6)
    v_mfma_f32_32x32x16_bf16 v[144:159], v[76:79], v[48:51], v[144:159]
    s_waitcnt vmcnt(10)
    s_mov_b32 s59, 30000
L_pl_40:
    v_cmp_ne_u32 vcc, s50, v253
    s_nop 4
    s_cbranch_vccz L_pd_39
    buffer_load_dword v253, v252, s[20:23], s4 offen sc1
    s_waitcnt vmcnt(0)
    s_sub_u32 s59, s59, 1
    s_cmp_lg_u32 s59, 0
    s_cbranch_scc1 L_pl_40
L_pd_39:
    v_and_b32 v252, 31, v0
    v_lshlrev_b32 v252, 2, v252
    v_add_u32 v252, 16384, v252
    buffer_load_dwordx4 v[48:51], v235, s[20:23], s63 offen offset:0 sc1
    ds_read_b64_tr_b16 v[72:73], v233 offset:25600
    ds_read_b64_tr_b16 v[74:75], v233 offset:28160
    s_add_u32 m0, s66, 122880
    s_nop 0
    buffer_load_dwordx4 v224, s[84:87], s61 offen lds
    s_waitcnt lgkmcnt(6)
    v_mfma_f32_32x32x16_bf16 v[80:95], v[60:63], v[52:55], v[80:95]
    ds_read_b64_tr_b16 v[76:77], v234 offset:25600
    ds_read_b64_tr_b16 v[78:79], v234 offset:28160
    s_waitcnt lgkmcnt(6)
    v_mfma_f32_32x32x16_bf16 v[96:111], v[64:67], v[52:55], v[96:111]
    v_subrev_u32 v230, 122880, v230
    v_subrev_u32 v231, 122880, v231
    v_subrev_u32 v232, 122880, v232
    v_subrev_u32 v233, 122880, v233
    v_subrev_u32 v234, 122880, v234
    ds_read_b64_tr_b16 v[60:61], v230 offset:0
    ds_read_b64_tr_b16 v[62:63], v230 offset:2560
    s_waitcnt lgkmcnt(6)
    v_mfma_f32_32x32x16_bf16 v[112:127], v[68:71], v[52:55], v[112:127]
    ds_read_b64_tr_b16 v[64:65], v231 offset:0
    ds_read_b64_tr_b16 v[66:67], v231 offset:2560
    s_add_u32 m0, s66, 123904
    s_nop 0
    buffer_load_dwordx4 v225, s[84:87], s61 offen lds
    s_waitcnt lgkmcnt(6)
    v_mfma_f32_32x32x16_bf16 v[128:143], v[72:75], v[52:55], v[128:143]
    ds_read_b64_tr_b16 v[68:69], v232 offset:0
    ds_read_b64_tr_b16 v[70:71], v232 offset:2560
    s_waitcnt lgkmcnt(6)
    v_mfma_f32_32x32x16_bf16 v[144:159], v[76:79], v[52:55], v[144:159]
    buffer_load_dwordx4 v[52:55], v235, s[20:23], s63 offen offset:1024 sc1
    s_add_u32 s63, s63, 4096
    ds_read_b64_tr_b16 v[72:73], v233 offset:0
    ds_read_b64_tr_b16 v[74:75], v233 offset:2560
    s_add_u32 m0, s66, 124928
    s_mov_b32 exec_hi, 0
    buffer_load_dwordx4 v226, s[84:87], s61 offen lds
    s_mov_b32 exec_hi, -1
    s_add_u32 s61, s61, s62
    s_waitcnt lgkmcnt(6)
    v_mfma_f32_32x32x16_bf16 v[80:95], v[60:63], v[16:19], v[80:95]
    ds_read_b64_tr_b16 v[76:77], v234 offset:0
    ds_read_b64_tr_b16 v[78:79], v234 offset:2560
    s_waitcnt lgkmcnt(6)
    v_mfma_f32_32x32x16_bf16 v[96:111], v[64:67], v[16:19], v[96:111]
    ds_read_b64_tr_b16 v[60:61], v230 offset:5120
    ds_read_b64_tr_b16 v[62:63], v230 offset:7680
    s_waitcnt lgkmcnt(6)
    v_mfma_f32_32x32x16_bf16 v[112:127], v[68:71], v[16:19], v[112:127]
    ds_read_b64_tr_b16 v[64:65], v231 offset:5120
    ds_read_b64_tr_b16 v[66:67], v231 offset:7680
    s_waitcnt lgkmcnt(6)
    v_mfma_f32_32x32x16_bf16 v[128:143], v[72:75], v[16:19], v[128:143]
    ds_read_b64_tr_b16 v[68:69], v232 offset:5120
    ds_read_b64_tr_b16 v[70:71], v232 offset:7680
    s_waitcnt lgkmcnt(6)
    v_mfma_f32_32x32x16_bf16 v[144:159], v[76:79], v[16:19], v[144:159]
    buffer_load_dwordx4 v[16:19], v235, s[20:23], s63 offen offset:0 sc1
    ds_read_b64_tr_b16 v[72:73], v233 offset:5120
    ds_read_b64_tr_b16 v[74:75], v233 offset:7680
    s_waitcnt lgkmcnt(6)
    v_mfma_f32_32x32x16_bf16 v[80:95], v[60:63], v[20:23], v[80:95]
    ds_read_b64_tr_b16 v[76:77], v234 offset:5120
    ds_read_b64_tr_b16 v[78:79], v234 offset:7680
    s_waitcnt lgkmcnt(6)
    v_mfma_f32_32x32x16_bf16 v[96:111], v[64:67], v[20:23], v[96:111]
    s_barrier
    ds_read_b64_tr_b16 v[60:61], v230 offset:20480
    ds_read_b64_tr_b16 v[62:63], v230 offset:23040
    s_waitcnt lgkmcnt(6)
    v_mfma_f32_32x32x16_bf16 v[112:127], v[68:71], v[20:23], v[112:127]
    ds_read_b64_tr_b16 v[64:65], v231 offset:20480
    ds_read_b64_tr_b16 v[66:67], v231 offset:23040
    s_add_u32 m0, s66, 143360
    s_nop 0
    buffer_load_dwordx4 v224, s[84:87], s61 offen lds
    s_waitcnt lgkmcnt(6)
    v_mfma_f32_32x32x16_bf16 v[128:143], v[72:75], v[20:23], v[128:143]
    ds_read_b64_tr_b16 v[68:69], v232 offset:20480
    ds_read_b64_tr_b16 v[70:71], v232 offset:23040
    s_waitcnt lgkmcnt(6)
    v_mfma_f32_32x32x16_bf16 v[144:159], v[76:79], v[20:23], v[144:159]
    buffer_load_dwordx4 v[20:23], v235, s[20:23], s63 offen offset:1024 sc1
    s_add_u32 s63, s63, 4096
    ds_read_b64_tr_b16 v[72:73], v233 offset:20480
    ds_read_b64_tr_b16 v[74:75], v233 offset:23040
    s_add_u32 m0, s66, 144384
    s_nop 0
    buffer_load_dwordx4 v225, s[84:87], s61 offen lds
    s_waitcnt lgkmcnt(6)
    v_mfma_f32_32x32x16_bf16 v[80:95], v[60:63], v[24:27], v[80:95]
    ds_read_b64_tr_b16 v[76:77], v234 offset:20480
    ds_read_b64_tr_b16 v[78:79], v234 offset:23040
    s_waitcnt lgkmcnt(6)
    v_mfma_f32_32x32x16_bf16 v[96:111], v[64:67], v[24:27], v[96:111]
    ds_read_b64_tr_b16 v[60:61], v230 offset:25600
    ds_read_b64_tr_b16 v[62:63], v230 offset:28160
    s_waitcnt lgkmcnt(6)
    v_mfma_f32_32x32x16_bf16 v[112:127], v[68:71], v[24:27], v[112:127]
    ds_read_b64_tr_b16 v[64:65], v231 offset:25600
    ds_read_b64_tr_b16 v[66:67], v231 offset:28160
    s_add_u32 m0, s66, 145408
    s_mov_b32 exec_hi, 0
    buffer_load_dwordx4 v226, s[84:87], s61 offen lds
    s_mov_b32 exec_hi, -1
    s_add_u32 s61, s61, s62
    s_waitcnt lgkmcnt(6)
    v_mfma_f32_32x32x16_bf16 v[128:143], v[72:75], v[24:27], v[128:143]
    ds_read_b64_tr_b16 v[68:69], v232 offset:25600
    ds_read_b64_tr_b16 v[70:71], v232 offset:28160
    s_waitcnt lgkmcnt(6)
    v_mfma_f32_32x32x16_bf16 v[144:159], v[76:79], v[24:27], v[144:159]
    buffer_load_dwordx4 v[24:27], v235, s[20:23], s63 offen offset:0 sc1
    ds_read_b64_tr_b16 v[72:73], v233 offset:25600
    ds_read_b64_tr_b16 v[74:75], v233 offset:28160
    s_add_u32 m0, s66, 0
    s_nop 0
    buffer_load_dwordx4 v224, s[84:87], s61 offen lds
    s_waitcnt lgkmcnt(6)
    v_mfma_f32_32x32x16_bf16 v[80:95], v[60:63], v[28:31], v[80:95]
    ds_read_b64_tr_b16 v[76:77], v234 offset:25600
    ds_read_b64_tr_b16 v[78:79], v234 offset:28160
    s_waitcnt lgkmcnt(6)
    v_mfma_f32_32x32x16_bf16 v[96:111], v[64:67], v[28:31], v[96:111]
    ds_read_b64_tr_b16 v[60:61], v230 offset:40960
    ds_read_b64_tr_b16 v[62:63], v230 offset:43520
    s_waitcnt lgkmcnt(6)
    v_mfma_f32_32x32x16_bf16 v[112:127], v[68:71], v[28:31], v[112:127]
    ds_read_b64_tr_b16 v[64:65], v231 offset:40960
    ds_read_b64_tr_b16 v[66:67], v231 offset:43520
    s_add_u32 m0, s66, 1024
    s_nop 0
    buffer_load_dwordx4 v225, s[84:87], s61 offen lds
    s_waitcnt lgkmcnt(6)
    v_mfma_f32_32x32x16_bf16 v[128:143], v[72:75], v[28:31], v[128:143]
    ds_read_b64_tr_b16 v[68:69], v232 offset:40960
    ds_read_b64_tr_b16 v[70:71], v232 offset:43520
    s_waitcnt lgkmcnt(6)
    v_mfma_f32_32x32x16_bf16 v[144:159], v[76:79], v[28:31], v[144:159]
    buffer_load_dwordx4 v[28:31], v235, s[20:23], s63 offen offset:1024 sc1
    s_add_u32 s63, s63, 4096
    ds_read_b64_tr_b16 v[72:73], v233 offset:40960
    ds_read_b64_tr_b16 v[74:75], v233 offset:43520
    s_add_u32 m0, s66, 2048
    s_mov_b32 exec_hi, 0
    buffer_load_dwordx4 v226, s[84:87], s61 offen lds
    s_mov_b32 exec_hi, -1
    s_add_u32 s61, s61, s62
    s_waitcnt lgkmcnt(6)
    v_mfma_f32_32x32x16_bf16 v[80:95], v[60:63], v[32:35], v[80:95]
    ds_read_b64_tr_b16 v[76:77], v234 offset:40960
    ds_read_b64_tr_b16 v[78:79], v234 offset:43520
    s_waitcnt lgkmcnt(6)
    v_mfma_f32_32x32x16_bf16 v[96:111], v[64:67], v[32:35], v[96:111]
    ds_read_b64_tr_b16 v[60:61], v230 offset:46080
    ds_read_b64_tr_b16 v[62:63], v230 offset:48640
    s_waitcnt lgkmcnt(6)
    v_mfma_f32_32x32x16_bf16 v[112:127], v[68:71], v[32:35], v[112:127]
    ds_read_b64_tr_b16 v[64:65], v231 offset:46080
    ds_read_b64_tr_b16 v[66:67], v231 offset:48640
    s_waitcnt lgkmcnt(6)
    v_mfma_f32_32x32x16_bf16 v[128:143], v[72:75], v[32:35], v[128:143]
    ds_read_b64_tr_b16 v[68:69], v232 offset:46080
    ds_read_b64_tr_b16 v[70:71], v232 offset:48640
    s_waitcnt lgkmcnt(6)
    v_mfma_f32_32x32x16_bf16 v[144:159], v[76:79], v[32:35], v[144:159]
    s_lshl_b32 s52, s60, 2
    s_add_u32 s52, s52, s71
    v_mov_b32 v254, s50
    s_mov_b64 exec, 1
    buffer_store_dword v254, off, s[20:23], s52 offset:0 sc1
    s_mov_b64 exec, -1
    buffer_load_dwordx4 v[32:35], v235, s[20:23], s63 offen offset:0 sc1
    ds_read_b64_tr_b16 v[72:73], v233 offset:46080
    ds_read_b64_tr_b16 v[74:75], v233 offset:48640
    s_waitcnt vmcnt(25)
    s_waitcnt lgkmcnt(6)
    v_mfma_f32_32x32x16_bf16 v[80:95], v[60:63], v[36:39], v[80:95]
    ds_read_b64_tr_b16 v[76:77], v234 offset:46080
    ds_read_b64_tr_b16 v[78:79], v234 offset:48640
    s_waitcnt lgkmcnt(6)
    v_mfma_f32_32x32x16_bf16 v[96:111], v[64:67], v[36:39], v[96:111]
    s_waitcnt vmcnt(20)
    s_barrier
    ds_read_b64_tr_b16 v[60:61], v230 offset:61440
    ds_read_b64_tr_b16 v[62:63], v230 offset:64000
    s_waitcnt lgkmcnt(6)
    v_mfma_f32_32x32x16_bf16 v[112:127], v[68:71], v[36:39], v[112:127]
    ds_read_b64_tr_b16 v[64:65], v231 offset:61440
    ds_read_b64_tr_b16 v[66:67], v231 offset:64000
    s_add_u32 m0, s66, 20480
    s_nop 0
    buffer_load_dwordx4 v224, s[84:87], s61 offen lds
    s_waitcnt lgkmcnt(6)
    v_mfma_f32_32x32x16_bf16 v[128:143], v[72:75], v[36:39], v[128:143]
    ds_read_b64_tr_b16 v[68:69], v232 offset:61440
    ds_read_b64_tr_b16 v[70:71], v232 offset:64000
    s_waitcnt lgkmcnt(6)
    v_mfma_f32_32x32x16_bf16 v[144:159], v[76:79], v[36:39], v[144:159]
    buffer_load_dwordx4 v[36:39], v235, s[20:23], s63 offen offset:1024 sc1
    s_add_u32 s63, s63, 4096
    ds_read_b64_tr_b16 v[72:73], v233 offset:61440
    ds_read_b64_tr_b16 v[74:75], v233 offset:64000
    s_add_u32 m0, s66, 21504
    s_nop 0
    buffer_load_dwordx4 v225, s[84:87], s61 offen lds
    s_waitcnt lgkmcnt(6)
    v_mfma_f32_32x32x16_bf16 v[80:95], v[60:63], v[40:43], v[80:95]
    ds_read_b64_tr_b16 v[76:77], v234 offset:61440
    ds_read_b64_tr_b16 v[78:79], v234 offset:64000
    s_waitcnt lgkmcnt(6)
    v_mfma_f32_32x32x16_bf16 v[96:111], v[64:67], v[40:43], v[96:111]
    v_add_u32 v230, 61440, v230
    v_add_u32 v231, 61440, v231
    v_add_u32 v232, 61440, v232
    v_add_u32 v233, 61440, v233
    v_add_u32 v234, 61440, v234
    ds_read_b64_tr_b16 v[60:61], v230 offset:5120
    ds_read_b64_tr_b16 v[62:63], v230 offset:7680
    s_waitcnt lgkmcnt(6)
    v_mfma_f32_32x32x16_bf16 v[112:127], v[68:71], v[40:43], v[112:127]
    ds_read_b64_tr_b16 v[64:65], v231 offset:5120
    ds_read_b64_tr_b16 v[66:67], v231 offset:7680
    s_add_u32 m0, s66, 22528
    s_mov_b32 exec_hi, 0
    buffer_load_dwordx4 v226, s[84:87], s61 offen lds
    s_mov_b32 exec_hi, -1
    s_add_u32 s61, s61, s62
    s_waitcnt lgkmcnt(6)
    v_mfma_f32_32x32x16_bf16 v[128:143], v[72:75], v[40:43], v[128:143]
    ds_read_b64_tr_b16 v[68:69], v232 offset:5120
    ds_read_b64_tr_b16 v[70:71], v232 offset:7680
    s_waitcnt lgkmcnt(6)
    v_mfma_f32_32x32x16_bf16 v[144:159], v[76:79], v[40:43], v[144:159]
    buffer_load_dwordx4 v[40:43], v235, s[20:23], s63 offen offset:0 sc1
    ds_read_b64_tr_b16 v[72:73], v233 offset:5120
    ds_read_b64_tr_b16 v[74:75], v233 offset:7680
    s_add_u32 m0, s66, 40960
    s_nop 0
    buffer_load_dwordx4 v224, s[84:87], s61 offen lds
    s_waitcnt vmcnt(24)
    s_waitcnt lgkmcnt(6)
    v_mfma_f32_32x32x16_bf16 v[80:95], v[60:63], v[44:47], v[80:95]
    ds_read_b64_tr_b16 v[76:77], v234 offset:5120
    ds_read_b64_tr_b16 v[78:79], v234 offset:7680
    s_waitcnt lgkmcnt(6)
    v_mfma_f32_32x32x16_bf16 v[96:111], v[64:67], v[44:47], v[96:111]
    ds_read_b64_tr_b16 v[60:61], v230 offset:20480
    ds_read_b64_tr_b16 v[62:63], v230 offset:23040
    s_waitcnt lgkmcnt(6)
    v_mfma_f32_32x32x16_bf16 v[112:127], v[68:71], v[44:47], v[112:127]
    ds_read_b64_tr_b16 v[64:65], v231 offset:20480
    ds_read_b64_tr_b16 v[66:67], v231 offset:23040
    s_add_u32 m0, s66, 41984
    s_nop 0
    buffer_load_dwordx4 v225, s[84:87], s61 offen lds
    s_waitcnt lgkmcnt(6)
    v_mfma_f32_32x32x16_bf16 v[128:143], v[72:75], v[44:47], v[128:143]
    ds_read_b64_tr_b16 v[68:69], v232 offset:20480
    ds_read_b64_tr_b16 v[70:71], v232 offset:23040
    s_waitcnt lgkmcnt(6)
    v_mfma_f32_32x32x16_bf16 v[144:159], v[76:79], v[44:47], v[144:159]
    buffer_load_dwordx4 v[44:47], v235, s[20:23], s63 offen offset:1024 sc1
    s_add_u32 s63, s63, 4096
    ds_read_b64_tr_b16 v[72:73], v233 offset:20480
    ds_read_b64_tr_b16 v[74:75], v233 offset:23040
    s_add_u32 m0, s66, 43008
    s_mov_b32 exec_hi, 0
    buffer_load_dwordx4 v226, s[84:87], s61 offen lds
    s_mov_b32 exec_hi, -1
    s_add_u32 s61, s61, s62
    s_waitcnt vmcnt(24)
    s_waitcnt lgkmcnt(6)
    v_mfma_f32_32x32x16_bf16 v[80:95], v[60:63], v[48:51], v[80:95]
    ds_read_b64_tr_b16 v[76:77], v234 offset:20480
    ds_read_b64_tr_b16 v[78:79], v234 offset:23040
    s_waitcnt lgkmcnt(6)
    v_mfma_f32_32x32x16_bf16 v[96:111], v[64:67], v[48:51], v[96:111]
    ds_read_b64_tr_b16 v[60:61], v230 offset:25600
    ds_read_b64_tr_b16 v[62:63], v230 offset:28160
    s_waitcnt lgkmcnt(6)
    v_mfma_f32_32x32x16_bf16 v[112:127], v[68:71], v[48:51], v[112:127]
    ds_read_b64_tr_b16 v[64:65], v231 offset:25600
    ds_read_b64_tr_b16 v[66:67], v231 offset:28160
    s_waitcnt lgkmcnt(6)
    v_mfma_f32_32x32x16_bf16 v[128:143], v[72:75], v[48:51], v[128:143]
    ds_read_b64_tr_b16 v[68:69], v232 offset:25600
    ds_read_b64_tr_b16 v[70:71], v232 offset:28160
    s_waitcnt lgkmcnt(6)
    v_mfma_f32_32x32x16_bf16 v[144:159], v[76:79], v[48:51], v[144:159]
    buffer_load_dwordx4 v[48:51], v235, s[20:23], s63 offen offset:0 sc1
    ds_read_b64_tr_b16 v[72:73], v233 offset:25600
    ds_read_b64_tr_b16 v[74:75], v233 offset:28160
    s_waitcnt vmcnt(22)
    s_waitcnt lgkmcnt(6)
    v_mfma_f32_32x32x16_bf16 v[80:95], v[60:63], v[52:55], v[80:95]
    ds_read_b64_tr_b16 v[76:77], v234 offset:25600
    ds_read_b64_tr_b16 v[78:79], v234 offset:28160
    s_waitcnt lgkmcnt(6)
    v_mfma_f32_32x32x16_bf16 v[96:111], v[64:67], v[52:55], v[96:111]
    s_waitcnt vmcnt(21)
    s_barrier
    ds_read_b64_tr_b16 v[60:61], v230 offset:40960
    ds_read_b64_tr_b16 v[62:63], v230 offset:43520
    s_waitcnt lgkmcnt(6)
    v_mfma_f32_32x32x16_bf16 v[112:127], v[68:71], v[52:55], v[112:127]
    ds_read_b64_tr_b16 v[64:65], v231 offset:40960
    ds_read_b64_tr_b16 v[66:67], v231 offset:43520
    s_add_u32 m0, s66, 61440
    s_nop 0
    buffer_load_dwordx4 v224, s[84:87], s61 offen lds
    s_waitcnt lgkmcnt(6)
    v_mfma_f32_32x32x16_bf16 v[128:143], v[72:75], v[52:55], v[128:143]
    ds_read_b64_tr_b16 v[68:69], v232 offset:40960
    ds_read_b64_tr_b16 v[70:71], v232 offset:43520
    s_waitcnt lgkmcnt(6)
    v_mfma_f32_32x32x16_bf16 v[144:159], v[76:79], v[52:55], v[144:159]
    buffer_load_dword v253, v252, s[20:23], s4 offen sc1
    buffer_load_dwordx4 v[52:55], v235, s[20:23], s63 offen offset:1024 sc1
    s_add_u32 s63, s63, 4096
    ds_read_b64_tr_b16 v[72:73], v233 offset:40960
    ds_read_b64_tr_b16 v[74:75], v233 offset:43520
    s_add_u32 m0, s66, 62464
    s_nop 0
    buffer_load_dwordx4 v225, s[84:87], s61 offen lds
    s_waitcnt vmcnt(24)
    s_waitcnt lgkmcnt(6)
    v_mfma_f32_32x32x16_bf16 v[80:95], v[60:63], v[16:19], v[80:95]
    ds_read_b64_tr_b16 v[76:77], v234 offset:40960
    ds_read_b64_tr_b16 v[78:79], v234 offset:43520
    s_waitcnt lgkmcnt(6)
    v_mfma_f32_32x32x16_bf16 v[96:111], v[64:67], v[16:19], v[96:111]
    ds_read_b64_tr_b16 v[60:61], v230 offset:46080
    ds_read_b64_tr_b16 v[62:63], v230 offset:48640
    s_waitcnt lgkmcnt(6)
    v_mfma_f32_32x32x16_bf16 v[112:127], v[68:71], v[16:19], v[112:127]
    ds_read_b64_tr_b16 v[64:65], v231 offset:46080
    ds_read_b64_tr_b16 v[66:67], v231 offset:48640
    s_add_u32 m0, s66, 63488
    s_mov_b32 exec_hi, 0
    buffer_load_dwordx4 v226, s[84:87], s61 offen lds
    s_mov_b32 exec_hi, -1
    s_add_u32 s61, s61, s62
    s_waitcnt lgkmcnt(6)
    v_mfma_f32_32x32x16_bf16 v[128:143], v[72:75], v[16:19], v[128:143]
    ds_read_b64_tr_b16 v[68:69], v232 offset:46080
    ds_read_b64_tr_b16 v[70:71], v232 offset:48640
    s_waitcnt lgkmcnt(6)
    v_mfma_f32_32x32x16_bf16 v[144:159], v[76:79], v[16:19], v[144:159]
    buffer_load_dwordx4 v[16:19], v235, s[20:23], s63 offen offset:0 sc1
    ds_read_b64_tr_b16 v[72:73], v233 offset:46080
    ds_read_b64_tr_b16 v[74:75], v233 offset:48640
    s_mov_b32 s61, s64
    s_cmp_lg_u32 s60, 0
    s_cselect_b32 s62, 82944, s62
    s_cselect_b64 s[84:85], s[28:29], s[24:25]
    s_cselect_b32 s86, s30, s26
    s_add_u32 m0, s66, 81920
    s_nop 0
    buffer_load_dwordx4 v224, s[84:87], s61 offen lds
    s_waitcnt vmcnt(25)
    s_waitcnt lgkmcnt(6)
    v_mfma_f32_32x32x16_bf16 v[80:95], v[60:63], v[20:23], v[80:95]
    ds_read_b64_tr_b16 v[76:77], v234 offset:46080
    ds_read_b64_tr_b16 v[78:79], v234 offset:48640
    s_waitcnt lgkmcnt(6)
    v_mfma_f32_32x32x16_bf16 v[96:111], v[64:67], v[20:23], v[96:111]
    ds_read_b64_tr_b16 v[60:61], v230 offset:61440
    ds_read_b64_tr_b16 v[62:63], v230 offset:64000
    s_waitcnt lgkmcnt(6)
    v_mfma_f32_32x32x16_bf16 v[112:127], v[68:71], v[20:23], v[112:127]
    ds_read_b64_tr_b16 v[64:65], v231 offset:61440
    ds_read_b64_tr_b16 v[66:67], v231 offset:64000
    s_add_u32 m0, s66, 82944
    s_nop 0
    buffer_load_dwordx4 v225, s[84:87], s61 offen lds
    s_waitcnt lgkmcnt(6)
    v_mfma_f32_32x32x16_bf16 v[128:143], v[72:75], v[20:23], v[128:143]
    ds_read_b64_tr_b16 v[68:69], v232 offset:61440
    ds_read_b64_tr_b16 v[70:71], v232 offset:64000
    s_waitcnt lgkmcnt(6)
    v_mfma_f32_32x32x16_bf16 v[144:159], v[76:79], v[20:23], v[144:159]
    buffer_load_dwordx4 v[20:23], v235, s[20:23], s63 offen offset:1024 sc1
    s_add_u32 s63, s63, 4096
    ds_read_b64_tr_b16 v[72:73], v233 offset:61440
    ds_read_b64_tr_b16 v[74:75], v233 offset:64000
    s_add_u32 m0, s66, 83968
    s_mov_b32 exec_hi, 0
    buffer_load_dwordx4 v226, s[84:87], s61 offen lds
    s_mov_b32 exec_hi, -1
    s_add_u32 s61, s61, s62
    s_waitcnt vmcnt(25)
    s_waitcnt lgkmcnt(6)
    v_mfma_f32_32x32x16_bf16 v[80:95], v[60:63], v[24:27], v[80:95]
    ds_read_b64_tr_b16 v[76:77], v234 offset:61440
    ds_read_b64_tr_b16 v[78:79], v234 offset:64000
    s_waitcnt lgkmcnt(6)
    v_mfma_f32_32x32x16_bf16 v[96:111], v[64:67], v[24:27], v[96:111]
    v_add_u32 v230, 61440, v230
    v_add_u32 v231, 61440, v231
    v_add_u32 v232, 61440, v232
    v_add_u32 v233, 61440, v233
    v_add_u32 v234, 61440, v234
    ds_read_b64_tr_b16 v[60:61], v230 offset:5120
    ds_read_b64_tr_b16 v[62:63], v230 offset:7680
    s_waitcnt lgkmcnt(6)
    v_mfma_f32_32x32x16_bf16 v[112:127], v[68:71], v[24:27], v[112:127]
    ds_read_b64_tr_b16 v[64:65], v231 offset:5120
    ds_read_b64_tr_b16 v[66:67], v231 offset:7680
    s_waitcnt lgkmcnt(6)
    v_mfma_f32_32x32x16_bf16 v[128:143], v[72:75], v[24:27], v[128:143]
    ds_read_b64_tr_b16 v[68:69], v232 offset:5120
    ds_read_b64_tr_b16 v[70:71], v232 offset:7680
    s_waitcnt lgkmcnt(6)
    v_mfma_f32_32x32x16_bf16 v[144:159], v[76:79], v[24:27], v[144:159]
    buffer_load_dwordx4 v[24:27], v235, s[20:23], s63 offen offset:0 sc1
    ds_read_b64_tr_b16 v[72:73], v233 offset:5120
    ds_read_b64_tr_b16 v[74:75], v233 offset:7680
    s_waitcnt vmcnt(23)
    s_waitcnt lgkmcnt(6)
    v_mfma_f32_32x32x16_bf16 v[80:95], v[60:63], v[28:31], v[80:95]
    ds_read_b64_tr_b16 v[76:77], v234 offset:5120
    ds_read_b64_tr_b16 v[78:79], v234 offset:7680
    s_waitcnt lgkmcnt(6)
    v_mfma_f32_32x32x16_bf16 v[96:111], v[64:67], v[28:31], v[96:111]
    s_waitcnt vmcnt(22)
    s_barrier
    ds_read_b64_tr_b16 v[60:61], v230 offset:20480
    ds_read_b64_tr_b16 v[62:63], v230 offset:23040
    s_waitcnt lgkmcnt(6)
    v_mfma_f32_32x32x16_bf16 v[112:127], v[68:71], v[28:31], v[112:127]
    ds_read_b64_tr_b16 v[64:65], v231 offset:20480
    ds_read_b64_tr_b16 v[66:67], v231 offset:23040
    s_add_u32 m0, s66, 102400
    s_nop 0
    buffer_load_dwordx4 v224, s[84:87], s61 offen lds
    s_waitcnt lgkmcnt(6)
    v_mfma_f32_32x32x16_bf16 v[128:143], v[72:75], v[28:31], v[128:143]
    ds_read_b64_tr_b16 v[68:69], v232 offset:20480
    ds_read_b64_tr_b16 v[70:71], v232 offset:23040
    s_waitcnt lgkmcnt(6)
    v_mfma_f32_32x32x16_bf16 v[144:159], v[76:79], v[28:31], v[144:159]
    buffer_load_dwordx4 v[28:31], v235, s[20:23], s63 offen offset:1024 sc1
    s_add_u32 s63, s63, 4096
    s_mul_i32 s52, s60, 57344
    s_sub_u32 s63, s63, s52
    s_add_u32 s63, s63, 212992
    ds_read_b64_tr_b16 v[72:73], v233 offset:20480
    ds_read_b64_tr_b16 v[74:75], v233 offset:23040
    s_add_u32 m0, s66, 103424
    s_nop 0
    buffer_load_dwordx4 v225, s[84:87], s61 offen lds
    s_waitcnt vmcnt(24)
    s_waitcnt lgkmcnt(6)
    v_mfma_f32_32x32x16_bf16 v[80:95], v[60:63], v[32:35], v[80:95]
    ds_read_b64_tr_b16 v[76:77], v234 offset:20480
    ds_read_b64_tr_b16 v[78:79], v234 offset:23040
    s_waitcnt lgkmcnt(6)
    v_mfma_f32_32x32x16_bf16 v[96:111], v[64:67], v[32:35], v[96:111]
    ds_read_b64_tr_b16 v[60:61], v230 offset:25600
    ds_read_b64_tr_b16 v[62:63], v230 offset:28160
    s_waitcnt lgkmcnt(6)
    v_mfma_f32_32x32x16_bf16 v[112:127], v[68:71], v[32:35], v[112:127]
    ds_read_b64_tr_b16 v[64:65], v231 offset:25600
    ds_read_b64_tr_b16 v[66:67], v231 offset:28160
    s_add_u32 m0, s66, 104448
    s_mov_b32 exec_hi, 0
    buffer_load_dwordx4 v226, s[84:87], s61 offen lds
    s_mov_b32 exec_hi, -1
    s_add_u32 s61, s61, s62
    s_waitcnt lgkmcnt(6)
    v_mfma_f32_32x32x16_bf16 v[128:143], v[72:75], v[32:35], v[128:143]
    ds_read_b64_tr_b16 v[68:69], v232 offset:25600
    ds_read_b64_tr_b16 v[70:71], v232 offset:28160
    s_waitcnt lgkmcnt(6)
    v_mfma_f32_32x32x16_bf16 v[144:159], v[76:79], v[32:35], v[144:159]
    s_waitcnt vmcnt(13)
    s_mov_b32 s59, 30000
L_pl_42:
    v_cmp_ne_u32 vcc, s50, v253
    s_nop 4
    s_cbranch_vccz L_pd_41
    buffer_load_dword v253, v252, s[20:23], s4 offen sc1
    s_waitcnt vmcnt(0)
    s_sub_u32 s59, s59, 1
    s_cmp_lg_u32 s59, 0
    s_cbranch_scc1 L_pl_42
L_pd_41:
    v_and_b32 v1, 31, v0
    v_lshlrev_b32 v1, 3, v1
    buffer_load_dword v236, v1, s[20:23], s74 offen sc1
    v_and_b32 v252, 3, v0
    v_lshlrev_b32 v252, 2, v252
    buffer_load_dwordx4 v[32:35], v235, s[20:23], s63 offen offset:0 sc1
    ds_read_b64_tr_b16 v[72:73], v233 offset:25600
    ds_read_b64_tr_b16 v[74:75], v233 offset:28160
    s_cmp_eq_u32 s60, 3
    s_cselect_b32 s61, s65, s61
    s_add_u32 m0, s66, 122880
    s_nop 0
    buffer_load_dwordx4 v227, s[84:87], s61 offen lds
    s_waitcnt lgkmcnt(6)
    v_mfma_f32_32x32x16_bf16 v[80:95], v[60:63], v[36:39], v[80:95]
    ds_read_b64_tr_b16 v[76:77], v234 offset:25600
    ds_read_b64_tr_b16 v[78:79], v234 offset:28160
    s_waitcnt lgkmcnt(6)
    v_mfma_f32_32x32x16_bf16 v[96:111], v[64:67], v[36:39], v[96:111]
    v_subrev_u32 v230, 122880, v230
    v_subrev_u32 v231, 122880, v231
    v_subrev_u32 v232, 122880, v232
    v_subrev_u32 v233, 122880, v233
    v_subrev_u32 v234, 122880, v234
    ds_read_b64_tr_b16 v[60:61], v230 offset:0
    ds_read_b64_tr_b16 v[62:63], v230 offset:2560
    s_waitcnt lgkmcnt(6)
    v_mfma_f32_32x32x16_bf16 v[112:127], v[68:71], v[36:39], v[112:127]
    ds_read_b64_tr_b16 v[64:65], v231 offset:0
    ds_read_b64_tr_b16 v[66:67], v231 offset:2560
    s_add_u32 m0, s66, 123904
    s_nop 0
    buffer_load_dwordx4 v228, s[84:87], s61 offen lds
    s_waitcnt lgkmcnt(6)
    v_mfma_f32_32x32x16_bf16 v[128:143], v[72:75], v[36:39], v[128:143]
    ds_read_b64_tr_b16 v[68:69], v232 offset:0
    ds_read_b64_tr_b16 v[70:71], v232 offset:2560
    s_waitcnt lgkmcnt(6)
    v_mfma_f32_32x32x16_bf16 v[144:159], v[76:79], v[36:39], v[144:159]
    buffer_load_dwordx4 v[36:39], v235, s[20:23], s63 offen offset:1024 sc1
    s_add_u32 s63, s63, 4096
    ds_read_b64_tr_b16 v[72:73], v233 offset:0
    ds_read_b64_tr_b16 v[74:75], v233 offset:2560
    s_add_u32 m0, s66, 124928
    s_mov_b32 exec_hi, 0
    buffer_load_dwordx4 v229, s[84:87], s61 offen lds
    s_mov_b32 exec_hi, -1
    s_waitcnt lgkmcnt(6)
    v_mfma_f32_32x32x16_bf16 v[80:95], v[60:63], v[40:43], v[80:95]
    ds_read_b64_tr_b16 v[76:77], v234 offset:0
    ds_read_b64_tr_b16 v[78:79], v234 offset:2560
    s_waitcnt lgkmcnt(6)
    v_mfma_f32_32x32x16_bf16 v[96:111], v[64:67], v[40:43], v[96:111]
    ds_read_b64_tr_b16 v[60:61], v230 offset:5120
    ds_read_b64_tr_b16 v[62:63], v230 offset:7680
    s_waitcnt lgkmcnt(6)
    v_mfma_f32_32x32x16_bf16 v[112:127], v[68:71], v[40:43], v[112:127]
    ds_read_b64_tr_b16 v[64:65], v231 offset:5120
    ds_read_b64_tr_b16 v[66:67], v231 offset:7680
    s_waitcnt lgkmcnt(6)
    v_mfma_f32_32x32x16_bf16 v[128:143], v[72:75], v[40:43], v[128:143]
    ds_read_b64_tr_b16 v[68:69], v232 offset:5120
    ds_read_b64_tr_b16 v[70:71], v232 offset:7680
    s_waitcnt lgkmcnt(6)
    v_mfma_f32_32x32x16_bf16 v[144:159], v[76:79], v[40:43], v[144:159]
    buffer_load_dwordx4 v[40:43], v235, s[20:23], s63 offen offset:0 sc1
    ds_read_b64_tr_b16 v[72:73], v233 offset:5120
    ds_read_b64_tr_b16 v[74:75], v233 offset:7680
    s_waitcnt lgkmcnt(6)
    v_mfma_f32_32x32x16_bf16 v[80:95], v[60:63], v[44:47], v[80:95]
    ds_read_b64_tr_b16 v[76:77], v234 offset:5120
    ds_read_b64_tr_b16 v[78:79], v234 offset:7680
    s_waitcnt lgkmcnt(6)
    v_mfma_f32_32x32x16_bf16 v[96:111], v[64:67], v[44:47], v[96:111]
    s_barrier
    ds_read_b64_tr_b16 v[60:61], v230 offset:20480
    ds_read_b64_tr_b16 v[62:63], v230 offset:23040
    s_waitcnt lgkmcnt(6)
    v_mfma_f32_32x32x16_bf16 v[112:127], v[68:71], v[44:47], v[112:127]
    ds_read_b64_tr_b16 v[64:65], v231 offset:20480
    ds_read_b64_tr_b16 v[66:67], v231 offset:23040
    s_waitcnt lgkmcnt(6)
    v_mfma_f32_32x32x16_bf16 v[128:143], v[72:75], v[44:47], v[128:143]
    ds_read_b64_tr_b16 v[68:69], v232 offset:20480
    ds_read_b64_tr_b16 v[70:71], v232 offset:23040
    s_waitcnt lgkmcnt(6)
    v_mfma_f32_32x32x16_bf16 v[144:159], v[76:79], v[44:47], v[144:159]
    buffer_load_dwordx4 v[44:47], v235, s[20:23], s63 offen offset:1024 sc1
    s_add_u32 s63, s63, 4096
    ds_read_b64_tr_b16 v[72:73], v233 offset:20480
    ds_read_b64_tr_b16 v[74:75], v233 offset:23040
    s_waitcnt lgkmcnt(6)
    v_mfma_f32_32x32x16_bf16 v[80:95], v[60:63], v[48:51], v[80:95]
    ds_read_b64_tr_b16 v[76:77], v234 offset:20480
    ds_read_b64_tr_b16 v[78:79], v234 offset:23040
    s_waitcnt lgkmcnt(6)
    v_mfma_f32_32x32x16_bf16 v[96:111], v[64:67], v[48:51], v[96:111]
    ds_read_b64_tr_b16 v[60:61], v230 offset:25600
    ds_read_b64_tr_b16 v[62:63], v230 offset:28160
    s_waitcnt lgkmcnt(6)
    v_mfma_f32_32x32x16_bf16 v[112:127], v[68:71], v[48:51], v[112:127]
    ds_read_b64_tr_b16 v[64:65], v231 offset:25600
    ds_read_b64_tr_b16 v[66:67], v231 offset:28160
    s_waitcnt lgkmcnt(6)
    v_mfma_f32_32x32x16_bf16 v[128:143], v[72:75], v[48:51], v[128:143]
    ds_read_b64_tr_b16 v[68:69], v232 offset:25600
    ds_read_b64_tr_b16 v[70:71], v232 offset:28160
    s_waitcnt lgkmcnt(6)
    v_mfma_f32_32x32x16_bf16 v[144:159], v[76:79], v[48:51], v[144:159]
    buffer_load_dwordx4 v[48:51], v235, s[20:23], s63 offen offset:0 sc1
    ds_read_b64_tr_b16 v[72:73], v233 offset:25600
    ds_read_b64_tr_b16 v[74:75], v233 offset:28160
    s_waitcnt vmcnt(21)
    s_waitcnt lgkmcnt(6)
    v_mfma_f32_32x32x16_bf16 v[80:95], v[60:63], v[52:55], v[80:95]
    ds_read_b64_tr_b16 v[76:77], v234 offset:25600
    ds_read_b64_tr_b16 v[78:79], v234 offset:28160
    s_waitcnt lgkmcnt(6)
    v_mfma_f32_32x32x16_bf16 v[96:111], v[64:67], v[52:55], v[96:111]
    ds_read_b64_tr_b16 v[60:61], v230 offset:40960
    ds_read_b64_tr_b16 v[62:63], v230 offset:43520
    s_waitcnt lgkmcnt(6)
    v_mfma_f32_32x32x16_bf16 v[112:127], v[68:71], v[52:55], v[112:127]
    ds_read_b64_tr_b16 v[64:65], v231 offset:40960
    ds_read_b64_tr_b16 v[66:67], v231 offset:43520
    s_waitcnt lgkmcnt(6)
    v_mfma_f32_32x32x16_bf16 v[128:143], v[72:75], v[52:55], v[128:143]
    ds_read_b64_tr_b16 v[68:69], v232 offset:40960
    ds_read_b64_tr_b16 v[70:71], v232 offset:43520
    s_waitcnt lgkmcnt(6)
    v_mfma_f32_32x32x16_bf16 v[144:159], v[76:79], v[52:55], v[144:159]
    buffer_load_dwordx4 v[52:55], v235, s[20:23], s63 offen offset:1024 sc1
    s_add_u32 s63, s63, 4096
    ds_read_b64_tr_b16 v[72:73], v233 offset:40960
    ds_read_b64_tr_b16 v[74:75], v233 offset:43520
    s_waitcnt vmcnt(19)
    s_waitcnt lgkmcnt(6)
    v_mfma_f32_32x32x16_bf16 v[80:95], v[60:63], v[16:19], v[80:95]
    ds_read_b64_tr_b16 v[76:77], v234 offset:40960
    ds_read_b64_tr_b16 v[78:79], v234 offset:43520
    s_waitcnt lgkmcnt(6)
    v_mfma_f32_32x32x16_bf16 v[96:111], v[64:67], v[16:19], v[96:111]
    ds_read_b64_tr_b16 v[60:61], v230 offset:46080
    ds_read_b64_tr_b16 v[62:63], v230 offset:48640
    s_waitcnt lgkmcnt(6)
    v_mfma_f32_32x32x16_bf16 v[112:127], v[68:71], v[16:19], v[112:127]
    ds_read_b64_tr_b16 v[64:65], v231 offset:46080
    ds_read_b64_tr_b16 v[66:67], v231 offset:48640
    s_waitcnt lgkmcnt(6)
    v_mfma_f32_32x32x16_bf16 v[128:143], v[72:75], v[16:19], v[128:143]
    ds_read_b64_tr_b16 v[68:69], v232 offset:46080
    ds_read_b64_tr_b16 v[70:71], v232 offset:48640
    s_waitcnt lgkmcnt(6)
    v_mfma_f32_32x32x16_bf16 v[144:159], v[76:79], v[16:19], v[144:159]
    ds_read_b64_tr_b16 v[72:73], v233 offset:46080
    ds_read_b64_tr_b16 v[74:75], v233 offset:48640
    s_waitcnt vmcnt(16)
    s_waitcnt lgkmcnt(6)
    v_mfma_f32_32x32x16_bf16 v[80:95], v[60:63], v[20:23], v[80:95]
    ds_read_b64_tr_b16 v[76:77], v234 offset:46080
    ds_read_b64_tr_b16 v[78:79], v234 offset:48640
    s_waitcnt lgkmcnt(6)
    v_mfma_f32_32x32x16_bf16 v[96:111], v[64:67], v[20:23], v[96:111]
    s_waitcnt vmcnt(15)
    s_barrier
    ds_read_b64_tr_b16 v[60:61], v230 offset:61440
    ds_read_b64_tr_b16 v[62:63], v230 offset:64000
    s_waitcnt lgkmcnt(6)
    v_mfma_f32_32x32x16_bf16 v[112:127], v[68:71], v[20:23], v[112:127]
    ds_read_b64_tr_b16 v[64:65], v231 offset:61440
    ds_read_b64_tr_b16 v[66:67], v231 offset:64000
    s_waitcnt lgkmcnt(6)
    v_mfma_f32_32x32x16_bf16 v[128:143], v[72:75], v[20:23], v[128:143]
    ds_read_b64_tr_b16 v[68:69], v232 offset:61440
    ds_read_b64_tr_b16 v[70:71], v232 offset:64000
    s_waitcnt lgkmcnt(6)
    v_mfma_f32_32x32x16_bf16 v[144:159], v[76:79], v[20:23], v[144:159]
    ds_read_b64_tr_b16 v[72:73], v233 offset:61440
    ds_read_b64_tr_b16 v[74:75], v233 offset:64000
    s_waitcnt vmcnt(14)
    s_waitcnt lgkmcnt(6)
    v_mfma_f32_32x32x16_bf16 v[80:95], v[60:63], v[24:27], v[80:95]
    ds_read_b64_tr_b16 v[76:77], v234 offset:61440
    ds_read_b64_tr_b16 v[78:79], v234 offset:64000
    s_waitcnt lgkmcnt(6)
    v_mfma_f32_32x32x16_bf16 v[96:111], v[64:67], v[24:27], v[96:111]
    v_add_u32 v230, 61440, v230
    v_add_u32 v231, 61440, v231
    v_add_u32 v232, 61440, v232
    v_add_u32 v233, 61440, v233
    v_add_u32 v234, 61440, v234
    ds_read_b64_tr_b16 v[60:61], v230 offset:5120
    ds_read_b64_tr_b16 v[62:63], v230 offset:7680
    s_waitcnt lgkmcnt(6)
    v_mfma_f32_32x32x16_bf16 v[112:127], v[68:71], v[24:27], v[112:127]
    ds_read_b64_tr_b16 v[64:65], v231 offset:5120
    ds_read_b64_tr_b16 v[66:67], v231 offset:7680
    s_waitcnt lgkmcnt(6)
    v_mfma_f32_32x32x16_bf16 v[128:143], v[72:75], v[24:27], v[128:143]
    ds_read_b64_tr_b16 v[68:69], v232 offset:5120
    ds_read_b64_tr_b16 v[70:71], v232 offset:7680
    s_waitcnt lgkmcnt(6)
    v_mfma_f32_32x32x16_bf16 v[144:159], v[76:79], v[24:27], v[144:159]
    ds_read_b64_tr_b16 v[72:73], v233 offset:5120
    ds_read_b64_tr_b16 v[74:75], v233 offset:7680
    s_waitcnt vmcnt(12)
    s_waitcnt lgkmcnt(6)
    v_mfma_f32_32x32x16_bf16 v[80:95], v[60:63], v[28:31], v[80:95]
    ds_read_b64_tr_b16 v[76:77], v234 offset:5120
    ds_read_b64_tr_b16 v[78:79], v234 offset:7680
    s_waitcnt lgkmcnt(6)
    v_mfma_f32_32x32x16_bf16 v[96:111], v[64:67], v[28:31], v[96:111]
    ds_read_b64_tr_b16 v[60:61], v230 offset:20480
    ds_read_b64_tr_b16 v[62:63], v230 offset:23040
    s_waitcnt lgkmcnt(6)
    v_mfma_f32_32x32x16_bf16 v[112:127], v[68:71], v[28:31], v[112:127]
    ds_read_b64_tr_b16 v[64:65], v231 offset:20480
    ds_read_b64_tr_b16 v[66:67], v231 offset:23040
    s_waitcnt lgkmcnt(6)
    v_mfma_f32_32x32x16_bf16 v[128:143], v[72:75], v[28:31], v[128:143]
    ds_read_b64_tr_b16 v[68:69], v232 offset:20480
    ds_read_b64_tr_b16 v[70:71], v232 offset:23040
    s_waitcnt lgkmcnt(6)
    v_mfma_f32_32x32x16_bf16 v[144:159], v[76:79], v[28:31], v[144:159]
    ds_read_b64_tr_b16 v[72:73], v233 offset:20480
    ds_read_b64_tr_b16 v[74:75], v233 offset:23040
    s_waitcnt vmcnt(9)
    v_and_b32 v236, 0xffff0000, v236
    v_mul_f32 v80, v80, v236
    v_mul_f32 v81, v81, v236
    v_mul_f32 v82, v82, v236
    v_mul_f32 v83, v83, v236
    v_mul_f32 v84, v84, v236
    v_mul_f32 v85, v85, v236
    v_mul_f32 v86, v86, v236
    v_mul_f32 v87, v87, v236
    v_mul_f32 v88, v88, v236
    v_mul_f32 v89, v89, v236
    v_mul_f32 v90, v90, v236
    v_mul_f32 v91, v91, v236
    v_mul_f32 v92, v92, v236
    v_mul_f32 v93, v93, v236
    v_mul_f32 v94, v94, v236
    v_mul_f32 v95, v95, v236
    v_mul_f32 v96, v96, v236
    v_mul_f32 v97, v97, v236
    v_mul_f32 v98, v98, v236
    v_mul_f32 v99, v99, v236
    v_mul_f32 v100, v100, v236
    v_mul_f32 v101, v101, v236
    v_mul_f32 v102, v102, v236
    v_mul_f32 v103, v103, v236
    v_mul_f32 v104, v104, v236
    v_mul_f32 v105, v105, v236
    v_mul_f32 v106, v106, v236
    v_mul_f32 v107, v107, v236
    v_mul_f32 v108, v108, v236
    v_mul_f32 v109, v109, v236
    v_mul_f32 v110, v110, v236
    v_mul_f32 v111, v111, v236
    v_mul_f32 v112, v112, v236
    v_mul_f32 v113, v113, v236
    v_mul_f32 v114, v114, v236
    v_mul_f32 v115, v115, v236
    v_mul_f32 v116, v116, v236
    v_mul_f32 v117, v117, v236
    v_mul_f32 v118, v118, v236
    v_mul_f32 v119, v119, v236
    v_mul_f32 v120, v120, v236
    v_mul_f32 v121, v121, v236
    v_mul_f32 v122, v122, v236
    v_mul_f32 v123, v123, v236
    v_mul_f32 v124, v124, v236
    v_mul_f32 v125, v125, v236
    v_mul_f32 v126, v126, v236
    v_mul_f32 v127, v127, v236
    v_mul_f32 v128, v128, v236
    v_mul_f32 v129, v129, v236
    v_mul_f32 v130, v130, v236
    v_mul_f32 v131, v131, v236
    v_mul_f32 v132, v132, v236
    v_mul_f32 v133, v133, v236
    v_mul_f32 v134, v134, v236
    v_mul_f32 v135, v135, v236
    v_mul_f32 v136, v136, v236
    v_mul_f32 v137, v137, v236
    v_mul_f32 v138, v138, v236
    v_mul_f32 v139, v139, v236
    v_mul_f32 v140, v140, v236
    v_mul_f32 v141, v141, v236
    v_mul_f32 v142, v142, v236
    v_mul_f32 v143, v143, v236
    v_mul_f32 v144, v144, v236
    v_mul_f32 v145, v145, v236
    v_mul_f32 v146, v146, v236
    v_mul_f32 v147, v147, v236
    v_mul_f32 v148, v148, v236
    v_mul_f32 v149, v149, v236
    v_mul_f32 v150, v150, v236
    v_mul_f32 v151, v151, v236
    v_mul_f32 v152, v152, v236
    v_mul_f32 v153, v153, v236
    v_mul_f32 v154, v154, v236
    v_mul_f32 v155, v155, v236
    v_mul_f32 v156, v156, v236
    v_mul_f32 v157, v157, v236
    v_mul_f32 v158, v158, v236
    v_mul_f32 v159, v159, v236
    s_waitcnt vmcnt(8)
    s_waitcnt lgkmcnt(6)
    v_mfma_f32_32x32x16_bf16 v[80:95], v[60:63], v[32:35], v[80:95]
    ds_read_b64_tr_b16 v[76:77], v234 offset:20480
    ds_read_b64_tr_b16 v[78:79], v234 offset:23040
    s_waitcnt lgkmcnt(6)
    v_mfma_f32_32x32x16_bf16 v[96:111], v[64:67], v[32:35], v[96:111]
    ds_read_b64_tr_b16 v[60:61], v230 offset:25600
    ds_read_b64_tr_b16 v[62:63], v230 offset:28160
    s_waitcnt lgkmcnt(6)
    v_mfma_f32_32x32x16_bf16 v[112:127], v[68:71], v[32:35], v[112:127]
    ds_read_b64_tr_b16 v[64:65], v231 offset:25600
    ds_read_b64_tr_b16 v[66:67], v231 offset:28160
    s_waitcnt lgkmcnt(6)
    v_mfma_f32_32x32x16_bf16 v[128:143], v[72:75], v[32:35], v[128:143]
    ds_read_b64_tr_b16 v[68:69], v232 offset:25600
    ds_read_b64_tr_b16 v[70:71], v232 offset:28160
    s_waitcnt lgkmcnt(6)
    v_mfma_f32_32x32x16_bf16 v[144:159], v[76:79], v[32:35], v[144:159]
    ds_read_b64_tr_b16 v[72:73], v233 offset:25600
    ds_read_b64_tr_b16 v[74:75], v233 offset:28160
    s_waitcnt vmcnt(5)
    s_waitcnt lgkmcnt(6)
    v_mfma_f32_32x32x16_bf16 v[80:95], v[60:63], v[36:39], v[80:95]
    ds_read_b64_tr_b16 v[76:77], v234 offset:25600
    ds_read_b64_tr_b16 v[78:79], v234 offset:28160
    s_waitcnt lgkmcnt(6)
    v_mfma_f32_32x32x16_bf16 v[96:111], v[64:67], v[36:39], v[96:111]
    s_waitcnt vmcnt(4)
    s_barrier
    ds_read_b64_tr_b16 v[60:61], v230 offset:40960
    ds_read_b64_tr_b16 v[62:63], v230 offset:43520
    s_waitcnt lgkmcnt(6)
    v_mfma_f32_32x32x16_bf16 v[112:127], v[68:71], v[36:39], v[112:127]
    ds_read_b64_tr_b16 v[64:65], v231 offset:40960
    ds_read_b64_tr_b16 v[66:67], v231 offset:43520
    s_waitcnt lgkmcnt(6)
    v_mfma_f32_32x32x16_bf16 v[128:143], v[72:75], v[36:39], v[128:143]
    ds_read_b64_tr_b16 v[68:69], v232 offset:40960
    ds_read_b64_tr_b16 v[70:71], v232 offset:43520
    s_waitcnt lgkmcnt(6)
    v_mfma_f32_32x32x16_bf16 v[144:159], v[76:79], v[36:39], v[144:159]
    buffer_load_dword v253, v252, s[20:23], s71 offen sc1
    ds_read_b64_tr_b16 v[72:73], v233 offset:40960
    ds_read_b64_tr_b16 v[74:75], v233 offset:43520
    s_waitcnt vmcnt(4)
    s_waitcnt lgkmcnt(6)
    v_mfma_f32_32x32x16_bf16 v[80:95], v[60:63], v[40:43], v[80:95]
    ds_read_b64_tr_b16 v[76:77], v234 offset:40960
    ds_read_b64_tr_b16 v[78:79], v234 offset:43520
    s_waitcnt lgkmcnt(6)
    v_mfma_f32_32x32x16_bf16 v[96:111], v[64:67], v[40:43], v[96:111]
    ds_read_b64_tr_b16 v[60:61], v230 offset:46080
    ds_read_b64_tr_b16 v[62:63], v230 offset:48640
    s_waitcnt lgkmcnt(6)
    v_mfma_f32_32x32x16_bf16 v[112:127], v[68:71], v[40:43], v[112:127]
    ds_read_b64_tr_b16 v[64:65], v231 offset:46080
    ds_read_b64_tr_b16 v[66:67], v231 offset:48640
    s_waitcnt lgkmcnt(6)
    v_mfma_f32_32x32x16_bf16 v[128:143], v[72:75], v[40:43], v[128:143]
    ds_read_b64_tr_b16 v[68:69], v232 offset:46080
    ds_read_b64_tr_b16 v[70:71], v232 offset:48640
    s_waitcnt lgkmcnt(6)
    v_mfma_f32_32x32x16_bf16 v[144:159], v[76:79], v[40:43], v[144:159]
    ds_read_b64_tr_b16 v[72:73], v233 offset:46080
    ds_read_b64_tr_b16 v[74:75], v233 offset:48640
    s_waitcnt vmcnt(3)
    s_waitcnt lgkmcnt(6)
    v_mfma_f32_32x32x16_bf16 v[80:95], v[60:63], v[44:47], v[80:95]
    ds_read_b64_tr_b16 v[76:77], v234 offset:46080
    ds_read_b64_tr_b16 v[78:79], v234 offset:48640
    s_waitcnt lgkmcnt(6)
    v_mfma_f32_32x32x16_bf16 v[96:111], v[64:67], v[44:47], v[96:111]
    ds_read_b64_tr_b16 v[60:61], v230 offset:61440
    ds_read_b64_tr_b16 v[62:63], v230 offset:64000
    s_waitcnt lgkmcnt(6)
    v_mfma_f32_32x32x16_bf16 v[112:127], v[68:71], v[44:47], v[112:127]
    ds_read_b64_tr_b16 v[64:65], v231 offset:61440
    ds_read_b64_tr_b16 v[66:67], v231 offset:64000
    s_waitcnt lgkmcnt(6)
    v_mfma_f32_32x32x16_bf16 v[128:143], v[72:75], v[44:47], v[128:143]
    ds_read_b64_tr_b16 v[68:69], v232 offset:61440
    ds_read_b64_tr_b16 v[70:71], v232 offset:64000
    s_waitcnt lgkmcnt(6)
    v_mfma_f32_32x32x16_bf16 v[144:159], v[76:79], v[44:47], v[144:159]
    ds_read_b64_tr_b16 v[72:73], v233 offset:61440
    ds_read_b64_tr_b16 v[74:75], v233 offset:64000
    s_waitcnt vmcnt(2)
    s_waitcnt lgkmcnt(6)
    v_mfma_f32_32x32x16_bf16 v[80:95], v[60:63], v[48:51], v[80:95]
    ds_read_b64_tr_b16 v[76:77], v234 offset:61440
    ds_read_b64_tr_b16 v[78:79], v234 offset:64000
    s_waitcnt lgkmcnt(6)
    v_mfma_f32_32x32x16_bf16 v[96:111], v[64:67], v[48:51], v[96:111]
    v_add_u32 v230, 61440, v230
    v_add_u32 v231, 61440, v231
    v_add_u32 v232, 61440, v232
    v_add_u32 v233, 61440, v233
    v_add_u32 v234, 61440, v234
    ds_read_b64_tr_b16 v[60:61], v230 offset:5120
    ds_read_b64_tr_b16 v[62:63], v230 offset:7680
    s_waitcnt lgkmcnt(6)
    v_mfma_f32_32x32x16_bf16 v[112:127], v[68:71], v[48:51], v[112:127]
    ds_read_b64_tr_b16 v[64:65], v231 offset:5120
    ds_read_b64_tr_b16 v[66:67], v231 offset:7680
    s_waitcnt lgkmcnt(6)
    v_mfma_f32_32x32x16_bf16 v[128:143], v[72:75], v[48:51], v[128:143]
    ds_read_b64_tr_b16 v[68:69], v232 offset:5120
    ds_read_b64_tr_b16 v[70:71], v232 offset:7680
    s_waitcnt lgkmcnt(6)
    v_mfma_f32_32x32x16_bf16 v[144:159], v[76:79], v[48:51], v[144:159]
    ds_read_b64_tr_b16 v[72:73], v233 offset:5120
    ds_read_b64_tr_b16 v[74:75], v233 offset:7680
    s_waitcnt vmcnt(1)
    s_waitcnt lgkmcnt(6)
    v_mfma_f32_32x32x16_bf16 v[80:95], v[60:63], v[52:55], v[80:95]
    ds_read_b64_tr_b16 v[76:77], v234 offset:5120
    ds_read_b64_tr_b16 v[78:79], v234 offset:7680
    s_waitcnt lgkmcnt(6)
    v_mfma_f32_32x32x16_bf16 v[96:111], v[64:67], v[52:55], v[96:111]
    s_waitcnt lgkmcnt(4)
    v_mfma_f32_32x32x16_bf16 v[112:127], v[68:71], v[52:55], v[112:127]
    s_waitcnt lgkmcnt(2)
    v_mfma_f32_32x32x16_bf16 v[128:143], v[72:75], v[52:55], v[128:143]
    s_waitcnt lgkmcnt(0)
    v_mfma_f32_32x32x16_bf16 v[144:159], v[76:79], v[52:55], v[144:159]
    s_mul_i32 s52, s46, 10240
    v_add_u32 v238, s52, v235
    s_xor_b32 s52, s46, 6
    s_mul_i32 s52, s52, 10240
    v_add_u32 v239, s52, v235
    s_nop 2
    ds_write_b128 v238, v[112:115] offset:0
    ds_write_b128 v238, v[116:119] offset:1024
    ds_write_b128 v238, v[120:123] offset:2048
    ds_write_b128 v238, v[124:127] offset:3072
    ds_write_b128 v238, v[128:131] offset:4096
    ds_write_b128 v238, v[132:135] offset:5120
    ds_write_b128 v238, v[136:139] offset:6144
    ds_write_b128 v238, v[140:143] offset:7168
    ds_write_b128 v238, v[152:155] offset:8192
    ds_write_b128 v238, v[156:159] offset:9216
    v_and_b32 v1, 31, v0
    v_mul_u32_u24 v240, 1152, v1
    v_lshrrev_b32 v1, 5, v0
    v_lshl_add_u32 v240, v1, 4, v240
    v_and_b32 v1, 3, v0
    v_lshlrev_b32 v241, 2, v1
    s_mul_i32 s52, s60, 9216
    s_add_u32 s52, s52, s70
    s_add_u32 s53, s52, s49
    s_xor_b32 s89, s60, 1
    s_mul_i32 s89, s89, 36864
    s_add_u32 s89, s89, s53
    s_xor_b32 s90, s60, 2
    s_mul_i32 s90, s90, 36864
    s_add_u32 s90, s90, s53
    s_xor_b32 s91, s60, 3
    s_mul_i32 s91, s91, 36864
    s_add_u32 s91, s91, s53
    s_mul_i32 s54, s75, 36864
    s_add_u32 s54, s54, s52
    s_add_u32 s54, s54, 8192
    s_waitcnt vmcnt(0)
    s_mov_b32 s59, 30000
L_pl_44:
    v_cmp_ne_u32 vcc, s50, v253
    s_nop 4
    s_cbranch_vccz L_pd_43
    buffer_load_dword v253, v252, s[20:23], s71 offen sc1
    s_waitcnt vmcnt(0)
    s_sub_u32 s59, s59, 1
    s_cmp_lg_u32 s59, 0
    s_cbranch_scc1 L_pl_44
L_pd_43:
    s_waitcnt lgkmcnt(0)
    s_barrier
    ds_read_b128 v[168:171], v239 offset:2048
    ds_read_b128 v[172:175], v239 offset:3072
    ds_read_b128 v[176:179], v239 offset:4096
    ds_read_b128 v[180:183], v239 offset:5120
    ds_read_b128 v[184:187], v239 offset:6144
    ds_read_b128 v[188:191], v239 offset:7168
    ds_read_b128 v[192:195], v239 offset:8192
    ds_read_b128 v[196:199], v239 offset:9216
    ds_read_b128 v[160:163], v239 offset:0
    ds_read_b128 v[164:167], v239 offset:1024
    s_waitcnt lgkmcnt(9)
    v_add_f32 v88, v88, v168
    v_add_f32 v89, v89, v169
    v_add_f32 v90, v90, v170
    v_add_f32 v91, v91, v171
    s_waitcnt lgkmcnt(8)
    v_add_f32 v92, v92, v172
    v_add_f32 v93, v93, v173
    v_add_f32 v94, v94, v174
    v_add_f32 v95, v95, v175
    v_cvt_pk_bf16_f32 v88, v88, v89
    v_cvt_pk_bf16_f32 v89, v90, v91
    v_cvt_pk_bf16_f32 v90, v92, v93
    v_cvt_pk_bf16_f32 v91, v94, v95
    buffer_store_dwordx4 v[88:91], v235, s[20:23], s89 offen sc1
    s_waitcnt lgkmcnt(7)
    v_add_f32 v96, v96, v176
    v_add_f32 v97, v97, v177
    v_add_f32 v98, v98, v178
    v_add_f32 v99, v99, v179
    s_waitcnt lgkmcnt(6)
    v_add_f32 v100, v100, v180
    v_add_f32 v101, v101, v181
    v_add_f32 v102, v102, v182
    v_add_f32 v103, v103, v183
    v_cvt_pk_bf16_f32 v96, v96, v97
    v_cvt_pk_bf16_f32 v97, v98, v99
    v_cvt_pk_bf16_f32 v98, v100, v101
    v_cvt_pk_bf16_f32 v99, v102, v103
    buffer_store_dwordx4 v[96:99], v235, s[20:23], s90 offen sc1
    s_waitcnt lgkmcnt(5)
    v_add_f32 v104, v104, v184
    v_add_f32 v105, v105, v185
    v_add_f32 v106, v106, v186
    v_add_f32 v107, v107, v187
    s_waitcnt lgkmcnt(4)
    v_add_f32 v108, v108, v188
    v_add_f32 v109, v109, v189
    v_add_f32 v110, v110, v190
    v_add_f32 v111, v111, v191
    v_cvt_pk_bf16_f32 v104, v104, v105
    v_cvt_pk_bf16_f32 v105, v106, v107
    v_cvt_pk_bf16_f32 v106, v108, v109
    v_cvt_pk_bf16_f32 v107, v110, v111
    buffer_store_dwordx4 v[104:107], v235, s[20:23], s91 offen sc1
    s_waitcnt lgkmcnt(3)
    v_add_f32 v144, v144, v192
    v_add_f32 v145, v145, v193
    v_add_f32 v146, v146, v194
    v_add_f32 v147, v147, v195
    s_waitcnt lgkmcnt(2)
    v_add_f32 v148, v148, v196
    v_add_f32 v149, v149, v197
    v_add_f32 v150, v150, v198
    v_add_f32 v151, v151, v199
    s_cmp_eq_u32 s75, s60
    s_cbranch_scc1 L_keep_45
    v_cvt_pk_bf16_f32 v144, v144, v145
    v_cvt_pk_bf16_f32 v145, v146, v147
    v_cvt_pk_bf16_f32 v146, v148, v149
    v_cvt_pk_bf16_f32 v147, v150, v151
    buffer_store_dwordx4 v[144:147], v235, s[20:23], s54 offen sc1
L_keep_45:
    s_waitcnt lgkmcnt(1)
    v_add_f32 v80, v80, v160
    v_add_f32 v81, v81, v161
    v_add_f32 v82, v82, v162
    v_add_f32 v83, v83, v163
    s_waitcnt lgkmcnt(0)
    v_add_f32 v84, v84, v164
    v_add_f32 v85, v85, v165
    v_add_f32 v86, v86, v166
    v_add_f32 v87, v87, v167
    s_mul_i32 s52, s60, 36864
    s_add_u32 s52, s52, s70
    s_xor_b32 s89, s60, 1
    s_mul_i32 s89, s89, 9216
    s_add_u32 s89, s89, s52
    s_xor_b32 s90, s60, 2
    s_mul_i32 s90, s90, 9216
    s_add_u32 s90, s90, s52
    s_xor_b32 s91, s60, 3
    s_mul_i32 s91, s91, 9216
    s_add_u32 s91, s91, s52
    v_add_u32 v238, s49, v235
    v_add_u32 v239, 8192, v235
    s_cmp_lg_u32 s75, s60
    s_cbranch_scc1 L_nokeep2_46
    s_mov_b32 s59, 30000
L_rl_48:
    buffer_load_dwordx4 v[164:167], v238, s[20:23], s89 offen sc1
    buffer_load_dwordx4 v[168:171], v238, s[20:23], s90 offen sc1
    buffer_load_dwordx4 v[172:175], v238, s[20:23], s91 offen sc1
    buffer_load_dwordx4 v[180:183], v239, s[20:23], s89 offen sc1
    buffer_load_dwordx4 v[184:187], v239, s[20:23], s90 offen sc1
    buffer_load_dwordx4 v[188:191], v239, s[20:23], s91 offen sc1
    s_waitcnt vmcnt(0)
    v_max3_u32 v192, v164, v165, v166
    v_max3_u32 v193, v167, v168, v169
    v_max3_u32 v194, v170, v171, v172
    v_max3_u32 v192, v192, v173, v174
    v_max3_u32 v193, v193, v175, v194
    v_max_u32 v192, v192, v193
    v_max3_u32 v195, v180, v181, v182
    v_max_u32 v192, v192, v195
    v_max3_u32 v193, v183, v184, v185
    v_max3_u32 v194, v186, v187, v188
    v_max3_u32 v192, v192, v189, v190
    v_max3_u32 v193, v193, v191, v194
    v_max_u32 v192, v192, v193
    v_cmp_eq_u32 vcc, -1, v192
    s_nop 4
    s_cbranch_vccz L_rd_49
    s_sub_u32 s59, s59, 1
    s_cmp_lg_u32 s59, 0
    s_cbranch_scc1 L_rl_48
L_rd_49:
    v_lshlrev_b32 v192, 16, v164
    v_and_b32 v193, 0xffff0000, v164
    v_add_f32 v80, v80, v192
    v_add_f32 v81, v81, v193
    v_lshlrev_b32 v192, 16, v165
    v_and_b32 v193, 0xffff0000, v165
    v_add_f32 v82, v82, v192
    v_add_f32 v83, v83, v193
    v_lshlrev_b32 v192, 16, v166
    v_and_b32 v193, 0xffff0000, v166
    v_add_f32 v84, v84, v192
    v_add_f32 v85, v85, v193
    v_lshlrev_b32 v192, 16, v167
    v_and_b32 v193, 0xffff0000, v167
    v_add_f32 v86, v86, v192
    v_add_f32 v87, v87, v193
    v_lshlrev_b32 v192, 16, v168
    v_and_b32 v193, 0xffff0000, v168
    v_add_f32 v80, v80, v192
    v_add_f32 v81, v81, v193
    v_lshlrev_b32 v192, 16, v169
    v_and_b32 v193, 0xffff0000, v169
    v_add_f32 v82, v82, v192
    v_add_f32 v83, v83, v193
    v_lshlrev_b32 v192, 16, v170
    v_and_b32 v193, 0xffff0000, v170
    v_add_f32 v84, v84, v192
    v_add_f32 v85, v85, v193
    v_lshlrev_b32 v192, 16, v171
    v_and_b32 v193, 0xffff0000, v171
    v_add_f32 v86, v86, v192
    v_add_f32 v87, v87, v193
    v_lshlrev_b32 v192, 16, v172
    v_and_b32 v193, 0xffff0000, v172
    v_add_f32 v80, v80, v192
    v_add_f32 v81, v81, v193
    v_lshlrev_b32 v192, 16, v173
    v_and_b32 v193, 0xffff0000, v173
    v_add_f32 v82, v82, v192
    v_add_f32 v83, v83, v193
    v_lshlrev_b32 v192, 16, v174
    v_and_b32 v193, 0xffff0000, v174
    v_add_f32 v84, v84, v192
    v_add_f32 v85, v85, v193
    v_lshlrev_b32 v192, 16, v175
    v_and_b32 v193, 0xffff0000, v175
    v_add_f32 v86, v86, v192
    v_add_f32 v87, v87, v193
    v_cvt_pk_bf16_f32 v80, v80, v81
    v_cvt_pk_bf16_f32 v81, v82, v83
    v_cvt_pk_bf16_f32 v82, v84, v85
    v_cvt_pk_bf16_f32 v83, v86, v87
    s_nop 0
    v_permlane32_swap_b32 v80, v82
    v_permlane32_swap_b32 v81, v83
    buffer_store_dwordx4 v[80:83], v240, s[32:35], s72 offen sc1
    v_lshlrev_b32 v192, 16, v180
    v_and_b32 v193, 0xffff0000, v180
    v_add_f32 v144, v144, v192
    v_add_f32 v145, v145, v193
    v_lshlrev_b32 v192, 16, v181
    v_and_b32 v193, 0xffff0000, v181
    v_add_f32 v146, v146, v192
    v_add_f32 v147, v147, v193
    v_lshlrev_b32 v192, 16, v182
    v_and_b32 v193, 0xffff0000, v182
    v_add_f32 v148, v148, v192
    v_add_f32 v149, v149, v193
    v_lshlrev_b32 v192, 16, v183
    v_and_b32 v193, 0xffff0000, v183
    v_add_f32 v150, v150, v192
    v_add_f32 v151, v151, v193
    v_lshlrev_b32 v192, 16, v184
    v_and_b32 v193, 0xffff0000, v184
    v_add_f32 v144, v144, v192
    v_add_f32 v145, v145, v193
    v_lshlrev_b32 v192, 16, v185
    v_and_b32 v193, 0xffff0000, v185
    v_add_f32 v146, v146, v192
    v_add_f32 v147, v147, v193
    v_lshlrev_b32 v192, 16, v186
    v_and_b32 v193, 0xffff0000, v186
    v_add_f32 v148, v148, v192
    v_add_f32 v149, v149, v193
    v_lshlrev_b32 v192, 16, v187
    v_and_b32 v193, 0xffff0000, v187
    v_add_f32 v150, v150, v192
    v_add_f32 v151, v151, v193
    v_lshlrev_b32 v192, 16, v188
    v_and_b32 v193, 0xffff0000, v188
    v_add_f32 v144, v144, v192
    v_add_f32 v145, v145, v193
    v_lshlrev_b32 v192, 16, v189
    v_and_b32 v193, 0xffff0000, v189
    v_add_f32 v146, v146, v192
    v_add_f32 v147, v147, v193
    v_lshlrev_b32 v192, 16, v190
    v_and_b32 v193, 0xffff0000, v190
    v_add_f32 v148, v148, v192
    v_add_f32 v149, v149, v193
    v_lshlrev_b32 v192, 16, v191
    v_and_b32 v193, 0xffff0000, v191
    v_add_f32 v150, v150, v192
    v_add_f32 v151, v151, v193
    v_cvt_pk_bf16_f32 v144, v144, v145
    v_cvt_pk_bf16_f32 v145, v146, v147
    v_cvt_pk_bf16_f32 v146, v148, v149
    v_cvt_pk_bf16_f32 v147, v150, v151
    s_nop 0
    v_permlane32_swap_b32 v144, v146
    v_permlane32_swap_b32 v145, v147
    buffer_store_dwordx4 v[144:147], v240, s[32:35], s73 offen sc1
    s_branch L_rend_47
L_nokeep2_46:
    s_mov_b32 s59, 30000
L_rl_50:
    buffer_load_dwordx4 v[164:167], v238, s[20:23], s89 offen sc1
    buffer_load_dwordx4 v[168:171], v238, s[20:23], s90 offen sc1
    buffer_load_dwordx4 v[172:175], v238, s[20:23], s91 offen sc1
    s_waitcnt vmcnt(0)
    v_max3_u32 v192, v164, v165, v166
    v_max3_u32 v193, v167, v168, v169
    v_max3_u32 v194, v170, v171, v172
    v_max3_u32 v192, v192, v173, v174
    v_max3_u32 v193, v193, v175, v194
    v_max_u32 v192, v192, v193
    v_cmp_eq_u32 vcc, -1, v192
    s_nop 4
    s_cbranch_vccz L_rd_51
    s_sub_u32 s59, s59, 1
    s_cmp_lg_u32 s59, 0
    s_cbranch_scc1 L_rl_50
L_rd_51:
    v_lshlrev_b32 v192, 16, v164
    v_and_b32 v193, 0xffff0000, v164
    v_add_f32 v80, v80, v192
    v_add_f32 v81, v81, v193
    v_lshlrev_b32 v192, 16, v165
    v_and_b32 v193, 0xffff0000, v165
    v_add_f32 v82, v82, v192
    v_add_f32 v83, v83, v193
    v_lshlrev_b32 v192, 16, v166
    v_and_b32 v193, 0xffff0000, v166
    v_add_f32 v84, v84, v192
    v_add_f32 v85, v85, v193
    v_lshlrev_b32 v192, 16, v167
    v_and_b32 v193, 0xffff0000, v167
    v_add_f32 v86, v86, v192
    v_add_f32 v87, v87, v193
    v_lshlrev_b32 v192, 16, v168
    v_and_b32 v193, 0xffff0000, v168
    v_add_f32 v80, v80, v192
    v_add_f32 v81, v81, v193
    v_lshlrev_b32 v192, 16, v169
    v_and_b32 v193, 0xffff0000, v169
    v_add_f32 v82, v82, v192
    v_add_f32 v83, v83, v193
    v_lshlrev_b32 v192, 16, v170
    v_and_b32 v193, 0xffff0000, v170
    v_add_f32 v84, v84, v192
    v_add_f32 v85, v85, v193
    v_lshlrev_b32 v192, 16, v171
    v_and_b32 v193, 0xffff0000, v171
    v_add_f32 v86, v86, v192
    v_add_f32 v87, v87, v193
    v_lshlrev_b32 v192, 16, v172
    v_and_b32 v193, 0xffff0000, v172
    v_add_f32 v80, v80, v192
    v_add_f32 v81, v81, v193
    v_lshlrev_b32 v192, 16, v173
    v_and_b32 v193, 0xffff0000, v173
    v_add_f32 v82, v82, v192
    v_add_f32 v83, v83, v193
    v_lshlrev_b32 v192, 16, v174
    v_and_b32 v193, 0xffff0000, v174
    v_add_f32 v84, v84, v192
    v_add_f32 v85, v85, v193
    v_lshlrev_b32 v192, 16, v175
    v_and_b32 v193, 0xffff0000, v175
    v_add_f32 v86, v86, v192
    v_add_f32 v87, v87, v193
    v_cvt_pk_bf16_f32 v80, v80, v81
    v_cvt_pk_bf16_f32 v81, v82, v83
    v_cvt_pk_bf16_f32 v82, v84, v85
    v_cvt_pk_bf16_f32 v83, v86, v87
    s_nop 0
    v_permlane32_swap_b32 v80, v82
    v_permlane32_swap_b32 v81, v83
    buffer_store_dwordx4 v[80:83], v240, s[32:35], s72 offen sc1
L_rend_47:
    s_branch L_g2fin_37
L_nt4_36:
    ds_read_b64_tr_b16 v[60:61], v230
    ds_read_b64_tr_b16 v[62:63], v230 offset:2560
    s_add_u32 m0, s66, 0
    s_nop 0
    buffer_load_dwordx4 v224, s[84:87], s61 offen lds
    ds_read_b64_tr_b16 v[64:65], v231
    ds_read_b64_tr_b16 v[66:67], v231 offset:2560
    s_add_u32 m0, s66, 1024
    s_nop 0
    buffer_load_dwordx4 v225, s[84:87], s61 offen lds
    ds_read_b64_tr_b16 v[68:69], v232
    ds_read_b64_tr_b16 v[70:71], v232 offset:2560
    s_add_u32 m0, s66, 2048
    s_mov_b32 exec_hi, 0
    buffer_load_dwordx4 v226, s[84:87], s61 offen lds
    s_mov_b32 exec_hi, -1
    s_add_u32 s61, s61, s62
    ds_read_b64_tr_b16 v[72:73], v233
    ds_read_b64_tr_b16 v[74:75], v233 offset:2560
    s_add_u32 m0, s66, 20480
    s_nop 0
    buffer_load_dwordx4 v224, s[84:87], s61 offen lds
    s_waitcnt vmcnt(19)
    s_waitcnt lgkmcnt(6)
    v_mfma_f32_32x32x16_bf16 v[80:95], v[60:63], v[56:59], 0
    ds_read_b64_tr_b16 v[76:77], v230 offset:8192
    ds_read_b64_tr_b16 v[78:79], v230 offset:10752
    s_add_u32 m0, s66, 21504
    s_nop 0
    buffer_load_dwordx4 v225, s[84:87], s61 offen lds
    s_waitcnt lgkmcnt(6)
    v_mfma_f32_32x32x16_bf16 v[96:111], v[64:67], v[56:59], 0
    ds_read_b64_tr_b16 v[60:61], v231 offset:8192
    ds_read_b64_tr_b16 v[62:63], v231 offset:10752
    s_add_u32 m0, s66, 22528
    s_mov_b32 exec_hi, 0
    buffer_load_dwordx4 v226, s[84:87], s61 offen lds
    s_mov_b32 exec_hi, -1
    s_add_u32 s61, s61, s62
    s_waitcnt lgkmcnt(6)
    v_mfma_f32_32x32x16_bf16 v[112:127], v[68:71], v[56:59], 0
    ds_read_b64_tr_b16 v[64:65], v232 offset:8192
    ds_read_b64_tr_b16 v[66:67], v232 offset:10752
    s_waitcnt lgkmcnt(6)
    v_mfma_f32_32x32x16_bf16 v[128:143], v[72:75], v[56:59], 0
    ds_read_b64_tr_b16 v[68:69], v233 offset:8192
    ds_read_b64_tr_b16 v[70:71], v233 offset:10752
    s_waitcnt vmcnt(20)
    s_waitcnt lgkmcnt(6)
    v_mfma_f32_32x32x16_bf16 v[80:95], v[76:79], v[16:19], v[80:95]
    ds_read_b64_tr_b16 v[72:73], v230 offset:13312
    ds_read_b64_tr_b16 v[74:75], v230 offset:15872
    s_waitcnt lgkmcnt(6)
    v_mfma_f32_32x32x16_bf16 v[96:111], v[60:63], v[16:19], v[96:111]
    ds_read_b64_tr_b16 v[76:77], v231 offset:13312
    ds_read_b64_tr_b16 v[78:79], v231 offset:15872
    s_waitcnt lgkmcnt(6)
    v_mfma_f32_32x32x16_bf16 v[112:127], v[64:67], v[16:19], v[112:127]
    ds_read_b64_tr_b16 v[60:61], v232 offset:13312
    ds_read_b64_tr_b16 v[62:63], v232 offset:15872
    s_waitcnt lgkmcnt(6)
    v_mfma_f32_32x32x16_bf16 v[128:143], v[68:71], v[16:19], v[128:143]
    buffer_load_dwordx4 v[16:19], v235, s[20:23], s63 offen offset:0 sc1
    ds_read_b64_tr_b16 v[64:65], v233 offset:13312
    ds_read_b64_tr_b16 v[66:67], v233 offset:15872
    s_waitcnt vmcnt(20)
    s_waitcnt lgkmcnt(6)
    v_mfma_f32_32x32x16_bf16 v[80:95], v[72:75], v[20:23], v[80:95]
    ds_read_b64_tr_b16 v[68:69], v230 offset:28672
    ds_read_b64_tr_b16 v[70:71], v230 offset:31232
    s_waitcnt lgkmcnt(6)
    v_mfma_f32_32x32x16_bf16 v[96:111], v[76:79], v[20:23], v[96:111]
    ds_read_b64_tr_b16 v[72:73], v231 offset:28672
    ds_read_b64_tr_b16 v[74:75], v231 offset:31232
    s_waitcnt lgkmcnt(6)
    v_mfma_f32_32x32x16_bf16 v[112:127], v[60:63], v[20:23], v[112:127]
    ds_read_b64_tr_b16 v[76:77], v232 offset:28672
    ds_read_b64_tr_b16 v[78:79], v232 offset:31232
    s_waitcnt lgkmcnt(6)
    v_mfma_f32_32x32x16_bf16 v[128:143], v[64:67], v[20:23], v[128:143]
    buffer_load_dwordx4 v[20:23], v235, s[20:23], s63 offen offset:1024 sc1
    s_add_u32 s63, s63, 4096
    ds_read_b64_tr_b16 v[60:61], v233 offset:28672
    ds_read_b64_tr_b16 v[62:63], v233 offset:31232
    s_waitcnt vmcnt(20)
    s_waitcnt lgkmcnt(6)
    v_mfma_f32_32x32x16_bf16 v[80:95], v[68:71], v[24:27], v[80:95]
    ds_read_b64_tr_b16 v[64:65], v230 offset:33792
    ds_read_b64_tr_b16 v[66:67], v230 offset:36352
    s_waitcnt lgkmcnt(6)
    v_mfma_f32_32x32x16_bf16 v[96:111], v[72:75], v[24:27], v[96:111]
    ds_read_b64_tr_b16 v[68:69], v231 offset:33792
    ds_read_b64_tr_b16 v[70:71], v231 offset:36352
    s_waitcnt lgkmcnt(6)
    v_mfma_f32_32x32x16_bf16 v[112:127], v[76:79], v[24:27], v[112:127]
    ds_read_b64_tr_b16 v[72:73], v232 offset:33792
    ds_read_b64_tr_b16 v[74:75], v232 offset:36352
    s_waitcnt lgkmcnt(6)
    v_mfma_f32_32x32x16_bf16 v[128:143], v[60:63], v[24:27], v[128:143]
    buffer_load_dwordx4 v[24:27], v235, s[20:23], s63 offen offset:0 sc1
    ds_read_b64_tr_b16 v[76:77], v233 offset:33792
    ds_read_b64_tr_b16 v[78:79], v233 offset:36352
    s_waitcnt vmcnt(20)
    s_waitcnt lgkmcnt(6)
    v_mfma_f32_32x32x16_bf16 v[80:95], v[64:67], v[28:31], v[80:95]
    s_barrier
    s_waitcnt vmcnt(9)
    s_add_u32 s52, s3, 16384
    v_mov_b32 v254, s50
    s_mov_b64 exec, 1
    buffer_store_dword v254, off, s[20:23], s52 offset:0 sc1
    s_mov_b64 exec, -1
    ds_read_b64_tr_b16 v[60:61], v230 offset:49152
    ds_read_b64_tr_b16 v[62:63], v230 offset:51712
    s_waitcnt lgkmcnt(6)
    v_mfma_f32_32x32x16_bf16 v[96:111], v[68:71], v[28:31], v[96:111]
    ds_read_b64_tr_b16 v[64:65], v231 offset:49152
    ds_read_b64_tr_b16 v[66:67], v231 offset:51712
    s_add_u32 m0, s66, 40960
    s_nop 0
    buffer_load_dwordx4 v224, s[84:87], s61 offen lds
    s_waitcnt lgkmcnt(6)
    v_mfma_f32_32x32x16_bf16 v[112:127], v[72:75], v[28:31], v[112:127]
    ds_read_b64_tr_b16 v[68:69], v232 offset:49152
    ds_read_b64_tr_b16 v[70:71], v232 offset:51712
    s_waitcnt lgkmcnt(6)
    v_mfma_f32_32x32x16_bf16 v[128:143], v[76:79], v[28:31], v[128:143]
    buffer_load_dwordx4 v[28:31], v235, s[20:23], s63 offen offset:1024 sc1
    s_add_u32 s63, s63, 4096
    ds_read_b64_tr_b16 v[72:73], v233 offset:49152
    ds_read_b64_tr_b16 v[74:75], v233 offset:51712
    s_add_u32 m0, s66, 41984
    s_nop 0
    buffer_load_dwordx4 v225, s[84:87], s61 offen lds
    s_waitcnt lgkmcnt(6)
    v_mfma_f32_32x32x16_bf16 v[80:95], v[60:63], v[32:35], v[80:95]
    ds_read_b64_tr_b16 v[76:77], v230 offset:54272
    ds_read_b64_tr_b16 v[78:79], v230 offset:56832
    s_waitcnt lgkmcnt(6)
    v_mfma_f32_32x32x16_bf16 v[96:111], v[64:67], v[32:35], v[96:111]
    ds_read_b64_tr_b16 v[60:61], v231 offset:54272
    ds_read_b64_tr_b16 v[62:63], v231 offset:56832
    s_add_u32 m0, s66, 43008
    s_mov_b32 exec_hi, 0
    buffer_load_dwordx4 v226, s[84:87], s61 offen lds
    s_mov_b32 exec_hi, -1
    s_add_u32 s61, s61, s62
    s_waitcnt lgkmcnt(6)
    v_mfma_f32_32x32x16_bf16 v[112:127], v[68:71], v[32:35], v[112:127]
    ds_read_b64_tr_b16 v[64:65], v232 offset:54272
    ds_read_b64_tr_b16 v[66:67], v232 offset:56832
    s_waitcnt lgkmcnt(6)
    v_mfma_f32_32x32x16_bf16 v[128:143], v[72:75], v[32:35], v[128:143]
    buffer_load_dwordx4 v[32:35], v235, s[20:23], s63 offen offset:0 sc1
    ds_read_b64_tr_b16 v[68:69], v233 offset:54272
    ds_read_b64_tr_b16 v[70:71], v233 offset:56832
    s_add_u32 m0, s66, 61440
    s_nop 0
    buffer_load_dwordx4 v224, s[84:87], s61 offen lds
    s_waitcnt lgkmcnt(6)
    v_mfma_f32_32x32x16_bf16 v[80:95], v[76:79], v[36:39], v[80:95]
    v_add_u32 v230, 69632, v230
    v_add_u32 v231, 69632, v231
    v_add_u32 v232, 69632, v232
    v_add_u32 v233, 69632, v233
    ds_read_b64_tr_b16 v[72:73], v230 offset:0
    ds_read_b64_tr_b16 v[74:75], v230 offset:2560
    s_waitcnt lgkmcnt(6)
    v_mfma_f32_32x32x16_bf16 v[96:111], v[60:63], v[36:39], v[96:111]
    ds_read_b64_tr_b16 v[76:77], v231 offset:0
    ds_read_b64_tr_b16 v[78:79], v231 offset:2560
    s_add_u32 m0, s66, 62464
    s_nop 0
    buffer_load_dwordx4 v225, s[84:87], s61 offen lds
    s_waitcnt lgkmcnt(6)
    v_mfma_f32_32x32x16_bf16 v[112:127], v[64:67], v[36:39], v[112:127]
    ds_read_b64_tr_b16 v[60:61], v232 offset:0
    ds_read_b64_tr_b16 v[62:63], v232 offset:2560
    s_waitcnt lgkmcnt(6)
    v_mfma_f32_32x32x16_bf16 v[128:143], v[68:71], v[36:39], v[128:143]
    buffer_load_dword v253, v252, s[20:23], s4 offen sc1
    buffer_load_dwordx4 v[36:39], v235, s[20:23], s63 offen offset:1024 sc1
    s_add_u32 s63, s63, 4096
    ds_read_b64_tr_b16 v[64:65], v233 offset:0
    ds_read_b64_tr_b16 v[66:67], v233 offset:2560
    s_add_u32 m0, s66, 63488
    s_mov_b32 exec_hi, 0
    buffer_load_dwordx4 v226, s[84:87], s61 offen lds
    s_mov_b32 exec_hi, -1
    s_add_u32 s61, s61, s62
    s_waitcnt lgkmcnt(6)
    v_mfma_f32_32x32x16_bf16 v[80:95], v[72:75], v[40:43], v[80:95]
    ds_read_b64_tr_b16 v[68:69], v230 offset:5120
    ds_read_b64_tr_b16 v[70:71], v230 offset:7680
    s_waitcnt lgkmcnt(6)
    v_mfma_f32_32x32x16_bf16 v[96:111], v[76:79], v[40:43], v[96:111]
    ds_read_b64_tr_b16 v[72:73], v231 offset:5120
    ds_read_b64_tr_b16 v[74:75], v231 offset:7680
    s_add_u32 m0, s66, 81920
    s_nop 0
    buffer_load_dwordx4 v224, s[84:87], s61 offen lds
    s_waitcnt lgkmcnt(6)
    v_mfma_f32_32x32x16_bf16 v[112:127], v[60:63], v[40:43], v[112:127]
    ds_read_b64_tr_b16 v[76:77], v232 offset:5120
    ds_read_b64_tr_b16 v[78:79], v232 offset:7680
    s_waitcnt lgkmcnt(6)
    v_mfma_f32_32x32x16_bf16 v[128:143], v[64:67], v[40:43], v[128:143]
    buffer_load_dwordx4 v[40:43], v235, s[20:23], s63 offen offset:0 sc1
    ds_read_b64_tr_b16 v[60:61], v233 offset:5120
    ds_read_b64_tr_b16 v[62:63], v233 offset:7680
    s_add_u32 m0, s66, 82944
    s_nop 0
    buffer_load_dwordx4 v225, s[84:87], s61 offen lds
    s_waitcnt lgkmcnt(6)
    v_mfma_f32_32x32x16_bf16 v[80:95], v[68:71], v[44:47], v[80:95]
    s_add_u32 m0, s66, 83968
    s_mov_b32 exec_hi, 0
    buffer_load_dwordx4 v226, s[84:87], s61 offen lds
    s_mov_b32 exec_hi, -1
    s_add_u32 s61, s61, s62
    s_waitcnt vmcnt(20)
    s_barrier
    ds_read_b64_tr_b16 v[64:65], v230 offset:20480
    ds_read_b64_tr_b16 v[66:67], v230 offset:23040
    s_waitcnt lgkmcnt(6)
    v_mfma_f32_32x32x16_bf16 v[96:111], v[72:75], v[44:47], v[96:111]
    ds_read_b64_tr_b16 v[68:69], v231 offset:20480
    ds_read_b64_tr_b16 v[70:71], v231 offset:23040
    s_add_u32 m0, s66, 102400
    s_nop 0
    buffer_load_dwordx4 v224, s[84:87], s61 offen lds
    s_waitcnt lgkmcnt(6)
    v_mfma_f32_32x32x16_bf16 v[112:127], v[76:79], v[44:47], v[112:127]
    ds_read_b64_tr_b16 v[72:73], v232 offset:20480
    ds_read_b64_tr_b16 v[74:75], v232 offset:23040
    s_waitcnt lgkmcnt(6)
    v_mfma_f32_32x32x16_bf16 v[128:143], v[60:63], v[44:47], v[128:143]
    buffer_load_dwordx4 v[44:47], v235, s[20:23], s63 offen offset:1024 sc1
    s_add_u32 s63, s63, 4096
    ds_read_b64_tr_b16 v[76:77], v233 offset:20480
    ds_read_b64_tr_b16 v[78:79], v233 offset:23040
    s_add_u32 m0, s66, 103424
    s_nop 0
    buffer_load_dwordx4 v225, s[84:87], s61 offen lds
    s_waitcnt lgkmcnt(6)
    v_mfma_f32_32x32x16_bf16 v[80:95], v[64:67], v[48:51], v[80:95]
    ds_read_b64_tr_b16 v[60:61], v230 offset:25600
    ds_read_b64_tr_b16 v[62:63], v230 offset:28160
    s_waitcnt lgkmcnt(6)
    v_mfma_f32_32x32x16_bf16 v[96:111], v[68:71], v[48:51], v[96:111]
    ds_read_b64_tr_b16 v[64:65], v231 offset:25600
    ds_read_b64_tr_b16 v[66:67], v231 offset:28160
    s_add_u32 m0, s66, 104448
    s_mov_b32 exec_hi, 0
    buffer_load_dwordx4 v226, s[84:87], s61 offen lds
    s_mov_b32 exec_hi, -1
    s_add_u32 s61, s61, s62
    s_waitcnt lgkmcnt(6)
    v_mfma_f32_32x32x16_bf16 v[112:127], v[72:75], v[48:51], v[112:127]
    ds_read_b64_tr_b16 v[68:69], v232 offset:25600
    ds_read_b64_tr_b16 v[70:71], v232 offset:28160
    s_waitcnt lgkmcnt(6)
    v_mfma_f32_32x32x16_bf16 v[128:143], v[76:79], v[48:51], v[128:143]
    s_waitcnt vmcnt(10)
    s_mov_b32 s59, 30000
L_pl_54:
    v_cmp_ne_u32 vcc, s50, v253
    s_nop 4
    s_cbranch_vccz L_pd_53
    buffer_load_dword v253, v252, s[20:23], s4 offen sc1
    s_waitcnt vmcnt(0)
    s_sub_u32 s59, s59, 1
    s_cmp_lg_u32 s59, 0
    s_cbranch_scc1 L_pl_54
L_pd_53:
    v_and_b32 v252, 31, v0
    v_lshlrev_b32 v252, 2, v252
    v_add_u32 v252, 16384, v252
    buffer_load_dwordx4 v[48:51], v235, s[20:23], s63 offen offset:0 sc1
    ds_read_b64_tr_b16 v[72:73], v233 offset:25600
    ds_read_b64_tr_b16 v[74:75], v233 offset:28160
    s_add_u32 m0, s66, 122880
    s_nop 0
    buffer_load_dwordx4 v224, s[84:87], s61 offen lds
    s_waitcnt lgkmcnt(6)
    v_mfma_f32_32x32x16_bf16 v[80:95], v[60:63], v[52:55], v[80:95]
    v_subrev_u32 v230, 122880, v230
    v_subrev_u32 v231, 122880, v231
    v_subrev_u32 v232, 122880, v232
    v_subrev_u32 v233, 122880, v233
    ds_read_b64_tr_b16 v[76:77], v230 offset:0
    ds_read_b64_tr_b16 v[78:79], v230 offset:2560
    s_waitcnt lgkmcnt(6)
    v_mfma_f32_32x32x16_bf16 v[96:111], v[64:67], v[52:55], v[96:111]
    ds_read_b64_tr_b16 v[60:61], v231 offset:0
    ds_read_b64_tr_b16 v[62:63], v231 offset:2560
    s_add_u32 m0, s66, 123904
    s_nop 0
    buffer_load_dwordx4 v225, s[84:87], s61 offen lds
    s_waitcnt lgkmcnt(6)
    v_mfma_f32_32x32x16_bf16 v[112:127], v[68:71], v[52:55], v[112:127]
    ds_read_b64_tr_b16 v[64:65], v232 offset:0
    ds_read_b64_tr_b16 v[66:67], v232 offset:2560
    s_waitcnt lgkmcnt(6)
    v_mfma_f32_32x32x16_bf16 v[128:143], v[72:75], v[52:55], v[128:143]
    buffer_load_dwordx4 v[52:55], v235, s[20:23], s63 offen offset:1024 sc1
    s_add_u32 s63, s63, 4096
    ds_read_b64_tr_b16 v[68:69], v233 offset:0
    ds_read_b64_tr_b16 v[70:71], v233 offset:2560
    s_add_u32 m0, s66, 124928
    s_mov_b32 exec_hi, 0
    buffer_load_dwordx4 v226, s[84:87], s61 offen lds
    s_mov_b32 exec_hi, -1
    s_add_u32 s61, s61, s62
    s_waitcnt lgkmcnt(6)
    v_mfma_f32_32x32x16_bf16 v[80:95], v[76:79], v[16:19], v[80:95]
    ds_read_b64_tr_b16 v[72:73], v230 offset:5120
    ds_read_b64_tr_b16 v[74:75], v230 offset:7680
    s_waitcnt lgkmcnt(6)
    v_mfma_f32_32x32x16_bf16 v[96:111], v[60:63], v[16:19], v[96:111]
    ds_read_b64_tr_b16 v[76:77], v231 offset:5120
    ds_read_b64_tr_b16 v[78:79], v231 offset:7680
    s_waitcnt lgkmcnt(6)
    v_mfma_f32_32x32x16_bf16 v[112:127], v[64:67], v[16:19], v[112:127]
    ds_read_b64_tr_b16 v[60:61], v232 offset:5120
    ds_read_b64_tr_b16 v[62:63], v232 offset:7680
    s_waitcnt lgkmcnt(6)
    v_mfma_f32_32x32x16_bf16 v[128:143], v[68:71], v[16:19], v[128:143]
    buffer_load_dwordx4 v[16:19], v235, s[20:23], s63 offen offset:0 sc1
    ds_read_b64_tr_b16 v[64:65], v233 offset:5120
    ds_read_b64_tr_b16 v[66:67], v233 offset:7680
    s_waitcnt lgkmcnt(6)
    v_mfma_f32_32x32x16_bf16 v[80:95], v[72:75], v[20:23], v[80:95]
    s_barrier
    ds_read_b64_tr_b16 v[68:69], v230 offset:20480
    ds_read_b64_tr_b16 v[70:71], v230 offset:23040
    s_waitcnt lgkmcnt(6)
    v_mfma_f32_32x32x16_bf16 v[96:111], v[76:79], v[20:23], v[96:111]
    ds_read_b64_tr_b16 v[72:73], v231 offset:20480
    ds_read_b64_tr_b16 v[74:75], v231 offset:23040
    s_add_u32 m0, s66, 143360
    s_nop 0
    buffer_load_dwordx4 v224, s[84:87], s61 offen lds
    s_waitcnt lgkmcnt(6)
    v_mfma_f32_32x32x16_bf16 v[112:127], v[60:63], v[20:23], v[112:127]
    ds_read_b64_tr_b16 v[76:77], v232 offset:20480
    ds_read_b64_tr_b16 v[78:79], v232 offset:23040
    s_waitcnt lgkmcnt(6)
    v_mfma_f32_32x32x16_bf16 v[128:143], v[64:67], v[20:23], v[128:143]
    buffer_load_dwordx4 v[20:23], v235, s[20:23], s63 offen offset:1024 sc1
    s_add_u32 s63, s63, 4096
    ds_read_b64_tr_b16 v[60:61], v233 offset:20480
    ds_read_b64_tr_b16 v[62:63], v233 offset:23040
    s_add_u32 m0, s66, 144384
    s_nop 0
    buffer_load_dwordx4 v225, s[84:87], s61 offen lds
    s_waitcnt lgkmcnt(6)
    v_mfma_f32_32x32x16_bf16 v[80:95], v[68:71], v[24:27], v[80:95]
    ds_read_b64_tr_b16 v[64:65], v230 offset:25600
    ds_read_b64_tr_b16 v[66:67], v230 offset:28160
    s_waitcnt lgkmcnt(6)
    v_mfma_f32_32x32x16_bf16 v[96:111], v[72:75], v[24:27], v[96:111]
    ds_read_b64_tr_b16 v[68:69], v231 offset:25600
    ds_read_b64_tr_b16 v[70:71], v231 offset:28160
    s_add_u32 m0, s66, 145408
    s_mov_b32 exec_hi, 0
    buffer_load_dwordx4 v226, s[84:87], s61 offen lds
    s_mov_b32 exec_hi, -1
    s_add_u32 s61, s61, s62
    s_waitcnt lgkmcnt(6)
    v_mfma_f32_32x32x16_bf16 v[112:127], v[76:79], v[24:27], v[112:127]
    ds_read_b64_tr_b16 v[72:73], v232 offset:25600
    ds_read_b64_tr_b16 v[74:75], v232 offset:28160
    s_waitcnt lgkmcnt(6)
    v_mfma_f32_32x32x16_bf16 v[128:143], v[60:63], v[24:27], v[128:143]
    buffer_load_dwordx4 v[24:27], v235, s[20:23], s63 offen offset:0 sc1
    ds_read_b64_tr_b16 v[76:77], v233 offset:25600
    ds_read_b64_tr_b16 v[78:79], v233 offset:28160
    s_add_u32 m0, s66, 0
    s_nop 0
    buffer_load_dwordx4 v224, s[84:87], s61 offen lds
    s_waitcnt lgkmcnt(6)
    v_mfma_f32_32x32x16_bf16 v[80:95], v[64:67], v[28:31], v[80:95]
    ds_read_b64_tr_b16 v[60:61], v230 offset:40960
    ds_read_b64_tr_b16 v[62:63], v230 offset:43520
    s_waitcnt lgkmcnt(6)
    v_mfma_f32_32x32x16_bf16 v[96:111], v[68:71], v[28:31], v[96:111]
    ds_read_b64_tr_b16 v[64:65], v231 offset:40960
    ds_read_b64_tr_b16 v[66:67], v231 offset:43520
    s_add_u32 m0, s66, 1024
    s_nop 0
    buffer_load_dwordx4 v225, s[84:87], s61 offen lds
    s_waitcnt lgkmcnt(6)
    v_mfma_f32_32x32x16_bf16 v[112:127], v[72:75], v[28:31], v[112:127]
    ds_read_b64_tr_b16 v[68:69], v232 offset:40960
    ds_read_b64_tr_b16 v[70:71], v232 offset:43520
    s_waitcnt lgkmcnt(6)
    v_mfma_f32_32x32x16_bf16 v[128:143], v[76:79], v[28:31], v[128:143]
    buffer_load_dwordx4 v[28:31], v235, s[20:23], s63 offen offset:1024 sc1
    s_add_u32 s63, s63, 4096
    ds_read_b64_tr_b16 v[72:73], v233 offset:40960
    ds_read_b64_tr_b16 v[74:75], v233 offset:43520
    s_add_u32 m0, s66, 2048
    s_mov_b32 exec_hi, 0
    buffer_load_dwordx4 v226, s[84:87], s61 offen lds
    s_mov_b32 exec_hi, -1
    s_add_u32 s61, s61, s62
    s_waitcnt lgkmcnt(6)
    v_mfma_f32_32x32x16_bf16 v[80:95], v[60:63], v[32:35], v[80:95]
    ds_read_b64_tr_b16 v[76:77], v230 offset:46080
    ds_read_b64_tr_b16 v[78:79], v230 offset:48640
    s_waitcnt lgkmcnt(6)
    v_mfma_f32_32x32x16_bf16 v[96:111], v[64:67], v[32:35], v[96:111]
    ds_read_b64_tr_b16 v[60:61], v231 offset:46080
    ds_read_b64_tr_b16 v[62:63], v231 offset:48640
    s_waitcnt lgkmcnt(6)
    v_mfma_f32_32x32x16_bf16 v[112:127], v[68:71], v[32:35], v[112:127]
    ds_read_b64_tr_b16 v[64:65], v232 offset:46080
    ds_read_b64_tr_b16 v[66:67], v232 offset:48640
    s_waitcnt lgkmcnt(6)
    v_mfma_f32_32x32x16_bf16 v[128:143], v[72:75], v[32:35], v[128:143]
    s_lshl_b32 s52, s60, 2
    s_add_u32 s52, s52, s71
    v_mov_b32 v254, s50
    s_mov_b64 exec, 1
    buffer_store_dword v254, off, s[20:23], s52 offset:0 sc1
    s_mov_b64 exec, -1
    buffer_load_dwordx4 v[32:35], v235, s[20:23], s63 offen offset:0 sc1
    ds_read_b64_tr_b16 v[68:69], v233 offset:46080
    ds_read_b64_tr_b16 v[70:71], v233 offset:48640
    s_waitcnt vmcnt(25)
    s_waitcnt lgkmcnt(6)
    v_mfma_f32_32x32x16_bf16 v[80:95], v[76:79], v[36:39], v[80:95]
    s_waitcnt vmcnt(20)
    s_barrier
    ds_read_b64_tr_b16 v[72:73], v230 offset:61440
    ds_read_b64_tr_b16 v[74:75], v230 offset:64000
    s_waitcnt lgkmcnt(6)
    v_mfma_f32_32x32x16_bf16 v[96:111], v[60:63], v[36:39], v[96:111]
    ds_read_b64_tr_b16 v[76:77], v231 offset:61440
    ds_read_b64_tr_b16 v[78:79], v231 offset:64000
    s_add_u32 m0, s66, 20480
    s_nop 0
    buffer_load_dwordx4 v224, s[84:87], s61 offen lds
    s_waitcnt lgkmcnt(6)
    v_mfma_f32_32x32x16_bf16 v[112:127], v[64:67], v[36:39], v[112:127]
    ds_read_b64_tr_b16 v[60:61], v232 offset:61440
    ds_read_b64_tr_b16 v[62:63], v232 offset:64000
    s_waitcnt lgkmcnt(6)
    v_mfma_f32_32x32x16_bf16 v[128:143], v[68:71], v[36:39], v[128:143]
    buffer_load_dwordx4 v[36:39], v235, s[20:23], s63 offen offset:1024 sc1
    s_add_u32 s63, s63, 4096
    ds_read_b64_tr_b16 v[64:65], v233 offset:61440
    ds_read_b64_tr_b16 v[66:67], v233 offset:64000
    s_add_u32 m0, s66, 21504
    s_nop 0
    buffer_load_dwordx4 v225, s[84:87], s61 offen lds
    s_waitcnt lgkmcnt(6)
    v_mfma_f32_32x32x16_bf16 v[80:95], v[72:75], v[40:43], v[80:95]
    v_add_u32 v230, 61440, v230
    v_add_u32 v231, 61440, v231
    v_add_u32 v232, 61440, v232
    v_add_u32 v233, 61440, v233
    ds_read_b64_tr_b16 v[68:69], v230 offset:5120
    ds_read_b64_tr_b16 v[70:71], v230 offset:7680
    s_waitcnt lgkmcnt(6)
    v_mfma_f32_32x32x16_bf16 v[96:111], v[76:79], v[40:43], v[96:111]
    ds_read_b64_tr_b16 v[72:73], v231 offset:5120
    ds_read_b64_tr_b16 v[74:75], v231 offset:7680
    s_add_u32 m0, s66, 22528
    s_mov_b32 exec_hi, 0
    buffer_load_dwordx4 v226, s[84:87], s61 offen lds
    s_mov_b32 exec_hi, -1
    s_add_u32 s61, s61, s62
    s_waitcnt lgkmcnt(6)
    v_mfma_f32_32x32x16_bf16 v[112:127], v[60:63], v[40:43], v[112:127]
    ds_read_b64_tr_b16 v[76:77], v232 offset:5120
    ds_read_b64_tr_b16 v[78:79], v232 offset:7680
    s_waitcnt lgkmcnt(6)
    v_mfma_f32_32x32x16_bf16 v[128:143], v[64:67], v[40:43], v[128:143]
    buffer_load_dwordx4 v[40:43], v235, s[20:23], s63 offen offset:0 sc1
    ds_read_b64_tr_b16 v[60:61], v233 offset:5120
    ds_read_b64_tr_b16 v[62:63], v233 offset:7680
    s_add_u32 m0, s66, 40960
    s_nop 0
    buffer_load_dwordx4 v224, s[84:87], s61 offen lds
    s_waitcnt vmcnt(24)
    s_waitcnt lgkmcnt(6)
    v_mfma_f32_32x32x16_bf16 v[80:95], v[68:71], v[44:47], v[80:95]
    ds_read_b64_tr_b16 v[64:65], v230 offset:20480
    ds_read_b64_tr_b16 v[66:67], v230 offset:23040
    s_waitcnt lgkmcnt(6)
    v_mfma_f32_32x32x16_bf16 v[96:111], v[72:75], v[44:47], v[96:111]
    ds_read_b64_tr_b16 v[68:69], v231 offset:20480
    ds_read_b64_tr_b16 v[70:71], v231 offset:23040
    s_add_u32 m0, s66, 41984
    s_nop 0
    buffer_load_dwordx4 v225, s[84:87], s61 offen lds
    s_waitcnt lgkmcnt(6)
    v_mfma_f32_32x32x16_bf16 v[112:127], v[76:79], v[44:47], v[112:127]
    ds_read_b64_tr_b16 v[72:73], v232 offset:20480
    ds_read_b64_tr_b16 v[74:75], v232 offset:23040
    s_waitcnt lgkmcnt(6)
    v_mfma_f32_32x32x16_bf16 v[128:143], v[60:63], v[44:47], v[128:143]
    buffer_load_dwordx4 v[44:47], v235, s[20:23], s63 offen offset:1024 sc1
    s_add_u32 s63, s63, 4096
    ds_read_b64_tr_b16 v[76:77], v233 offset:20480
    ds_read_b64_tr_b16 v[78:79], v233 offset:23040
    s_add_u32 m0, s66, 43008
    s_mov_b32 exec_hi, 0
    buffer_load_dwordx4 v226, s[84:87], s61 offen lds
    s_mov_b32 exec_hi, -1
    s_add_u32 s61, s61, s62
    s_waitcnt vmcnt(24)
    s_waitcnt lgkmcnt(6)
    v_mfma_f32_32x32x16_bf16 v[80:95], v[64:67], v[48:51], v[80:95]
    ds_read_b64_tr_b16 v[60:61], v230 offset:25600
    ds_read_b64_tr_b16 v[62:63], v230 offset:28160
    s_waitcnt lgkmcnt(6)
    v_mfma_f32_32x32x16_bf16 v[96:111], v[68:71], v[48:51], v[96:111]
    ds_read_b64_tr_b16 v[64:65], v231 offset:25600
    ds_read_b64_tr_b16 v[66:67], v231 offset:28160
    s_waitcnt lgkmcnt(6)
    v_mfma_f32_32x32x16_bf16 v[112:127], v[72:75], v[48:51], v[112:127]
    ds_read_b64_tr_b16 v[68:69], v232 offset:25600
    ds_read_b64_tr_b16 v[70:71], v232 offset:28160
    s_waitcnt lgkmcnt(6)
    v_mfma_f32_32x32x16_bf16 v[128:143], v[76:79], v[48:51], v[128:143]
    buffer_load_dwordx4 v[48:51], v235, s[20:23], s63 offen offset:0 sc1
    ds_read_b64_tr_b16 v[72:73], v233 offset:25600
    ds_read_b64_tr_b16 v[74:75], v233 offset:28160
    s_waitcnt vmcnt(22)
    s_waitcnt lgkmcnt(6)
    v_mfma_f32_32x32x16_bf16 v[80:95], v[60:63], v[52:55], v[80:95]
    s_waitcnt vmcnt(21)
    s_barrier
    ds_read_b64_tr_b16 v[76:77], v230 offset:40960
    ds_read_b64_tr_b16 v[78:79], v230 offset:43520
    s_waitcnt lgkmcnt(6)
    v_mfma_f32_32x32x16_bf16 v[96:111], v[64:67], v[52:55], v[96:111]
    ds_read_b64_tr_b16 v[60:61], v231 offset:40960
    ds_read_b64_tr_b16 v[62:63], v231 offset:43520
    s_add_u32 m0, s66, 61440
    s_nop 0
    buffer_load_dwordx4 v224, s[84:87], s61 offen lds
    s_waitcnt lgkmcnt(6)
    v_mfma_f32_32x32x16_bf16 v[112:127], v[68:71], v[52:55], v[112:127]
    ds_read_b64_tr_b16 v[64:65], v232 offset:40960
    ds_read_b64_tr_b16 v[66:67], v232 offset:43520
    s_waitcnt lgkmcnt(6)
    v_mfma_f32_32x32x16_bf16 v[128:143], v[72:75], v[52:55], v[128:143]
    buffer_load_dword v253, v252, s[20:23], s4 offen sc1
    buffer_load_dwordx4 v[52:55], v235, s[20:23], s63 offen offset:1024 sc1
    s_add_u32 s63, s63, 4096
    ds_read_b64_tr_b16 v[68:69], v233 offset:40960
    ds_read_b64_tr_b16 v[70:71], v233 offset:43520
    s_add_u32 m0, s66, 62464
    s_nop 0
    buffer_load_dwordx4 v225, s[84:87], s61 offen lds
    s_waitcnt vmcnt(24)
    s_waitcnt lgkmcnt(6)
    v_mfma_f32_32x32x16_bf16 v[80:95], v[76:79], v[16:19], v[80:95]
    ds_read_b64_tr_b16 v[72:73], v230 offset:46080
    ds_read_b64_tr_b16 v[74:75], v230 offset:48640
    s_waitcnt lgkmcnt(6)
    v_mfma_f32_32x32x16_bf16 v[96:111], v[60:63], v[16:19], v[96:111]
    ds_read_b64_tr_b16 v[76:77], v231 offset:46080
    ds_read_b64_tr_b16 v[78:79], v231 offset:48640
    s_add_u32 m0, s66, 63488
    s_mov_b32 exec_hi, 0
    buffer_load_dwordx4 v226, s[84:87], s61 offen lds
    s_mov_b32 exec_hi, -1
    s_add_u32 s61, s61, s62
    s_waitcnt lgkmcnt(6)
    v_mfma_f32_32x32x16_bf16 v[112:127], v[64:67], v[16:19], v[112:127]
    ds_read_b64_tr_b16 v[60:61], v232 offset:46080
    ds_read_b64_tr_b16 v[62:63], v232 offset:48640
    s_waitcnt lgkmcnt(6)
    v_mfma_f32_32x32x16_bf16 v[128:143], v[68:71], v[16:19], v[128:143]
    buffer_load_dwordx4 v[16:19], v235, s[20:23], s63 offen offset:0 sc1
    ds_read_b64_tr_b16 v[64:65], v233 offset:46080
    ds_read_b64_tr_b16 v[66:67], v233 offset:48640
    s_mov_b32 s61, s64
    s_cmp_lg_u32 s60, 0
    s_cselect_b32 s62, 82944, s62
    s_cselect_b64 s[84:85], s[28:29], s[24:25]
    s_cselect_b32 s86, s30, s26
    s_add_u32 m0, s66, 81920
    s_nop 0
    buffer_load_dwordx4 v224, s[84:87], s61 offen lds
    s_waitcnt vmcnt(25)
    s_waitcnt lgkmcnt(6)
    v_mfma_f32_32x32x16_bf16 v[80:95], v[72:75], v[20:23], v[80:95]
    ds_read_b64_tr_b16 v[68:69], v230 offset:61440
    ds_read_b64_tr_b16 v[70:71], v230 offset:64000
    s_waitcnt lgkmcnt(6)
    v_mfma_f32_32x32x16_bf16 v[96:111], v[76:79], v[20:23], v[96:111]
    ds_read_b64_tr_b16 v[72:73], v231 offset:61440
    ds_read_b64_tr_b16 v[74:75], v231 offset:64000
    s_add_u32 m0, s66, 82944
    s_nop 0
    buffer_load_dwordx4 v225, s[84:87], s61 offen lds
    s_waitcnt lgkmcnt(6)
    v_mfma_f32_32x32x16_bf16 v[112:127], v[60:63], v[20:23], v[112:127]
    ds_read_b64_tr_b16 v[76:77], v232 offset:61440
    ds_read_b64_tr_b16 v[78:79], v232 offset:64000
    s_waitcnt lgkmcnt(6)
    v_mfma_f32_32x32x16_bf16 v[128:143], v[64:67], v[20:23], v[128:143]
    buffer_load_dwordx4 v[20:23], v235, s[20:23], s63 offen offset:1024 sc1
    s_add_u32 s63, s63, 4096
    ds_read_b64_tr_b16 v[60:61], v233 offset:61440
    ds_read_b64_tr_b16 v[62:63], v233 offset:64000
    s_add_u32 m0, s66, 83968
    s_mov_b32 exec_hi, 0
    buffer_load_dwordx4 v226, s[84:87], s61 offen lds
    s_mov_b32 exec_hi, -1
    s_add_u32 s61, s61, s62
    s_waitcnt vmcnt(25)
    s_waitcnt lgkmcnt(6)
    v_mfma_f32_32x32x16_bf16 v[80:95], v[68:71], v[24:27], v[80:95]
    v_add_u32 v230, 61440, v230
    v_add_u32 v231, 61440, v231
    v_add_u32 v232, 61440, v232
    v_add_u32 v233, 61440, v233
    ds_read_b64_tr_b16 v[64:65], v230 offset:5120
    ds_read_b64_tr_b16 v[66:67], v230 offset:7680
    s_waitcnt lgkmcnt(6)
    v_mfma_f32_32x32x16_bf16 v[96:111], v[72:75], v[24:27], v[96:111]
    ds_read_b64_tr_b16 v[68:69], v231 offset:5120
    ds_read_b64_tr_b16 v[70:71], v231 offset:7680
    s_waitcnt lgkmcnt(6)
    v_mfma_f32_32x32x16_bf16 v[112:127], v[76:79], v[24:27], v[112:127]
    ds_read_b64_tr_b16 v[72:73], v232 offset:5120
    ds_read_b64_tr_b16 v[74:75], v232 offset:7680
    s_waitcnt lgkmcnt(6)
    v_mfma_f32_32x32x16_bf16 v[128:143], v[60:63], v[24:27], v[128:143]
    buffer_load_dwordx4 v[24:27], v235, s[20:23], s63 offen offset:0 sc1
    ds_read_b64_tr_b16 v[76:77], v233 offset:5120
    ds_read_b64_tr_b16 v[78:79], v233 offset:7680
    s_waitcnt vmcnt(23)
    s_waitcnt lgkmcnt(6)
    v_mfma_f32_32x32x16_bf16 v[80:95], v[64:67], v[28:31], v[80:95]
    s_waitcnt vmcnt(22)
    s_barrier
    ds_read_b64_tr_b16 v[60:61], v230 offset:20480
    ds_read_b64_tr_b16 v[62:63], v230 offset:23040
    s_waitcnt lgkmcnt(6)
    v_mfma_f32_32x32x16_bf16 v[96:111], v[68:71], v[28:31], v[96:111]
    ds_read_b64_tr_b16 v[64:65], v231 offset:20480
    ds_read_b64_tr_b16 v[66:67], v231 offset:23040
    s_add_u32 m0, s66, 102400
    s_nop 0
    buffer_load_dwordx4 v224, s[84:87], s61 offen lds
    s_waitcnt lgkmcnt(6)
    v_mfma_f32_32x32x16_bf16 v[112:127], v[72:75], v[28:31], v[112:127]
    ds_read_b64_tr_b16 v[68:69], v232 offset:20480
    ds_read_b64_tr_b16 v[70:71], v232 offset:23040
    s_waitcnt lgkmcnt(6)
    v_mfma_f32_32x32x16_bf16 v[128:143], v[76:79], v[28:31], v[128:143]
    buffer_load_dwordx4 v[28:31], v235, s[20:23], s63 offen offset:1024 sc1
    s_add_u32 s63, s63, 4096
    s_mul_i32 s52, s60, 57344
    s_sub_u32 s63, s63, s52
    s_add_u32 s63, s63, 212992
    ds_read_b64_tr_b16 v[72:73], v233 offset:20480
    ds_read_b64_tr_b16 v[74:75], v233 offset:23040
    s_add_u32 m0, s66, 103424
    s_nop 0
    buffer_load_dwordx4 v225, s[84:87], s61 offen lds
    s_waitcnt vmcnt(24)
    s_waitcnt lgkmcnt(6)
    v_mfma_f32_32x32x16_bf16 v[80:95], v[60:63], v[32:35], v[80:95]
    ds_read_b64_tr_b16 v[76:77], v230 offset:25600
    ds_read_b64_tr_b16 v[78:79], v230 offset:28160
    s_waitcnt lgkmcnt(6)
    v_mfma_f32_32x32x16_bf16 v[96:111], v[64:67], v[32:35], v[96:111]
    ds_read_b64_tr_b16 v[60:61], v231 offset:25600
    ds_read_b64_tr_b16 v[62:63], v231 offset:28160
    s_add_u32 m0, s66, 104448
    s_mov_b32 exec_hi, 0
    buffer_load_dwordx4 v226, s[84:87], s61 offen lds
    s_mov_b32 exec_hi, -1
    s_add_u32 s61, s61, s62
    s_waitcnt lgkmcnt(6)
    v_mfma_f32_32x32x16_bf16 v[112:127], v[68:71], v[32:35], v[112:127]
    ds_read_b64_tr_b16 v[64:65], v232 offset:25600
    ds_read_b64_tr_b16 v[66:67], v232 offset:28160
    s_waitcnt lgkmcnt(6)
    v_mfma_f32_32x32x16_bf16 v[128:143], v[72:75], v[32:35], v[128:143]
    s_waitcnt vmcnt(13)
    s_mov_b32 s59, 30000
L_pl_56:
    v_cmp_ne_u32 vcc, s50, v253
    s_nop 4
    s_cbranch_vccz L_pd_55
    buffer_load_dword v253, v252, s[20:23], s4 offen sc1
    s_waitcnt vmcnt(0)
    s_sub_u32 s59, s59, 1
    s_cmp_lg_u32 s59, 0
    s_cbranch_scc1 L_pl_56
L_pd_55:
    v_and_b32 v1, 31, v0
    v_lshlrev_b32 v1, 3, v1
    buffer_load_dword v236, v1, s[20:23], s74 offen sc1
    v_and_b32 v252, 3, v0
    v_lshlrev_b32 v252, 2, v252
    buffer_load_dwordx4 v[32:35], v235, s[20:23], s63 offen offset:0 sc1
    ds_read_b64_tr_b16 v[68:69], v233 offset:25600
    ds_read_b64_tr_b16 v[70:71], v233 offset:28160
    s_cmp_eq_u32 s60, 3
    s_cselect_b32 s61, s65, s61
    s_add_u32 m0, s66, 122880
    s_nop 0
    buffer_load_dwordx4 v227, s[84:87], s61 offen lds
    s_waitcnt lgkmcnt(6)
    v_mfma_f32_32x32x16_bf16 v[80:95], v[76:79], v[36:39], v[80:95]
    v_subrev_u32 v230, 122880, v230
    v_subrev_u32 v231, 122880, v231
    v_subrev_u32 v232, 122880, v232
    v_subrev_u32 v233, 122880, v233
    ds_read_b64_tr_b16 v[72:73], v230 offset:0
    ds_read_b64_tr_b16 v[74:75], v230 offset:2560
    s_waitcnt lgkmcnt(6)
    v_mfma_f32_32x32x16_bf16 v[96:111], v[60:63], v[36:39], v[96:111]
    ds_read_b64_tr_b16 v[76:77], v231 offset:0
    ds_read_b64_tr_b16 v[78:79], v231 offset:2560
    s_add_u32 m0, s66, 123904
    s_nop 0
    buffer_load_dwordx4 v228, s[84:87], s61 offen lds
    s_waitcnt lgkmcnt(6)
    v_mfma_f32_32x32x16_bf16 v[112:127], v[64:67], v[36:39], v[112:127]
    ds_read_b64_tr_b16 v[60:61], v232 offset:0
    ds_read_b64_tr_b16 v[62:63], v232 offset:2560
    s_waitcnt lgkmcnt(6)
    v_mfma_f32_32x32x16_bf16 v[128:143], v[68:71], v[36:39], v[128:143]
    buffer_load_dwordx4 v[36:39], v235, s[20:23], s63 offen offset:1024 sc1
    s_add_u32 s63, s63, 4096
    ds_read_b64_tr_b16 v[64:65], v233 offset:0
    ds_read_b64_tr_b16 v[66:67], v233 offset:2560
    s_add_u32 m0, s66, 124928
    s_mov_b32 exec_hi, 0
    buffer_load_dwordx4 v229, s[84:87], s61 offen lds
    s_mov_b32 exec_hi, -1
    s_waitcnt lgkmcnt(6)
    v_mfma_f32_32x32x16_bf16 v[80:95], v[72:75], v[40:43], v[80:95]
    ds_read_b64_tr_b16 v[68:69], v230 offset:5120
    ds_read_b64_tr_b16 v[70:71], v230 offset:7680
    s_waitcnt lgkmcnt(6)
    v_mfma_f32_32x32x16_bf16 v[96:111], v[76:79], v[40:43], v[96:111]
    ds_read_b64_tr_b16 v[72:73], v231 offset:5120
    ds_read_b64_tr_b16 v[74:75], v231 offset:7680
    s_waitcnt lgkmcnt(6)
    v_mfma_f32_32x32x16_bf16 v[112:127], v[60:63], v[40:43], v[112:127]
    ds_read_b64_tr_b16 v[76:77], v232 offset:5120
    ds_read_b64_tr_b16 v[78:79], v232 offset:7680
    s_waitcnt lgkmcnt(6)
    v_mfma_f32_32x32x16_bf16 v[128:143], v[64:67], v[40:43], v[128:143]
    buffer_load_dwordx4 v[40:43], v235, s[20:23], s63 offen offset:0 sc1
    ds_read_b64_tr_b16 v[60:61], v233 offset:5120
    ds_read_b64_tr_b16 v[62:63], v233 offset:7680
    s_waitcnt lgkmcnt(6)
    v_mfma_f32_32x32x16_bf16 v[80:95], v[68:71], v[44:47], v[80:95]
    s_barrier
    ds_read_b64_tr_b16 v[64:65], v230 offset:20480
    ds_read_b64_tr_b16 v[66:67], v230 offset:23040
    s_waitcnt lgkmcnt(6)
    v_mfma_f32_32x32x16_bf16 v[96:111], v[72:75], v[44:47], v[96:111]
    ds_read_b64_tr_b16 v[68:69], v231 offset:20480
    ds_read_b64_tr_b16 v[70:71], v231 offset:23040
    s_waitcnt lgkmcnt(6)
    v_mfma_f32_32x32x16_bf16 v[112:127], v[76:79], v[44:47], v[112:127]
    ds_read_b64_tr_b16 v[72:73], v232 offset:20480
    ds_read_b64_tr_b16 v[74:75], v232 offset:23040
    s_waitcnt lgkmcnt(6)
    v_mfma_f32_32x32x16_bf16 v[128:143], v[60:63], v[44:47], v[128:143]
    buffer_load_dwordx4 v[44:47], v235, s[20:23], s63 offen offset:1024 sc1
    s_add_u32 s63, s63, 4096
    ds_read_b64_tr_b16 v[76:77], v233 offset:20480
    ds_read_b64_tr_b16 v[78:79], v233 offset:23040
    s_waitcnt lgkmcnt(6)
    v_mfma_f32_32x32x16_bf16 v[80:95], v[64:67], v[48:51], v[80:95]
    ds_read_b64_tr_b16 v[60:61], v230 offset:25600
    ds_read_b64_tr_b16 v[62:63], v230 offset:28160
    s_waitcnt lgkmcnt(6)
    v_mfma_f32_32x32x16_bf16 v[96:111], v[68:71], v[48:51], v[96:111]
    ds_read_b64_tr_b16 v[64:65], v231 offset:25600
    ds_read_b64_tr_b16 v[66:67], v231 offset:28160
    s_waitcnt lgkmcnt(6)
    v_mfma_f32_32x32x16_bf16 v[112:127], v[72:75], v[48:51], v[112:127]
    ds_read_b64_tr_b16 v[68:69], v232 offset:25600
    ds_read_b64_tr_b16 v[70:71], v232 offset:28160
    s_waitcnt lgkmcnt(6)
    v_mfma_f32_32x32x16_bf16 v[128:143], v[76:79], v[48:51], v[128:143]
    buffer_load_dwordx4 v[48:51], v235, s[20:23], s63 offen offset:0 sc1
    ds_read_b64_tr_b16 v[72:73], v233 offset:25600
    ds_read_b64_tr_b16 v[74:75], v233 offset:28160
    s_waitcnt vmcnt(21)
    s_waitcnt lgkmcnt(6)
    v_mfma_f32_32x32x16_bf16 v[80:95], v[60:63], v[52:55], v[80:95]
    ds_read_b64_tr_b16 v[76:77], v230 offset:40960
    ds_read_b64_tr_b16 v[78:79], v230 offset:43520
    s_waitcnt lgkmcnt(6)
    v_mfma_f32_32x32x16_bf16 v[96:111], v[64:67], v[52:55], v[96:111]
    ds_read_b64_tr_b16 v[60:61], v231 offset:40960
    ds_read_b64_tr_b16 v[62:63], v231 offset:43520
    s_waitcnt lgkmcnt(6)
    v_mfma_f32_32x32x16_bf16 v[112:127], v[68:71], v[52:55], v[112:127]
    ds_read_b64_tr_b16 v[64:65], v232 offset:40960
    ds_read_b64_tr_b16 v[66:67], v232 offset:43520
    s_waitcnt lgkmcnt(6)
    v_mfma_f32_32x32x16_bf16 v[128:143], v[72:75], v[52:55], v[128:143]
    buffer_load_dwordx4 v[52:55], v235, s[20:23], s63 offen offset:1024 sc1
    s_add_u32 s63, s63, 4096
    ds_read_b64_tr_b16 v[68:69], v233 offset:40960
    ds_read_b64_tr_b16 v[70:71], v233 offset:43520
    s_waitcnt vmcnt(19)
    s_waitcnt lgkmcnt(6)
    v_mfma_f32_32x32x16_bf16 v[80:95], v[76:79], v[16:19], v[80:95]
    ds_read_b64_tr_b16 v[72:73], v230 offset:46080
    ds_read_b64_tr_b16 v[74:75], v230 offset:48640
    s_waitcnt lgkmcnt(6)
    v_mfma_f32_32x32x16_bf16 v[96:111], v[60:63], v[16:19], v[96:111]
    ds_read_b64_tr_b16 v[76:77], v231 offset:46080
    ds_read_b64_tr_b16 v[78:79], v231 offset:48640
    s_waitcnt lgkmcnt(6)
    v_mfma_f32_32x32x16_bf16 v[112:127], v[64:67], v[16:19], v[112:127]
    ds_read_b64_tr_b16 v[60:61], v232 offset:46080
    ds_read_b64_tr_b16 v[62:63], v232 offset:48640
    s_waitcnt lgkmcnt(6)
    v_mfma_f32_32x32x16_bf16 v[128:143], v[68:71], v[16:19], v[128:143]
    ds_read_b64_tr_b16 v[64:65], v233 offset:46080
    ds_read_b64_tr_b16 v[66:67], v233 offset:48640
    s_waitcnt vmcnt(16)
    s_waitcnt lgkmcnt(6)
    v_mfma_f32_32x32x16_bf16 v[80:95], v[72:75], v[20:23], v[80:95]
    s_waitcnt vmcnt(15)
    s_barrier
    ds_read_b64_tr_b16 v[68:69], v230 offset:61440
    ds_read_b64_tr_b16 v[70:71], v230 offset:64000
    s_waitcnt lgkmcnt(6)
    v_mfma_f32_32x32x16_bf16 v[96:111], v[76:79], v[20:23], v[96:111]
    ds_read_b64_tr_b16 v[72:73], v231 offset:61440
    ds_read_b64_tr_b16 v[74:75], v231 offset:64000
    s_waitcnt lgkmcnt(6)
    v_mfma_f32_32x32x16_bf16 v[112:127], v[60:63], v[20:23], v[112:127]
    ds_read_b64_tr_b16 v[76:77], v232 offset:61440
    ds_read_b64_tr_b16 v[78:79], v232 offset:64000
    s_waitcnt lgkmcnt(6)
    v_mfma_f32_32x32x16_bf16 v[128:143], v[64:67], v[20:23], v[128:143]
    ds_read_b64_tr_b16 v[60:61], v233 offset:61440
    ds_read_b64_tr_b16 v[62:63], v233 offset:64000
    s_waitcnt vmcnt(14)
    s_waitcnt lgkmcnt(6)
    v_mfma_f32_32x32x16_bf16 v[80:95], v[68:71], v[24:27], v[80:95]
    v_add_u32 v230, 61440, v230
    v_add_u32 v231, 61440, v231
    v_add_u32 v232, 61440, v232
    v_add_u32 v233, 61440, v233
    ds_read_b64_tr_b16 v[64:65], v230 offset:5120
    ds_read_b64_tr_b16 v[66:67], v230 offset:7680
    s_waitcnt lgkmcnt(6)
    v_mfma_f32_32x32x16_bf16 v[96:111], v[72:75], v[24:27], v[96:111]
    ds_read_b64_tr_b16 v[68:69], v231 offset:5120
    ds_read_b64_tr_b16 v[70:71], v231 offset:7680
    s_waitcnt lgkmcnt(6)
    v_mfma_f32_32x32x16_bf16 v[112:127], v[76:79], v[24:27], v[112:127]
    ds_read_b64_tr_b16 v[72:73], v232 offset:5120
    ds_read_b64_tr_b16 v[74:75], v232 offset:7680
    s_waitcnt lgkmcnt(6)
    v_mfma_f32_32x32x16_bf16 v[128:143], v[60:63], v[24:27], v[128:143]
    ds_read_b64_tr_b16 v[76:77], v233 offset:5120
    ds_read_b64_tr_b16 v[78:79], v233 offset:7680
    s_waitcnt vmcnt(12)
    s_waitcnt lgkmcnt(6)
    v_mfma_f32_32x32x16_bf16 v[80:95], v[64:67], v[28:31], v[80:95]
    ds_read_b64_tr_b16 v[60:61], v230 offset:20480
    ds_read_b64_tr_b16 v[62:63], v230 offset:23040
    s_waitcnt lgkmcnt(6)
    v_mfma_f32_32x32x16_bf16 v[96:111], v[68:71], v[28:31], v[96:111]
    ds_read_b64_tr_b16 v[64:65], v231 offset:20480
    ds_read_b64_tr_b16 v[66:67], v231 offset:23040
    s_waitcnt lgkmcnt(6)
    v_mfma_f32_32x32x16_bf16 v[112:127], v[72:75], v[28:31], v[112:127]
    ds_read_b64_tr_b16 v[68:69], v232 offset:20480
    ds_read_b64_tr_b16 v[70:71], v232 offset:23040
    s_waitcnt lgkmcnt(6)
    v_mfma_f32_32x32x16_bf16 v[128:143], v[76:79], v[28:31], v[128:143]
    ds_read_b64_tr_b16 v[72:73], v233 offset:20480
    ds_read_b64_tr_b16 v[74:75], v233 offset:23040
    s_waitcnt vmcnt(9)
    v_and_b32 v236, 0xffff0000, v236
    v_mul_f32 v80, v80, v236
    v_mul_f32 v81, v81, v236
    v_mul_f32 v82, v82, v236
    v_mul_f32 v83, v83, v236
    v_mul_f32 v84, v84, v236
    v_mul_f32 v85, v85, v236
    v_mul_f32 v86, v86, v236
    v_mul_f32 v87, v87, v236
    v_mul_f32 v88, v88, v236
    v_mul_f32 v89, v89, v236
    v_mul_f32 v90, v90, v236
    v_mul_f32 v91, v91, v236
    v_mul_f32 v92, v92, v236
    v_mul_f32 v93, v93, v236
    v_mul_f32 v94, v94, v236
    v_mul_f32 v95, v95, v236
    v_mul_f32 v96, v96, v236
    v_mul_f32 v97, v97, v236
    v_mul_f32 v98, v98, v236
    v_mul_f32 v99, v99, v236
    v_mul_f32 v100, v100, v236
    v_mul_f32 v101, v101, v236
    v_mul_f32 v102, v102, v236
    v_mul_f32 v103, v103, v236
    v_mul_f32 v104, v104, v236
    v_mul_f32 v105, v105, v236
    v_mul_f32 v106, v106, v236
    v_mul_f32 v107, v107, v236
    v_mul_f32 v108, v108, v236
    v_mul_f32 v109, v109, v236
    v_mul_f32 v110, v110, v236
    v_mul_f32 v111, v111, v236
    v_mul_f32 v112, v112, v236
    v_mul_f32 v113, v113, v236
    v_mul_f32 v114, v114, v236
    v_mul_f32 v115, v115, v236
    v_mul_f32 v116, v116, v236
    v_mul_f32 v117, v117, v236
    v_mul_f32 v118, v118, v236
    v_mul_f32 v119, v119, v236
    v_mul_f32 v120, v120, v236
    v_mul_f32 v121, v121, v236
    v_mul_f32 v122, v122, v236
    v_mul_f32 v123, v123, v236
    v_mul_f32 v124, v124, v236
    v_mul_f32 v125, v125, v236
    v_mul_f32 v126, v126, v236
    v_mul_f32 v127, v127, v236
    v_mul_f32 v128, v128, v236
    v_mul_f32 v129, v129, v236
    v_mul_f32 v130, v130, v236
    v_mul_f32 v131, v131, v236
    v_mul_f32 v132, v132, v236
    v_mul_f32 v133, v133, v236
    v_mul_f32 v134, v134, v236
    v_mul_f32 v135, v135, v236
    v_mul_f32 v136, v136, v236
    v_mul_f32 v137, v137, v236
    v_mul_f32 v138, v138, v236
    v_mul_f32 v139, v139, v236
    v_mul_f32 v140, v140, v236
    v_mul_f32 v141, v141, v236
    v_mul_f32 v142, v142, v236
    v_mul_f32 v143, v143, v236
    s_waitcnt vmcnt(8)
    s_waitcnt lgkmcnt(6)
    v_mfma_f32_32x32x16_bf16 v[80:95], v[60:63], v[32:35], v[80:95]
    ds_read_b64_tr_b16 v[76:77], v230 offset:25600
    ds_read_b64_tr_b16 v[78:79], v230 offset:28160
    s_waitcnt lgkmcnt(6)
    v_mfma_f32_32x32x16_bf16 v[96:111], v[64:67], v[32:35], v[96:111]
    ds_read_b64_tr_b16 v[60:61], v231 offset:25600
    ds_read_b64_tr_b16 v[62:63], v231 offset:28160
    s_waitcnt lgkmcnt(6)
    v_mfma_f32_32x32x16_bf16 v[112:127], v[68:71], v[32:35], v[112:127]
    ds_read_b64_tr_b16 v[64:65], v232 offset:25600
    ds_read_b64_tr_b16 v[66:67], v232 offset:28160
    s_waitcnt lgkmcnt(6)
    v_mfma_f32_32x32x16_bf16 v[128:143], v[72:75], v[32:35], v[128:143]
    ds_read_b64_tr_b16 v[68:69], v233 offset:25600
    ds_read_b64_tr_b16 v[70:71], v233 offset:28160
    s_waitcnt vmcnt(5)
    s_waitcnt lgkmcnt(6)
    v_mfma_f32_32x32x16_bf16 v[80:95], v[76:79], v[36:39], v[80:95]
    s_waitcnt vmcnt(4)
    s_barrier
    ds_read_b64_tr_b16 v[72:73], v230 offset:40960
    ds_read_b64_tr_b16 v[74:75], v230 offset:43520
    s_waitcnt lgkmcnt(6)
    v_mfma_f32_32x32x16_bf16 v[96:111], v[60:63], v[36:39], v[96:111]
    ds_read_b64_tr_b16 v[76:77], v231 offset:40960
    ds_read_b64_tr_b16 v[78:79], v231 offset:43520
    s_waitcnt lgkmcnt(6)
    v_mfma_f32_32x32x16_bf16 v[112:127], v[64:67], v[36:39], v[112:127]
    ds_read_b64_tr_b16 v[60:61], v232 offset:40960
    ds_read_b64_tr_b16 v[62:63], v232 offset:43520
    s_waitcnt lgkmcnt(6)
    v_mfma_f32_32x32x16_bf16 v[128:143], v[68:71], v[36:39], v[128:143]
    buffer_load_dword v253, v252, s[20:23], s71 offen sc1
    ds_read_b64_tr_b16 v[64:65], v233 offset:40960
    ds_read_b64_tr_b16 v[66:67], v233 offset:43520
    s_waitcnt vmcnt(4)
    s_waitcnt lgkmcnt(6)
    v_mfma_f32_32x32x16_bf16 v[80:95], v[72:75], v[40:43], v[80:95]
    ds_read_b64_tr_b16 v[68:69], v230 offset:46080
    ds_read_b64_tr_b16 v[70:71], v230 offset:48640
    s_waitcnt lgkmcnt(6)
    v_mfma_f32_32x32x16_bf16 v[96:111], v[76:79], v[40:43], v[96:111]
    ds_read_b64_tr_b16 v[72:73], v231 offset:46080
    ds_read_b64_tr_b16 v[74:75], v231 offset:48640
    s_waitcnt lgkmcnt(6)
    v_mfma_f32_32x32x16_bf16 v[112:127], v[60:63], v[40:43], v[112:127]
    ds_read_b64_tr_b16 v[76:77], v232 offset:46080
    ds_read_b64_tr_b16 v[78:79], v232 offset:48640
    s_waitcnt lgkmcnt(6)
    v_mfma_f32_32x32x16_bf16 v[128:143], v[64:67], v[40:43], v[128:143]
    ds_read_b64_tr_b16 v[60:61], v233 offset:46080
    ds_read_b64_tr_b16 v[62:63], v233 offset:48640
    s_waitcnt vmcnt(3)
    s_waitcnt lgkmcnt(6)
    v_mfma_f32_32x32x16_bf16 v[80:95], v[68:71], v[44:47], v[80:95]
    ds_read_b64_tr_b16 v[64:65], v230 offset:61440
    ds_read_b64_tr_b16 v[66:67], v230 offset:64000
    s_waitcnt lgkmcnt(6)
    v_mfma_f32_32x32x16_bf16 v[96:111], v[72:75], v[44:47], v[96:111]
    ds_read_b64_tr_b16 v[68:69], v231 offset:61440
    ds_read_b64_tr_b16 v[70:71], v231 offset:64000
    s_waitcnt lgkmcnt(6)
    v_mfma_f32_32x32x16_bf16 v[112:127], v[76:79], v[44:47], v[112:127]
    ds_read_b64_tr_b16 v[72:73], v232 offset:61440
    ds_read_b64_tr_b16 v[74:75], v232 offset:64000
    s_waitcnt lgkmcnt(6)
    v_mfma_f32_32x32x16_bf16 v[128:143], v[60:63], v[44:47], v[128:143]
    ds_read_b64_tr_b16 v[76:77], v233 offset:61440
    ds_read_b64_tr_b16 v[78:79], v233 offset:64000
    s_waitcnt vmcnt(2)
    s_waitcnt lgkmcnt(6)
    v_mfma_f32_32x32x16_bf16 v[80:95], v[64:67], v[48:51], v[80:95]
    v_add_u32 v230, 61440, v230
    v_add_u32 v231, 61440, v231
    v_add_u32 v232, 61440, v232
    v_add_u32 v233, 61440, v233
    ds_read_b64_tr_b16 v[60:61], v230 offset:5120
    ds_read_b64_tr_b16 v[62:63], v230 offset:7680
    s_waitcnt lgkmcnt(6)
    v_mfma_f32_32x32x16_bf16 v[96:111], v[68:71], v[48:51], v[96:111]
    ds_read_b64_tr_b16 v[64:65], v231 offset:5120
    ds_read_b64_tr_b16 v[66:67], v231 offset:7680
    s_waitcnt lgkmcnt(6)
    v_mfma_f32_32x32x16_bf16 v[112:127], v[72:75], v[48:51], v[112:127]
    ds_read_b64_tr_b16 v[68:69], v232 offset:5120
    ds_read_b64_tr_b16 v[70:71], v232 offset:7680
    s_waitcnt lgkmcnt(6)
    v_mfma_f32_32x32x16_bf16 v[128:143], v[76:79], v[48:51], v[128:143]
    ds_read_b64_tr_b16 v[72:73], v233 offset:5120
    ds_read_b64_tr_b16 v[74:75], v233 offset:7680
    s_waitcnt vmcnt(1)
    s_waitcnt lgkmcnt(6)
    v_mfma_f32_32x32x16_bf16 v[80:95], v[60:63], v[52:55], v[80:95]
    s_waitcnt lgkmcnt(4)
    v_mfma_f32_32x32x16_bf16 v[96:111], v[64:67], v[52:55], v[96:111]
    s_waitcnt lgkmcnt(2)
    v_mfma_f32_32x32x16_bf16 v[112:127], v[68:71], v[52:55], v[112:127]
    s_waitcnt lgkmcnt(0)
    v_mfma_f32_32x32x16_bf16 v[128:143], v[72:75], v[52:55], v[128:143]
    s_mul_i32 s52, s46, 10240
    v_add_u32 v238, s52, v235
    s_xor_b32 s52, s46, 6
    s_mul_i32 s52, s52, 10240
    v_add_u32 v239, s52, v235
    s_nop 4
    ds_write_b128 v238, v[112:115] offset:0
    ds_write_b128 v238, v[116:119] offset:1024
    ds_write_b128 v238, v[120:123] offset:2048
    ds_write_b128 v238, v[124:127] offset:3072
    ds_write_b128 v238, v[128:131] offset:4096
    ds_write_b128 v238, v[132:135] offset:5120
    ds_write_b128 v238, v[136:139] offset:6144
    ds_write_b128 v238, v[140:143] offset:7168
    v_and_b32 v1, 31, v0
    v_mul_u32_u24 v240, 1152, v1
    v_lshrrev_b32 v1, 5, v0
    v_lshl_add_u32 v240, v1, 4, v240
    v_and_b32 v1, 3, v0
    v_lshlrev_b32 v241, 2, v1
    s_mul_i32 s52, s60, 9216
    s_add_u32 s52, s52, s70
    s_add_u32 s53, s52, s49
    s_xor_b32 s89, s60, 1
    s_mul_i32 s89, s89, 36864
    s_add_u32 s89, s89, s53
    s_xor_b32 s90, s60, 2
    s_mul_i32 s90, s90, 36864
    s_add_u32 s90, s90, s53
    s_xor_b32 s91, s60, 3
    s_mul_i32 s91, s91, 36864
    s_add_u32 s91, s91, s53
    s_mul_i32 s54, s75, 36864
    s_add_u32 s54, s54, s52
    s_add_u32 s54, s54, 8192
    s_waitcnt vmcnt(0)
    s_mov_b32 s59, 30000
L_pl_58:
    v_cmp_ne_u32 vcc, s50, v253
    s_nop 4
    s_cbranch_vccz L_pd_57
    buffer_load_dword v253, v252, s[20:23], s71 offen sc1
    s_waitcnt vmcnt(0)
    s_sub_u32 s59, s59, 1
    s_cmp_lg_u32 s59, 0
    s_cbranch_scc1 L_pl_58
L_pd_57:
    s_waitcnt lgkmcnt(0)
    s_barrier
    ds_read_b128 v[168:171], v239 offset:2048
    ds_read_b128 v[172:175], v239 offset:3072
    ds_read_b128 v[176:179], v239 offset:4096
    ds_read_b128 v[180:183], v239 offset:5120
    ds_read_b128 v[184:187], v239 offset:6144
    ds_read_b128 v[188:191], v239 offset:7168
    ds_read_b128 v[160:163], v239 offset:0
    ds_read_b128 v[164:167], v239 offset:1024
    s_waitcnt lgkmcnt(7)
    v_add_f32 v88, v88, v168
    v_add_f32 v89, v89, v169
    v_add_f32 v90, v90, v170
    v_add_f32 v91, v91, v171
    s_waitcnt lgkmcnt(6)
    v_add_f32 v92, v92, v172
    v_add_f32 v93, v93, v173
    v_add_f32 v94, v94, v174
    v_add_f32 v95, v95, v175
    v_cvt_pk_bf16_f32 v88, v88, v89
    v_cvt_pk_bf16_f32 v89, v90, v91
    v_cvt_pk_bf16_f32 v90, v92, v93
    v_cvt_pk_bf16_f32 v91, v94, v95
    buffer_store_dwordx4 v[88:91], v235, s[20:23], s89 offen sc1
    s_waitcnt lgkmcnt(5)
    v_add_f32 v96, v96, v176
    v_add_f32 v97, v97, v177
    v_add_f32 v98, v98, v178
    v_add_f32 v99, v99, v179
    s_waitcnt lgkmcnt(4)
    v_add_f32 v100, v100, v180
    v_add_f32 v101, v101, v181
    v_add_f32 v102, v102, v182
    v_add_f32 v103, v103, v183
    v_cvt_pk_bf16_f32 v96, v96, v97
    v_cvt_pk_bf16_f32 v97, v98, v99
    v_cvt_pk_bf16_f32 v98, v100, v101
    v_cvt_pk_bf16_f32 v99, v102, v103
    buffer_store_dwordx4 v[96:99], v235, s[20:23], s90 offen sc1
    s_waitcnt lgkmcnt(3)
    v_add_f32 v104, v104, v184
    v_add_f32 v105, v105, v185
    v_add_f32 v106, v106, v186
    v_add_f32 v107, v107, v187
    s_waitcnt lgkmcnt(2)
    v_add_f32 v108, v108, v188
    v_add_f32 v109, v109, v189
    v_add_f32 v110, v110, v190
    v_add_f32 v111, v111, v191
    v_cvt_pk_bf16_f32 v104, v104, v105
    v_cvt_pk_bf16_f32 v105, v106, v107
    v_cvt_pk_bf16_f32 v106, v108, v109
    v_cvt_pk_bf16_f32 v107, v110, v111
    buffer_store_dwordx4 v[104:107], v235, s[20:23], s91 offen sc1
    s_waitcnt lgkmcnt(1)
    v_add_f32 v80, v80, v160
    v_add_f32 v81, v81, v161
    v_add_f32 v82, v82, v162
    v_add_f32 v83, v83, v163
    s_waitcnt lgkmcnt(0)
    v_add_f32 v84, v84, v164
    v_add_f32 v85, v85, v165
    v_add_f32 v86, v86, v166
    v_add_f32 v87, v87, v167
    s_mul_i32 s52, s60, 36864
    s_add_u32 s52, s52, s70
    s_xor_b32 s89, s60, 1
    s_mul_i32 s89, s89, 9216
    s_add_u32 s89, s89, s52
    s_xor_b32 s90, s60, 2
    s_mul_i32 s90, s90, 9216
    s_add_u32 s90, s90, s52
    s_xor_b32 s91, s60, 3
    s_mul_i32 s91, s91, 9216
    s_add_u32 s91, s91, s52
    v_add_u32 v238, s49, v235
    v_add_u32 v239, 8192, v235
    s_mov_b32 s59, 30000
L_rl_59:
    buffer_load_dwordx4 v[164:167], v238, s[20:23], s89 offen sc1
    buffer_load_dwordx4 v[168:171], v238, s[20:23], s90 offen sc1
    buffer_load_dwordx4 v[172:175], v238, s[20:23], s91 offen sc1
    s_waitcnt vmcnt(0)
    v_max3_u32 v192, v164, v165, v166
    v_max3_u32 v193, v167, v168, v169
    v_max3_u32 v194, v170, v171, v172
    v_max3_u32 v192, v192, v173, v174
    v_max3_u32 v193, v193, v175, v194
    v_max_u32 v192, v192, v193
    v_cmp_eq_u32 vcc, -1, v192
    s_nop 4
    s_cbranch_vccz L_rd_60
    s_sub_u32 s59, s59, 1
    s_cmp_lg_u32 s59, 0
    s_cbranch_scc1 L_rl_59
L_rd_60:
    v_lshlrev_b32 v192, 16, v164
    v_and_b32 v193, 0xffff0000, v164
    v_add_f32 v80, v80, v192
    v_add_f32 v81, v81, v193
    v_lshlrev_b32 v192, 16, v165
    v_and_b32 v193, 0xffff0000, v165
    v_add_f32 v82, v82, v192
    v_add_f32 v83, v83, v193
    v_lshlrev_b32 v192, 16, v166
    v_and_b32 v193, 0xffff0000, v166
    v_add_f32 v84, v84, v192
    v_add_f32 v85, v85, v193
    v_lshlrev_b32 v192, 16, v167
    v_and_b32 v193, 0xffff0000, v167
    v_add_f32 v86, v86, v192
    v_add_f32 v87, v87, v193
    v_lshlrev_b32 v192, 16, v168
    v_and_b32 v193, 0xffff0000, v168
    v_add_f32 v80, v80, v192
    v_add_f32 v81, v81, v193
    v_lshlrev_b32 v192, 16, v169
    v_and_b32 v193, 0xffff0000, v169
    v_add_f32 v82, v82, v192
    v_add_f32 v83, v83, v193
    v_lshlrev_b32 v192, 16, v170
    v_and_b32 v193, 0xffff0000, v170
    v_add_f32 v84, v84, v192
    v_add_f32 v85, v85, v193
    v_lshlrev_b32 v192, 16, v171
    v_and_b32 v193, 0xffff0000, v171
    v_add_f32 v86, v86, v192
    v_add_f32 v87, v87, v193
    v_lshlrev_b32 v192, 16, v172
    v_and_b32 v193, 0xffff0000, v172
    v_add_f32 v80, v80, v192
    v_add_f32 v81, v81, v193
    v_lshlrev_b32 v192, 16, v173
    v_and_b32 v193, 0xffff0000, v173
    v_add_f32 v82, v82, v192
    v_add_f32 v83, v83, v193
    v_lshlrev_b32 v192, 16, v174
    v_and_b32 v193, 0xffff0000, v174
    v_add_f32 v84, v84, v192
    v_add_f32 v85, v85, v193
    v_lshlrev_b32 v192, 16, v175
    v_and_b32 v193, 0xffff0000, v175
    v_add_f32 v86, v86, v192
    v_add_f32 v87, v87, v193
    v_cvt_pk_bf16_f32 v80, v80, v81
    v_cvt_pk_bf16_f32 v81, v82, v83
    v_cvt_pk_bf16_f32 v82, v84, v85
    v_cvt_pk_bf16_f32 v83, v86, v87
    s_nop 0
    v_permlane32_swap_b32 v80, v82
    v_permlane32_swap_b32 v81, v83
    buffer_store_dwordx4 v[80:83], v240, s[32:35], s72 offen sc1
L_g2fin_37:
L_end_gated_mix__sliding_block__dense_activation_silu__prompt_kernel:
    s_endpgm
.section .rodata,"a"
.p2align 6
.amdhsa_kernel gated_mix__sliding_block__dense_activation_silu__prompt_kernel
  .amdhsa_next_free_vgpr 256
  .amdhsa_next_free_sgpr 102
  .amdhsa_accum_offset 256
  .amdhsa_group_segment_fixed_size 0
  .amdhsa_kernarg_size 80
  .amdhsa_user_sgpr_count 2
  .amdhsa_user_sgpr_kernarg_segment_ptr 1
  .amdhsa_system_sgpr_workgroup_id_x 1
.end_amdhsa_kernel
```
